```python
import torch

def _softmax(x, axis=-1):
    return torch.softmax(x, dim=axis)

def _gelu(x):
    return torch.nn.functional.gelu(x, approximate='tanh')

def _silu(x):
    return torch.nn.functional.silu(x)

def _sigmoid(x):
    return torch.sigmoid(x)

def _layernorm(x, axis=-1, eps=1e-05):
    m = x.mean(dim=axis, keepdim=True)
    v = x.var(dim=axis, keepdim=True, unbiased=False)
    return (x - m) / torch.sqrt(v + eps)

def _scatter_add(tgt, idx, src, axis=0):
    return tgt.clone().index_add_(axis, idx, src)

def _segment_sum(src, seg, n):
    out = torch.zeros((n,) + src.shape[1:], dtype=src.dtype)
    return out.index_add_(0, seg, src)

def _pad(x, pw):
    flat = tuple((v for pair in reversed(pw) for v in pair))
    return torch.nn.functional.pad(x, flat)
kernel_name = 'interleave_layers__memory_aug_recurrent_mem_tr__dense_activation_silu__prompt'

def setup_inputs():

    _w = lambda a: (lambda t: t.to(torch.bfloat16) if t.is_floating_point() else t)(torch.as_tensor(a))

    def _A_setup():
        B, S, Dm = (1, 2048, 448)
        H, Dh = (16, 256)
        M, seg = (8, 32)
        seg = min(seg, S)
        S = S // seg * seg
        return {'x': _w((lambda *s: torch.randn(*s, dtype=torch.bfloat16) * 0.05)(B, S, Dm)), 'mem0': _w((lambda *s: torch.randn(*s, dtype=torch.bfloat16) * 0.2)(B, M, Dm)), 'Wq': _w((lambda *s: torch.randn(*s, dtype=torch.bfloat16) * 1.6)(Dm, H, Dh) * Dm ** (-0.5)), 'Wk': _w((lambda *s: torch.randn(*s, dtype=torch.bfloat16) * 1.6)(Dm, H, Dh) * Dm ** (-0.5)), 'Wv': _w((lambda *s: torch.randn(*s, dtype=torch.bfloat16) * 0.2)(Dm, H, Dh) * Dm ** (-0.5)), 'Wo': _w((lambda *s: torch.randn(*s, dtype=torch.bfloat16) * 0.2)(H, Dh, Dm) * (H * Dh) ** (-0.5)), 'seg_len': seg}
    _A_in = _A_setup()

    def _B_setup():
        B, S, D, F = (1, 2048, 448, 1792)
        return {'x': _w((lambda *s: torch.randn(*s, dtype=torch.bfloat16) * 0.05)(B, S, D)), 'w1': _w((lambda *s: torch.randn(*s, dtype=torch.bfloat16) * 0.4)(D, F) * D ** (-0.5)), 'w2': _w((lambda *s: torch.randn(*s, dtype=torch.bfloat16) * 0.1)(F, D) * F ** (-0.5))}
    _B_in = _B_setup()
    return {'A_x': _A_in['x'], 'A_mem0': _A_in['mem0'], 'A_Wq': _A_in['Wq'], 'A_Wk': _A_in['Wk'], 'A_Wv': _A_in['Wv'], 'A_Wo': _A_in['Wo'], 'A_seg_len': _A_in['seg_len'], 'B_x': _B_in['x'], 'B_w1': _B_in['w1'], 'B_w2': _B_in['w2']}

def reference(A_x, A_mem0, A_Wq, A_Wk, A_Wv, A_Wo, A_seg_len, B_x, B_w1, B_w2):

    def _A_ref(x, mem0, Wq, Wk, Wv, Wo, seg_len):
        B, S, Dm = x.shape
        H, Dh = (Wq.shape[1], Wq.shape[2])
        M = mem0.shape[1]
        scale = Dh ** (-0.5)
        n_seg = S // seg_len
        L = M + seg_len
        idx = torch.arange(L)
        mask = (idx[:, None] < M) | (idx[:, None] >= idx[None, :])
        mem = mem0
        outs = []
        for s in range(n_seg):
            xs = x[:, s * seg_len:(s + 1) * seg_len, :].clone()
            h = torch.concatenate([mem, xs], axis=1)
            q = torch.einsum('btd,dhe->bhte', h, Wq)
            k = torch.einsum('btd,dhe->bhte', h, Wk)
            v = torch.einsum('btd,dhe->bhte', h, Wv)
            scores = torch.einsum('bhqe,bhke->bhqk', q, k) * scale
            scores = torch.where(mask[None, None], scores, -1000000000.0)
            p = _softmax(scores, axis=-1)
            o = torch.einsum('bhqk,bhke->bhqe', p, v)
            o = torch.einsum('bhte,hed->btd', o, Wo)
            mem = o[:, :M, :].clone()
            outs.append(o[:, M:, :])
        return torch.concatenate(outs, axis=1)

    def _B_ref(x, w1, w2):
        h = torch.einsum('bsd,df->bsf', x, w1)
        h = _silu(h)
        out = torch.einsum('bsf,fd->bsd', h, w2)
        return out
    x = A_x
    x = x + _A_ref(_layernorm(x, axis=-1), A_mem0, A_Wq, A_Wk, A_Wv, A_Wo, A_seg_len)
    x = x + _B_ref(_layernorm(x, axis=-1), B_w1, B_w2)
    x = x + _A_ref(_layernorm(x, axis=-1), A_mem0, A_Wq, A_Wk, A_Wv, A_Wo, A_seg_len)
    x = x + _B_ref(_layernorm(x, axis=-1), B_w1, B_w2)
    return x
```

```asm
; @launch grid=(256,1,1) block=(256,1,1) lds=163840
.amdgcn_target "amdgcn-amd-amdhsa--gfx950"
.text
.globl interleave_layers__memory_aug_recurrent_mem_tr__dense_activation_silu__prompt_kernel
.p2align 8
.type interleave_layers__memory_aug_recurrent_mem_tr__dense_activation_silu__prompt_kernel,@function
interleave_layers__memory_aug_recurrent_mem_tr__dense_activation_silu__prompt_kernel:
  s_cmp_ge_u32 s2, 256
  s_cbranch_scc1 END
  s_load_dwordx4 s[40:43], s[0:1], 0
  s_load_dwordx4 s[44:47], s[0:1], 16
  s_load_dwordx4 s[48:51], s[0:1], 32
  s_load_dwordx4 s[52:55], s[0:1], 64
  s_load_dwordx4 s[8:11], s[0:1], 80
  s_load_dwordx2 s[4:5], s[0:1], 96
  s_getreg_b32 s19, hwreg(HW_REG_XCC_ID, 0, 4)
  v_and_b32 v1, 63, v0
  v_lshrrev_b32 v2, 6, v0
  s_nop 0
  v_readfirstlane_b32 s3, v2
  s_and_b32 s19, s19, 7
  s_waitcnt lgkmcnt(0)
  s_mov_b32 s6, s40
  s_mov_b32 s7, s41
  s_mov_b32 s12, s4
  s_mov_b32 s13, s5
  s_mov_b32 s14, 0x10000000
  s_mov_b32 s15, 0x20000
  s_mov_b32 s92, s10
  s_mov_b32 s93, s11
  s_mov_b32 s94, 0x100
  s_mov_b32 s95, 0x20000
  s_getpc_b64 s[56:57]
PC0:
  s_lshr_b32 s20, s2, 3
  s_lshl_b32 s20, s20, 2
  s_add_u32 s20, s20, s3
  s_lshl_b32 s20, s20, 9
  v_and_b32 v2, 3, v1
  v_lshlrev_b32 v2, 7, v2
  v_add_u32 v2, s20, v2
  v_min_u32 v2, CODE_END-PC0-4, v2
  global_load_dword v252, v2, s[56:57]
  s_lshl_b32 s20, s2, 2
  s_add_u32 s20, s20, s3
  s_cmp_lg_u32 s20, 3
  s_cbranch_scc1 TAG_NO
  s_mov_b32 s20, 17891328
  buffer_load_dword v2, off, s[12:15], s20 sc1
  s_waitcnt vmcnt(0)
  v_or_b32 v2, 7, v2
  v_add_u32 v2, 1, v2
  v_max_u32 v2, 8, v2
  buffer_store_dword v2, off, s[12:15], s20 sc1
  buffer_store_dword v2, off, s[92:95], 0 offset:128 sc1
TAG_NO:
  v_and_b32 v2, 15, v1
  v_lshrrev_b32 v3, 4, v1
  v_lshlrev_b32 v4, 4, v1
  s_and_b32 s20, s2, 7
  s_lshr_b32 s21, s2, 3
  s_mov_b32 s32, s40
  s_mov_b32 s33, s41
  s_mov_b32 s34, 0x1c0000
  s_mov_b32 s35, 0x20000
  v_lshrrev_b32 v6, 2, v1
  v_lshlrev_b32 v6, 6, v6
  v_and_b32 v7, 3, v1
  v_lshl_add_u32 v8, v7, 3, v6
  v_cmp_gt_u32 vcc, 56, v1
  v_mov_b32 v7, 0x7fffffff
  s_nop 0
  v_cndmask_b32 v8, v7, v8, vcc
  v_cndmask_b32 v9, 0, 1.0, vcc
  s_lshl_b32 s22, s2, 3
  s_lshl_b32 s23, s3, 1
  s_add_u32 s22, s22, s23
  s_mul_i32 s22, s22, 896
  buffer_load_dwordx2 v[12:13], v8, s[32:35], s22 offen offset:0 nt
  buffer_load_dwordx2 v[14:15], v8, s[32:35], s22 offen offset:32 nt
  buffer_load_dwordx2 v[16:17], v8, s[32:35], s22 offen offset:896 nt
  buffer_load_dwordx2 v[18:19], v8, s[32:35], s22 offen offset:928 nt
  s_cmp_lg_u32 s3, 0
  s_cselect_b32 s87, 512, 0
  v_sub_u32 v7, 4, v3
  v_xor_b32 v7, v7, v1
  v_and_b32 v7, 3, v7
  v_lshrrev_b32 v6, 2, v1
  v_lshrrev_b32 v10, 2, v2
  v_sub_u32 v10, 4, v10
  v_xor_b32 v10, v10, v3
  v_and_b32 v10, 3, v10
  v_lshl_add_u32 v10, v2, 2, v10
  v_lshlrev_b32 v11, 4, v10
  s_mov_b32 s36, 32
  s_cmp_lt_u32 s20, 2
  s_cbranch_scc1 P0_MEM
  s_sub_u32 s37, s20, 2
  s_mul_i32 s38, s37, 5
  s_min_u32 s39, s37, 2
  s_add_u32 s38, s38, s39
  s_mul_i32 s36, s37, 7
  s_sub_u32 s36, s36, 35
  s_lshl_b32 s39, s37, 1
  s_sub_u32 s39, s39, 30
  s_cmp_lt_u32 s37, 2
  s_cselect_b32 s36, s39, s36
  s_cselect_b32 s39, 30, 25
  s_add_u32 s36, s36, s21
  s_cmp_ge_u32 s21, s39
  s_cbranch_scc1 P0_W
  s_mul_i32 s36, s21, 52
  s_lshr_b32 s36, s36, 8
  s_mul_i32 s37, s36, 5
  s_sub_u32 s37, s21, s37
  s_add_u32 s36, s36, s38
  s_lshl_b32 s69, s36, 7
  s_lshl_b32 s70, s37, 2
  s_add_u32 s69, s69, s70
  s_add_u32 s69, s69, 17903616
  s_and_b32 s58, s36, 1
  s_lshr_b32 s38, s36, 1
  s_mul_i32 s39, s37, 6
  s_cmp_eq_u32 s37, 4
  s_cselect_b32 s39, 23, s39
  v_lshlrev_b32 v5, 13, v6
  v_lshl_add_u32 v5, v7, 4, v5
  s_lshl_b32 s57, s38, 9
  s_lshl_b32 s56, s3, 18
  s_add_u32 s56, s56, s57
  s_cmp_eq_u32 s58, 1
  s_cselect_b32 s60, s48, s44
  s_cselect_b32 s61, s49, s45
  s_mov_b32 s24, s60
  s_mov_b32 s25, s61
  s_mov_b32 s26, 0x380000
  s_mov_b32 s27, 0x20000
  s_lshl_b32 s59, s3, 14
  s_mul_i32 s70, s37, 360
  s_mul_i32 s71, s3, 90
  s_add_u32 s70, s70, s71
  v_add_u32 v10, 0, v1
  v_min_u32 v10, 89, v10
  v_add_u32 v10, s70, v10
  v_lshrrev_b32 v8, 2, v10
  v_lshlrev_b32 v8, 13, v8
  v_and_b32 v10, 3, v10
  v_lshl_add_u32 v8, v10, 7, v8
  buffer_load_dword v227, v8, s[24:27], s57 offen nt
  v_add_u32 v10, 64, v1
  v_min_u32 v10, 89, v10
  v_add_u32 v10, s70, v10
  v_lshrrev_b32 v8, 2, v10
  v_lshlrev_b32 v8, 13, v8
  v_and_b32 v10, 3, v10
  v_lshl_add_u32 v8, v10, 7, v8
  buffer_load_dword v227, v8, s[24:27], s57 offen nt
  s_cmp_eq_u32 s58, 1
  s_cbranch_scc1 P0_B
  s_mov_b32 s28, s46
  s_mov_b32 s29, s47
  s_mov_b32 s30, 0x380000
  s_mov_b32 s31, 0x20000
  s_mul_i32 s71, s3, 12
  s_add_u32 s72, s71, 0
  s_lshr_b32 s73, s72, 3
  s_add_u32 s73, s73, s39
  s_lshl_b32 s73, s73, 17
  s_and_b32 s70, s72, 7
  s_lshl_b32 s70, s70, 6
  s_add_u32 s70, s70, s73
  s_add_u32 s70, s70, s57
  s_lshl_b32 s72, s72, 10
  s_add_u32 m0, s72, 65536
  s_nop 0
  buffer_load_dwordx4 v5, s[28:31], s70 offen nt lds
  s_add_u32 s72, s71, 1
  s_lshr_b32 s73, s72, 3
  s_add_u32 s73, s73, s39
  s_lshl_b32 s73, s73, 17
  s_and_b32 s70, s72, 7
  s_lshl_b32 s70, s70, 6
  s_add_u32 s70, s70, s73
  s_add_u32 s70, s70, s57
  s_lshl_b32 s72, s72, 10
  s_add_u32 m0, s72, 65536
  s_nop 0
  buffer_load_dwordx4 v5, s[28:31], s70 offen nt lds
  s_add_u32 s72, s71, 2
  s_lshr_b32 s73, s72, 3
  s_add_u32 s73, s73, s39
  s_lshl_b32 s73, s73, 17
  s_and_b32 s70, s72, 7
  s_lshl_b32 s70, s70, 6
  s_add_u32 s70, s70, s73
  s_add_u32 s70, s70, s57
  s_lshl_b32 s72, s72, 10
  s_add_u32 m0, s72, 65536
  s_nop 0
  buffer_load_dwordx4 v5, s[28:31], s70 offen nt lds
  s_add_u32 s72, s71, 3
  s_lshr_b32 s73, s72, 3
  s_add_u32 s73, s73, s39
  s_lshl_b32 s73, s73, 17
  s_and_b32 s70, s72, 7
  s_lshl_b32 s70, s70, 6
  s_add_u32 s70, s70, s73
  s_add_u32 s70, s70, s57
  s_lshl_b32 s72, s72, 10
  s_add_u32 m0, s72, 65536
  s_nop 0
  buffer_load_dwordx4 v5, s[28:31], s70 offen nt lds
  s_add_u32 s72, s71, 4
  s_lshr_b32 s73, s72, 3
  s_add_u32 s73, s73, s39
  s_lshl_b32 s73, s73, 17
  s_and_b32 s70, s72, 7
  s_lshl_b32 s70, s70, 6
  s_add_u32 s70, s70, s73
  s_add_u32 s70, s70, s57
  s_lshl_b32 s72, s72, 10
  s_add_u32 m0, s72, 65536
  s_nop 0
  buffer_load_dwordx4 v5, s[28:31], s70 offen nt lds
  s_add_u32 s72, s71, 5
  s_lshr_b32 s73, s72, 3
  s_add_u32 s73, s73, s39
  s_lshl_b32 s73, s73, 17
  s_and_b32 s70, s72, 7
  s_lshl_b32 s70, s70, 6
  s_add_u32 s70, s70, s73
  s_add_u32 s70, s70, s57
  s_lshl_b32 s72, s72, 10
  s_add_u32 m0, s72, 65536
  s_nop 0
  buffer_load_dwordx4 v5, s[28:31], s70 offen nt lds
  s_add_u32 s72, s71, 6
  s_lshr_b32 s73, s72, 3
  s_add_u32 s73, s73, s39
  s_lshl_b32 s73, s73, 17
  s_and_b32 s70, s72, 7
  s_lshl_b32 s70, s70, 6
  s_add_u32 s70, s70, s73
  s_add_u32 s70, s70, s57
  s_lshl_b32 s72, s72, 10
  s_add_u32 m0, s72, 65536
  s_nop 0
  buffer_load_dwordx4 v5, s[28:31], s70 offen nt lds
  s_add_u32 s72, s71, 7
  s_lshr_b32 s73, s72, 3
  s_add_u32 s73, s73, s39
  s_lshl_b32 s73, s73, 17
  s_and_b32 s70, s72, 7
  s_lshl_b32 s70, s70, 6
  s_add_u32 s70, s70, s73
  s_add_u32 s70, s70, s57
  s_lshl_b32 s72, s72, 10
  s_add_u32 m0, s72, 65536
  s_nop 0
  buffer_load_dwordx4 v5, s[28:31], s70 offen nt lds
  s_add_u32 s72, s71, 8
  s_lshr_b32 s73, s72, 3
  s_add_u32 s73, s73, s39
  s_lshl_b32 s73, s73, 17
  s_and_b32 s70, s72, 7
  s_lshl_b32 s70, s70, 6
  s_add_u32 s70, s70, s73
  s_add_u32 s70, s70, s57
  s_lshl_b32 s72, s72, 10
  s_add_u32 m0, s72, 65536
  s_nop 0
  buffer_load_dwordx4 v5, s[28:31], s70 offen nt lds
  s_add_u32 s72, s71, 9
  s_lshr_b32 s73, s72, 3
  s_add_u32 s73, s73, s39
  s_lshl_b32 s73, s73, 17
  s_and_b32 s70, s72, 7
  s_lshl_b32 s70, s70, 6
  s_add_u32 s70, s70, s73
  s_add_u32 s70, s70, s57
  s_lshl_b32 s72, s72, 10
  s_add_u32 m0, s72, 65536
  s_nop 0
  buffer_load_dwordx4 v5, s[28:31], s70 offen nt lds
  s_add_u32 s72, s71, 10
  s_lshr_b32 s73, s72, 3
  s_add_u32 s73, s73, s39
  s_lshl_b32 s73, s73, 17
  s_and_b32 s70, s72, 7
  s_lshl_b32 s70, s70, 6
  s_add_u32 s70, s70, s73
  s_add_u32 s70, s70, s57
  s_lshl_b32 s72, s72, 10
  s_add_u32 m0, s72, 65536
  s_nop 0
  buffer_load_dwordx4 v5, s[28:31], s70 offen nt lds
  s_add_u32 s72, s71, 11
  s_lshr_b32 s73, s72, 3
  s_add_u32 s73, s73, s39
  s_lshl_b32 s73, s73, 17
  s_and_b32 s70, s72, 7
  s_lshl_b32 s70, s70, 6
  s_add_u32 s70, s70, s73
  s_add_u32 s70, s70, s57
  s_lshl_b32 s72, s72, 10
  s_add_u32 m0, s72, 65536
  s_nop 0
  buffer_load_dwordx4 v5, s[28:31], s70 offen nt lds
  s_add_u32 s75, s39, 0
  s_lshr_b32 s70, s75, 1
  s_and_b32 s76, s75, 1
  s_cmp_ge_u32 s70, 7
  s_cselect_b32 s72, 7, 0
  s_cselect_b32 s71, 2, 0
  s_sub_u32 s70, s70, s72
  s_lshl_b32 s72, s70, 1
  s_add_u32 s72, s72, s76
  s_sub_u32 s74, s72, 8
  s_cmp_gt_u32 s70, 3
  s_cselect_b32 s72, s74, s72
  s_cselect_b32 s77, 1, 0
  s_cmp_eq_u32 s70, 3
  s_cselect_b32 s72, 6, s72
  s_cselect_b32 s77, s76, s77
  s_add_u32 s77, s77, s71
  s_lshl_b32 s71, s38, 2
  s_add_u32 s77, s77, s71
  s_mul_i32 s77, s77, 100352
  s_lshl_b32 s72, s72, 11
  s_add_u32 s62, s77, s72
  s_add_u32 s75, s39, 1
  s_lshr_b32 s70, s75, 1
  s_and_b32 s76, s75, 1
  s_cmp_ge_u32 s70, 7
  s_cselect_b32 s72, 7, 0
  s_cselect_b32 s71, 2, 0
  s_sub_u32 s70, s70, s72
  s_lshl_b32 s72, s70, 1
  s_add_u32 s72, s72, s76
  s_sub_u32 s74, s72, 8
  s_cmp_gt_u32 s70, 3
  s_cselect_b32 s72, s74, s72
  s_cselect_b32 s77, 1, 0
  s_cmp_eq_u32 s70, 3
  s_cselect_b32 s72, 6, s72
  s_cselect_b32 s77, s76, s77
  s_add_u32 s77, s77, s71
  s_lshl_b32 s71, s38, 2
  s_add_u32 s77, s77, s71
  s_mul_i32 s77, s77, 100352
  s_lshl_b32 s72, s72, 11
  s_add_u32 s63, s77, s72
  s_add_u32 s75, s39, 2
  s_lshr_b32 s70, s75, 1
  s_and_b32 s76, s75, 1
  s_cmp_ge_u32 s70, 7
  s_cselect_b32 s72, 7, 0
  s_cselect_b32 s71, 2, 0
  s_sub_u32 s70, s70, s72
  s_lshl_b32 s72, s70, 1
  s_add_u32 s72, s72, s76
  s_sub_u32 s74, s72, 8
  s_cmp_gt_u32 s70, 3
  s_cselect_b32 s72, s74, s72
  s_cselect_b32 s77, 1, 0
  s_cmp_eq_u32 s70, 3
  s_cselect_b32 s72, 6, s72
  s_cselect_b32 s77, s76, s77
  s_add_u32 s77, s77, s71
  s_lshl_b32 s71, s38, 2
  s_add_u32 s77, s77, s71
  s_mul_i32 s77, s77, 100352
  s_lshl_b32 s72, s72, 11
  s_add_u32 s64, s77, s72
  s_add_u32 s75, s39, 3
  s_lshr_b32 s70, s75, 1
  s_and_b32 s76, s75, 1
  s_cmp_ge_u32 s70, 7
  s_cselect_b32 s72, 7, 0
  s_cselect_b32 s71, 2, 0
  s_sub_u32 s70, s70, s72
  s_lshl_b32 s72, s70, 1
  s_add_u32 s72, s72, s76
  s_sub_u32 s74, s72, 8
  s_cmp_gt_u32 s70, 3
  s_cselect_b32 s72, s74, s72
  s_cselect_b32 s77, 1, 0
  s_cmp_eq_u32 s70, 3
  s_cselect_b32 s72, 6, s72
  s_cselect_b32 s77, s76, s77
  s_add_u32 s77, s77, s71
  s_lshl_b32 s71, s38, 2
  s_add_u32 s77, s77, s71
  s_mul_i32 s77, s77, 100352
  s_lshl_b32 s72, s72, 11
  s_add_u32 s65, s77, s72
  s_add_u32 s75, s39, 4
  s_lshr_b32 s70, s75, 1
  s_and_b32 s76, s75, 1
  s_cmp_ge_u32 s70, 7
  s_cselect_b32 s72, 7, 0
  s_cselect_b32 s71, 2, 0
  s_sub_u32 s70, s70, s72
  s_lshl_b32 s72, s70, 1
  s_add_u32 s72, s72, s76
  s_sub_u32 s74, s72, 8
  s_cmp_gt_u32 s70, 3
  s_cselect_b32 s72, s74, s72
  s_cselect_b32 s77, 1, 0
  s_cmp_eq_u32 s70, 3
  s_cselect_b32 s72, 6, s72
  s_cselect_b32 s77, s76, s77
  s_add_u32 s77, s77, s71
  s_lshl_b32 s71, s38, 2
  s_add_u32 s77, s77, s71
  s_mul_i32 s77, s77, 100352
  s_lshl_b32 s72, s72, 11
  s_add_u32 s66, s77, s72
  s_add_u32 s75, s39, 5
  s_lshr_b32 s70, s75, 1
  s_and_b32 s76, s75, 1
  s_cmp_ge_u32 s70, 7
  s_cselect_b32 s72, 7, 0
  s_cselect_b32 s71, 2, 0
  s_sub_u32 s70, s70, s72
  s_lshl_b32 s72, s70, 1
  s_add_u32 s72, s72, s76
  s_sub_u32 s74, s72, 8
  s_cmp_gt_u32 s70, 3
  s_cselect_b32 s72, s74, s72
  s_cselect_b32 s77, 1, 0
  s_cmp_eq_u32 s70, 3
  s_cselect_b32 s72, 6, s72
  s_cselect_b32 s77, s76, s77
  s_add_u32 s77, s77, s71
  s_lshl_b32 s71, s38, 2
  s_add_u32 s77, s77, s71
  s_mul_i32 s77, s77, 100352
  s_lshl_b32 s72, s72, 11
  s_add_u32 s67, s77, s72
  s_mov_b32 s68, 14336
  s_mov_b32 s79, 0x3db8aa3b
  v_add_u32 v110, 65536, v11
  s_branch P0_F
P0_B:
  s_mov_b32 s28, s50
  s_mov_b32 s29, s51
  s_mov_b32 s30, 0x380000
  s_mov_b32 s31, 0x20000
  v_lshlrev_b32 v7, 1, v3
  v_xor_b32 v7, 0, v7
  v_xor_b32 v7, v7, v2
  v_mul_u32_u24 v248, 896, v3
  v_lshl_add_u32 v248, v7, 4, v248
  v_lshlrev_b32 v7, 1, v3
  v_xor_b32 v7, 8, v7
  v_xor_b32 v7, v7, v2
  v_mul_u32_u24 v249, 896, v3
  v_lshl_add_u32 v249, v7, 4, v249
  s_lshl_b32 s71, s38, 2
  s_add_u32 s71, s71, s3
  s_mul_i32 s71, s71, 57344
  s_lshl_b32 s72, s39, 5
  s_add_u32 s71, s71, s72
  s_add_u32 s70, s71, 0
  s_add_u32 m0, s59, 65536
  s_nop 0
  buffer_load_dwordx4 v248, s[28:31], s70 offen nt lds
  s_add_u32 s70, s71, 3584
  s_add_u32 m0, s59, 66560
  s_nop 0
  buffer_load_dwordx4 v248, s[28:31], s70 offen nt lds
  s_add_u32 s70, s71, 7168
  s_add_u32 m0, s59, 67584
  s_nop 0
  buffer_load_dwordx4 v249, s[28:31], s70 offen nt lds
  s_add_u32 s70, s71, 10752
  s_add_u32 m0, s59, 68608
  s_nop 0
  buffer_load_dwordx4 v249, s[28:31], s70 offen nt lds
  s_add_u32 s70, s71, 14336
  s_add_u32 m0, s59, 69632
  s_nop 0
  buffer_load_dwordx4 v248, s[28:31], s70 offen nt lds
  s_add_u32 s70, s71, 17920
  s_add_u32 m0, s59, 70656
  s_nop 0
  buffer_load_dwordx4 v248, s[28:31], s70 offen nt lds
  s_add_u32 s70, s71, 21504
  s_add_u32 m0, s59, 71680
  s_nop 0
  buffer_load_dwordx4 v249, s[28:31], s70 offen nt lds
  s_add_u32 s70, s71, 25088
  s_add_u32 m0, s59, 72704
  s_nop 0
  buffer_load_dwordx4 v249, s[28:31], s70 offen nt lds
  s_add_u32 s70, s71, 28672
  s_add_u32 m0, s59, 73728
  s_nop 0
  buffer_load_dwordx4 v248, s[28:31], s70 offen nt lds
  s_add_u32 s70, s71, 32256
  s_add_u32 m0, s59, 74752
  s_nop 0
  buffer_load_dwordx4 v248, s[28:31], s70 offen nt lds
  s_add_u32 s70, s71, 35840
  s_add_u32 m0, s59, 75776
  s_nop 0
  buffer_load_dwordx4 v249, s[28:31], s70 offen nt lds
  s_add_u32 s70, s71, 39424
  s_add_u32 m0, s59, 76800
  s_nop 0
  buffer_load_dwordx4 v249, s[28:31], s70 offen nt lds
  s_add_u32 s70, s71, 43008
  s_add_u32 m0, s59, 77824
  s_nop 0
  buffer_load_dwordx4 v248, s[28:31], s70 offen nt lds
  s_add_u32 s70, s71, 46592
  s_add_u32 m0, s59, 78848
  s_nop 0
  buffer_load_dwordx4 v248, s[28:31], s70 offen nt lds
  s_add_u32 s70, s71, 50176
  s_add_u32 m0, s59, 79872
  s_nop 0
  buffer_load_dwordx4 v249, s[28:31], s70 offen nt lds
  s_add_u32 s70, s71, 53760
  s_add_u32 m0, s59, 80896
  s_nop 0
  buffer_load_dwordx4 v249, s[28:31], s70 offen nt lds
  v_lshrrev_b32 v7, 2, v2
  v_and_b32 v8, 1, v3
  v_lshl_add_u32 v8, v8, 2, v7
  v_lshl_add_u32 v7, v3, 3, v7
  v_lshlrev_b32 v7, 8, v7
  v_and_b32 v10, 3, v1
  v_lshl_add_u32 v7, v10, 3, v7
  v_add_u32 v7, 65536, v7
  v_xor_b32 v10, 0, v8
  v_lshl_add_u32 v110, v10, 5, v7
  s_add_u32 s75, s39, 0
  s_lshr_b32 s70, s75, 1
  s_lshl_b32 s70, s70, 2
  s_lshr_b32 s71, s38, 2
  s_add_u32 s70, s70, s71
  s_mul_i32 s70, s70, 114688
  s_and_b32 s71, s38, 3
  s_lshl_b32 s71, s71, 1
  s_and_b32 s72, s75, 1
  s_add_u32 s71, s71, s72
  s_lshl_b32 s71, s71, 11
  s_add_u32 s70, s70, s71
  s_add_u32 s62, s70, 6422528
  v_xor_b32 v10, 1, v8
  v_lshl_add_u32 v111, v10, 5, v7
  s_add_u32 s75, s39, 1
  s_lshr_b32 s70, s75, 1
  s_lshl_b32 s70, s70, 2
  s_lshr_b32 s71, s38, 2
  s_add_u32 s70, s70, s71
  s_mul_i32 s70, s70, 114688
  s_and_b32 s71, s38, 3
  s_lshl_b32 s71, s71, 1
  s_and_b32 s72, s75, 1
  s_add_u32 s71, s71, s72
  s_lshl_b32 s71, s71, 11
  s_add_u32 s70, s70, s71
  s_add_u32 s63, s70, 6422528
  v_xor_b32 v10, 2, v8
  v_lshl_add_u32 v112, v10, 5, v7
  s_add_u32 s75, s39, 2
  s_lshr_b32 s70, s75, 1
  s_lshl_b32 s70, s70, 2
  s_lshr_b32 s71, s38, 2
  s_add_u32 s70, s70, s71
  s_mul_i32 s70, s70, 114688
  s_and_b32 s71, s38, 3
  s_lshl_b32 s71, s71, 1
  s_and_b32 s72, s75, 1
  s_add_u32 s71, s71, s72
  s_lshl_b32 s71, s71, 11
  s_add_u32 s70, s70, s71
  s_add_u32 s64, s70, 6422528
  v_xor_b32 v10, 3, v8
  v_lshl_add_u32 v113, v10, 5, v7
  s_add_u32 s75, s39, 3
  s_lshr_b32 s70, s75, 1
  s_lshl_b32 s70, s70, 2
  s_lshr_b32 s71, s38, 2
  s_add_u32 s70, s70, s71
  s_mul_i32 s70, s70, 114688
  s_and_b32 s71, s38, 3
  s_lshl_b32 s71, s71, 1
  s_and_b32 s72, s75, 1
  s_add_u32 s71, s71, s72
  s_lshl_b32 s71, s71, 11
  s_add_u32 s70, s70, s71
  s_add_u32 s65, s70, 6422528
  v_xor_b32 v10, 4, v8
  v_lshl_add_u32 v114, v10, 5, v7
  s_add_u32 s75, s39, 4
  s_lshr_b32 s70, s75, 1
  s_lshl_b32 s70, s70, 2
  s_lshr_b32 s71, s38, 2
  s_add_u32 s70, s70, s71
  s_mul_i32 s70, s70, 114688
  s_and_b32 s71, s38, 3
  s_lshl_b32 s71, s71, 1
  s_and_b32 s72, s75, 1
  s_add_u32 s71, s71, s72
  s_lshl_b32 s71, s71, 11
  s_add_u32 s70, s70, s71
  s_add_u32 s66, s70, 6422528
  v_xor_b32 v10, 5, v8
  v_lshl_add_u32 v115, v10, 5, v7
  s_add_u32 s75, s39, 5
  s_lshr_b32 s70, s75, 1
  s_lshl_b32 s70, s70, 2
  s_lshr_b32 s71, s38, 2
  s_add_u32 s70, s70, s71
  s_mul_i32 s70, s70, 114688
  s_and_b32 s71, s38, 3
  s_lshl_b32 s71, s71, 1
  s_and_b32 s72, s75, 1
  s_add_u32 s71, s71, s72
  s_lshl_b32 s71, s71, 11
  s_add_u32 s70, s70, s71
  s_add_u32 s67, s70, 6422528
  s_mov_b32 s68, 16384
  s_mov_b32 s79, 1.0
P0_F:
  buffer_load_dword v251, off, s[92:95], s87 offset:128 sc1
  s_add_u32 s76, s3, s37
  s_lshl_b32 s76, s76, 7
  s_cmp_ge_u32 s37, 3
  s_cselect_b32 s67, 2147418112, s67
  s_lshr_b32 s70, s3, 1
  s_mul_i32 s70, s70, s68
  s_and_b32 s71, s3, 1
  s_lshl_b32 s71, s71, 10
  s_add_u32 s70, s70, s71
  s_lshl_b32 s68, s68, 1
  s_add_u32 s62, s62, s70
  s_add_u32 s63, s63, s70
  s_add_u32 s64, s64, s70
  s_add_u32 s65, s65, s70
  s_add_u32 s66, s66, s70
  s_add_u32 s67, s67, s70
  v_add_u32 v11, s59, v11
  v_add_u32 v108, 65536, v11
  s_waitcnt vmcnt(15)
  v_mul_u32_u24 v10, 144, v1
  s_lshl_b32 s23, s3, 5
  s_add_u32 s23, s23, 147456
  v_add_u32 v10, s23, v10
  v_lshlrev_b32 v232, 16, v12
  v_and_b32 v233, 0xffff0000, v12
  v_lshlrev_b32 v234, 16, v13
  v_and_b32 v235, 0xffff0000, v13
  v_lshlrev_b32 v236, 16, v14
  v_and_b32 v237, 0xffff0000, v14
  v_lshlrev_b32 v238, 16, v15
  v_and_b32 v239, 0xffff0000, v15
  v_add_f32 v240, v232, v233
  v_add_f32 v240, v240, v234
  v_add_f32 v240, v240, v235
  v_add_f32 v240, v240, v236
  v_add_f32 v240, v240, v237
  v_add_f32 v240, v240, v238
  v_add_f32 v240, v240, v239
  s_nop 1
  v_add_f32_dpp v240, v240, v240 row_ror:8 row_mask:0xf bank_mask:0xf
  s_nop 1
  v_add_f32_dpp v240, v240, v240 row_ror:4 row_mask:0xf bank_mask:0xf
  s_nop 1
  v_add_f32_dpp v240, v240, v240 row_ror:2 row_mask:0xf bank_mask:0xf
  s_nop 1
  v_add_f32_dpp v240, v240, v240 row_ror:1 row_mask:0xf bank_mask:0xf
  v_mov_b32 v241, v240
  s_nop 1
  v_permlane16_swap_b32 v240, v241
  v_add_f32 v240, v240, v241
  v_mov_b32 v241, v240
  s_nop 1
  v_permlane32_swap_b32 v240, v241
  v_add_f32 v240, v240, v241
  v_mul_f32 v240, 0x3b124925, v240
  v_sub_f32 v232, v232, v240
  v_sub_f32 v233, v233, v240
  v_sub_f32 v234, v234, v240
  v_sub_f32 v235, v235, v240
  v_sub_f32 v236, v236, v240
  v_sub_f32 v237, v237, v240
  v_sub_f32 v238, v238, v240
  v_sub_f32 v239, v239, v240
  v_mul_f32 v240, v232, v232
  v_fmac_f32 v240, v233, v233
  v_fmac_f32 v240, v234, v234
  v_fmac_f32 v240, v235, v235
  v_fmac_f32 v240, v236, v236
  v_fmac_f32 v240, v237, v237
  v_fmac_f32 v240, v238, v238
  v_fmac_f32 v240, v239, v239
  v_mul_f32 v240, v240, v9
  s_nop 1
  v_add_f32_dpp v240, v240, v240 row_ror:8 row_mask:0xf bank_mask:0xf
  s_nop 1
  v_add_f32_dpp v240, v240, v240 row_ror:4 row_mask:0xf bank_mask:0xf
  s_nop 1
  v_add_f32_dpp v240, v240, v240 row_ror:2 row_mask:0xf bank_mask:0xf
  s_nop 1
  v_add_f32_dpp v240, v240, v240 row_ror:1 row_mask:0xf bank_mask:0xf
  v_mov_b32 v241, v240
  s_nop 1
  v_permlane16_swap_b32 v240, v241
  v_add_f32 v240, v240, v241
  v_mov_b32 v241, v240
  s_nop 1
  v_permlane32_swap_b32 v240, v241
  v_add_f32 v240, v240, v241
  v_mov_b32 v241, 0x3727c5ac
  v_fmac_f32 v241, 0x3b124925, v240
  v_rsq_f32 v240, v241
  s_nop 0
  v_mul_f32 v232, v232, v240
  v_mul_f32 v233, v233, v240
  v_mul_f32 v234, v234, v240
  v_mul_f32 v235, v235, v240
  v_mul_f32 v236, v236, v240
  v_mul_f32 v237, v237, v240
  v_mul_f32 v238, v238, v240
  v_mul_f32 v239, v239, v240
  v_cvt_pk_bf16_f32 v244, v232, v233
  v_cvt_pk_bf16_f32 v245, v234, v235
  v_cvt_pk_bf16_f32 v246, v236, v237
  v_cvt_pk_bf16_f32 v247, v238, v239
  ds_write_b128 v10, v[244:247] offset:0
  v_lshlrev_b32 v232, 16, v16
  v_and_b32 v233, 0xffff0000, v16
  v_lshlrev_b32 v234, 16, v17
  v_and_b32 v235, 0xffff0000, v17
  v_lshlrev_b32 v236, 16, v18
  v_and_b32 v237, 0xffff0000, v18
  v_lshlrev_b32 v238, 16, v19
  v_and_b32 v239, 0xffff0000, v19
  v_add_f32 v240, v232, v233
  v_add_f32 v240, v240, v234
  v_add_f32 v240, v240, v235
  v_add_f32 v240, v240, v236
  v_add_f32 v240, v240, v237
  v_add_f32 v240, v240, v238
  v_add_f32 v240, v240, v239
  s_nop 1
  v_add_f32_dpp v240, v240, v240 row_ror:8 row_mask:0xf bank_mask:0xf
  s_nop 1
  v_add_f32_dpp v240, v240, v240 row_ror:4 row_mask:0xf bank_mask:0xf
  s_nop 1
  v_add_f32_dpp v240, v240, v240 row_ror:2 row_mask:0xf bank_mask:0xf
  s_nop 1
  v_add_f32_dpp v240, v240, v240 row_ror:1 row_mask:0xf bank_mask:0xf
  v_mov_b32 v241, v240
  s_nop 1
  v_permlane16_swap_b32 v240, v241
  v_add_f32 v240, v240, v241
  v_mov_b32 v241, v240
  s_nop 1
  v_permlane32_swap_b32 v240, v241
  v_add_f32 v240, v240, v241
  v_mul_f32 v240, 0x3b124925, v240
  v_sub_f32 v232, v232, v240
  v_sub_f32 v233, v233, v240
  v_sub_f32 v234, v234, v240
  v_sub_f32 v235, v235, v240
  v_sub_f32 v236, v236, v240
  v_sub_f32 v237, v237, v240
  v_sub_f32 v238, v238, v240
  v_sub_f32 v239, v239, v240
  v_mul_f32 v240, v232, v232
  v_fmac_f32 v240, v233, v233
  v_fmac_f32 v240, v234, v234
  v_fmac_f32 v240, v235, v235
  v_fmac_f32 v240, v236, v236
  v_fmac_f32 v240, v237, v237
  v_fmac_f32 v240, v238, v238
  v_fmac_f32 v240, v239, v239
  v_mul_f32 v240, v240, v9
  s_nop 1
  v_add_f32_dpp v240, v240, v240 row_ror:8 row_mask:0xf bank_mask:0xf
  s_nop 1
  v_add_f32_dpp v240, v240, v240 row_ror:4 row_mask:0xf bank_mask:0xf
  s_nop 1
  v_add_f32_dpp v240, v240, v240 row_ror:2 row_mask:0xf bank_mask:0xf
  s_nop 1
  v_add_f32_dpp v240, v240, v240 row_ror:1 row_mask:0xf bank_mask:0xf
  v_mov_b32 v241, v240
  s_nop 1
  v_permlane16_swap_b32 v240, v241
  v_add_f32 v240, v240, v241
  v_mov_b32 v241, v240
  s_nop 1
  v_permlane32_swap_b32 v240, v241
  v_add_f32 v240, v240, v241
  v_mov_b32 v241, 0x3727c5ac
  v_fmac_f32 v241, 0x3b124925, v240
  v_rsq_f32 v240, v241
  s_nop 0
  v_mul_f32 v232, v232, v240
  v_mul_f32 v233, v233, v240
  v_mul_f32 v234, v234, v240
  v_mul_f32 v235, v235, v240
  v_mul_f32 v236, v236, v240
  v_mul_f32 v237, v237, v240
  v_mul_f32 v238, v238, v240
  v_mul_f32 v239, v239, v240
  v_cvt_pk_bf16_f32 v244, v232, v233
  v_cvt_pk_bf16_f32 v245, v234, v235
  v_cvt_pk_bf16_f32 v246, v236, v237
  v_cvt_pk_bf16_f32 v247, v238, v239
  ds_write_b128 v10, v[244:247] offset:16
  s_waitcnt vmcnt(13)
  s_add_u32 s74, s56, 0
  s_add_u32 s75, s59, 0
  s_add_u32 s76, s76, 64
  s_and_b32 s76, s76, 0x1ff
  s_lshl4_add_u32 m0, s76, s75
  s_add_u32 s77, s74, s76
  buffer_load_dwordx4 v5, s[24:27], s77 offen  lds
  s_add_u32 s76, s76, 64
  s_and_b32 s76, s76, 0x1ff
  s_lshl4_add_u32 m0, s76, s75
  s_add_u32 s77, s74, s76
  buffer_load_dwordx4 v5, s[24:27], s77 offen  lds
  s_add_u32 s76, s76, 64
  s_and_b32 s76, s76, 0x1ff
  s_lshl4_add_u32 m0, s76, s75
  s_add_u32 s77, s74, s76
  buffer_load_dwordx4 v5, s[24:27], s77 offen  lds
  s_add_u32 s76, s76, 64
  s_and_b32 s76, s76, 0x1ff
  s_lshl4_add_u32 m0, s76, s75
  s_add_u32 s77, s74, s76
  buffer_load_dwordx4 v5, s[24:27], s77 offen  lds
  s_add_u32 s76, s76, 64
  s_and_b32 s76, s76, 0x1ff
  s_lshl4_add_u32 m0, s76, s75
  s_add_u32 s77, s74, s76
  buffer_load_dwordx4 v5, s[24:27], s77 offen  lds
  s_add_u32 s76, s76, 64
  s_and_b32 s76, s76, 0x1ff
  s_lshl4_add_u32 m0, s76, s75
  s_add_u32 s77, s74, s76
  buffer_load_dwordx4 v5, s[24:27], s77 offen  lds
  s_add_u32 s76, s76, 64
  s_and_b32 s76, s76, 0x1ff
  s_lshl4_add_u32 m0, s76, s75
  s_add_u32 s77, s74, s76
  buffer_load_dwordx4 v5, s[24:27], s77 offen  lds
  s_add_u32 s76, s76, 64
  s_and_b32 s76, s76, 0x1ff
  s_lshl4_add_u32 m0, s76, s75
  s_add_u32 s77, s74, s76
  buffer_load_dwordx4 v5, s[24:27], s77 offen  lds
  s_add_u32 s74, s56, 131072
  s_add_u32 s75, s59, 8192
  s_add_u32 s76, s76, 64
  s_and_b32 s76, s76, 0x1ff
  s_lshl4_add_u32 m0, s76, s75
  s_add_u32 s77, s74, s76
  buffer_load_dwordx4 v5, s[24:27], s77 offen  lds
  s_add_u32 s76, s76, 64
  s_and_b32 s76, s76, 0x1ff
  s_lshl4_add_u32 m0, s76, s75
  s_add_u32 s77, s74, s76
  buffer_load_dwordx4 v5, s[24:27], s77 offen  lds
  s_add_u32 s76, s76, 64
  s_and_b32 s76, s76, 0x1ff
  s_lshl4_add_u32 m0, s76, s75
  s_add_u32 s77, s74, s76
  buffer_load_dwordx4 v5, s[24:27], s77 offen  lds
  s_add_u32 s76, s76, 64
  s_and_b32 s76, s76, 0x1ff
  s_lshl4_add_u32 m0, s76, s75
  s_add_u32 s77, s74, s76
  buffer_load_dwordx4 v5, s[24:27], s77 offen  lds
  s_add_u32 s76, s76, 64
  s_and_b32 s76, s76, 0x1ff
  s_lshl4_add_u32 m0, s76, s75
  s_add_u32 s77, s74, s76
  buffer_load_dwordx4 v5, s[24:27], s77 offen  lds
  s_add_u32 s76, s76, 64
  s_and_b32 s76, s76, 0x1ff
  s_lshl4_add_u32 m0, s76, s75
  s_add_u32 s77, s74, s76
  buffer_load_dwordx4 v5, s[24:27], s77 offen  lds
  s_add_u32 s76, s76, 64
  s_and_b32 s76, s76, 0x1ff
  s_lshl4_add_u32 m0, s76, s75
  s_add_u32 s77, s74, s76
  buffer_load_dwordx4 v5, s[24:27], s77 offen  lds
  s_add_u32 s76, s76, 64
  s_and_b32 s76, s76, 0x1ff
  s_lshl4_add_u32 m0, s76, s75
  s_add_u32 s77, s74, s76
  buffer_load_dwordx4 v5, s[24:27], s77 offen  lds
  s_waitcnt vmcnt(16) lgkmcnt(0)
  s_barrier
  s_cmp_lg_u32 s3, 0
  s_cselect_b32 s23, 2147418112, 0
  s_cbranch_scc1 TAG_S0
  v_cmp_eq_u32 vcc, 0, v251
  s_cbranch_vccz TAG_K0
TAG_L0:
  buffer_load_dword v251, off, s[92:95], s87 offset:128 sc1
  s_add_u32 s23, s23, 1
  s_cmp_gt_u32 s23, 131072
  s_mov_b32 s99, 19
  s_cbranch_scc1 FAIL
  s_waitcnt vmcnt(0)
  v_cmp_eq_u32 vcc, 0, v251
  s_cbranch_vccnz TAG_L0
TAG_K0:
  v_readfirstlane_b32 s90, v251
  v_add_u32 v251, s19, v251
  s_lshr_b32 s23, s2, 3
  s_lshl_b32 s23, s23, 7
  s_and_b32 s22, s2, 7
  s_lshl_b32 s22, s22, 2
  s_add_u32 s23, s23, s22
  s_add_u32 s23, s23, 17899520
TAG_S0:
  buffer_store_dword v251, off, s[12:15], s23 sc1
  s_cmp_eq_u32 s58, 1
  s_cbranch_scc1 P0_RB
  ds_read_b128 a[0:3], v110 offset:0
  ds_read_b128 a[4:7], v110 offset:1024
  ds_read_b128 a[8:11], v110 offset:2048
  ds_read_b128 a[12:15], v110 offset:3072
  ds_read_b128 a[16:19], v110 offset:4096
  ds_read_b128 a[20:23], v110 offset:5120
  ds_read_b128 a[24:27], v110 offset:6144
  ds_read_b128 a[28:31], v110 offset:7168
  ds_read_b128 a[32:35], v110 offset:8192
  ds_read_b128 a[36:39], v110 offset:9216
  ds_read_b128 a[40:43], v110 offset:10240
  ds_read_b128 a[44:47], v110 offset:11264
  s_waitcnt lgkmcnt(0)
  ds_read_b128 a[48:51], v110 offset:12288
  ds_read_b128 a[52:55], v110 offset:13312
  ds_read_b128 a[56:59], v110 offset:14336
  ds_read_b128 a[60:63], v110 offset:15360
  ds_read_b128 a[64:67], v110 offset:16384
  ds_read_b128 a[68:71], v110 offset:17408
  ds_read_b128 a[72:75], v110 offset:18432
  ds_read_b128 a[76:79], v110 offset:19456
  ds_read_b128 a[80:83], v110 offset:20480
  ds_read_b128 a[84:87], v110 offset:21504
  ds_read_b128 a[88:91], v110 offset:22528
  ds_read_b128 a[92:95], v110 offset:23552
  s_waitcnt lgkmcnt(0)
  ds_read_b128 a[96:99], v110 offset:24576
  ds_read_b128 a[100:103], v110 offset:25600
  ds_read_b128 a[104:107], v110 offset:26624
  ds_read_b128 a[108:111], v110 offset:27648
  ds_read_b128 a[112:115], v110 offset:28672
  ds_read_b128 a[116:119], v110 offset:29696
  ds_read_b128 a[120:123], v110 offset:30720
  ds_read_b128 a[124:127], v110 offset:31744
  ds_read_b128 a[128:131], v110 offset:32768
  ds_read_b128 a[132:135], v110 offset:33792
  ds_read_b128 a[136:139], v110 offset:34816
  ds_read_b128 a[140:143], v110 offset:35840
  s_waitcnt lgkmcnt(0)
  ds_read_b128 a[144:147], v110 offset:36864
  ds_read_b128 a[148:151], v110 offset:37888
  ds_read_b128 a[152:155], v110 offset:38912
  ds_read_b128 a[156:159], v110 offset:39936
  ds_read_b128 a[160:163], v110 offset:40960
  ds_read_b128 a[164:167], v110 offset:41984
  ds_read_b128 a[168:171], v110 offset:43008
  ds_read_b128 a[172:175], v110 offset:44032
  ds_read_b128 a[176:179], v110 offset:45056
  ds_read_b128 a[180:183], v110 offset:46080
  ds_read_b128 a[184:187], v110 offset:47104
  ds_read_b128 a[188:191], v110 offset:48128
  s_waitcnt lgkmcnt(0)
  s_branch P0_RE
P0_RB:
  ds_read_b64_tr_b16 a[0:1], v110 offset:0
  ds_read_b64_tr_b16 a[2:3], v110 offset:1024
  ds_read_b64_tr_b16 a[32:33], v111 offset:0
  ds_read_b64_tr_b16 a[34:35], v111 offset:1024
  ds_read_b64_tr_b16 a[64:65], v112 offset:0
  ds_read_b64_tr_b16 a[66:67], v112 offset:1024
  ds_read_b64_tr_b16 a[96:97], v113 offset:0
  ds_read_b64_tr_b16 a[98:99], v113 offset:1024
  ds_read_b64_tr_b16 a[128:129], v114 offset:0
  ds_read_b64_tr_b16 a[130:131], v114 offset:1024
  ds_read_b64_tr_b16 a[160:161], v115 offset:0
  ds_read_b64_tr_b16 a[162:163], v115 offset:1024
  s_waitcnt lgkmcnt(0)
  ds_read_b64_tr_b16 a[4:5], v110 offset:8192
  ds_read_b64_tr_b16 a[6:7], v110 offset:9216
  ds_read_b64_tr_b16 a[36:37], v111 offset:8192
  ds_read_b64_tr_b16 a[38:39], v111 offset:9216
  ds_read_b64_tr_b16 a[68:69], v112 offset:8192
  ds_read_b64_tr_b16 a[70:71], v112 offset:9216
  ds_read_b64_tr_b16 a[100:101], v113 offset:8192
  ds_read_b64_tr_b16 a[102:103], v113 offset:9216
  ds_read_b64_tr_b16 a[132:133], v114 offset:8192
  ds_read_b64_tr_b16 a[134:135], v114 offset:9216
  ds_read_b64_tr_b16 a[164:165], v115 offset:8192
  ds_read_b64_tr_b16 a[166:167], v115 offset:9216
  s_waitcnt lgkmcnt(0)
  ds_read_b64_tr_b16 a[8:9], v110 offset:16384
  ds_read_b64_tr_b16 a[10:11], v110 offset:17408
  ds_read_b64_tr_b16 a[40:41], v111 offset:16384
  ds_read_b64_tr_b16 a[42:43], v111 offset:17408
  ds_read_b64_tr_b16 a[72:73], v112 offset:16384
  ds_read_b64_tr_b16 a[74:75], v112 offset:17408
  ds_read_b64_tr_b16 a[104:105], v113 offset:16384
  ds_read_b64_tr_b16 a[106:107], v113 offset:17408
  ds_read_b64_tr_b16 a[136:137], v114 offset:16384
  ds_read_b64_tr_b16 a[138:139], v114 offset:17408
  ds_read_b64_tr_b16 a[168:169], v115 offset:16384
  ds_read_b64_tr_b16 a[170:171], v115 offset:17408
  s_waitcnt lgkmcnt(0)
  ds_read_b64_tr_b16 a[12:13], v110 offset:24576
  ds_read_b64_tr_b16 a[14:15], v110 offset:25600
  ds_read_b64_tr_b16 a[44:45], v111 offset:24576
  ds_read_b64_tr_b16 a[46:47], v111 offset:25600
  ds_read_b64_tr_b16 a[76:77], v112 offset:24576
  ds_read_b64_tr_b16 a[78:79], v112 offset:25600
  ds_read_b64_tr_b16 a[108:109], v113 offset:24576
  ds_read_b64_tr_b16 a[110:111], v113 offset:25600
  ds_read_b64_tr_b16 a[140:141], v114 offset:24576
  ds_read_b64_tr_b16 a[142:143], v114 offset:25600
  ds_read_b64_tr_b16 a[172:173], v115 offset:24576
  ds_read_b64_tr_b16 a[174:175], v115 offset:25600
  s_waitcnt lgkmcnt(0)
  ds_read_b64_tr_b16 a[16:17], v110 offset:32768
  ds_read_b64_tr_b16 a[18:19], v110 offset:33792
  ds_read_b64_tr_b16 a[48:49], v111 offset:32768
  ds_read_b64_tr_b16 a[50:51], v111 offset:33792
  ds_read_b64_tr_b16 a[80:81], v112 offset:32768
  ds_read_b64_tr_b16 a[82:83], v112 offset:33792
  ds_read_b64_tr_b16 a[112:113], v113 offset:32768
  ds_read_b64_tr_b16 a[114:115], v113 offset:33792
  ds_read_b64_tr_b16 a[144:145], v114 offset:32768
  ds_read_b64_tr_b16 a[146:147], v114 offset:33792
  ds_read_b64_tr_b16 a[176:177], v115 offset:32768
  ds_read_b64_tr_b16 a[178:179], v115 offset:33792
  s_waitcnt lgkmcnt(0)
  ds_read_b64_tr_b16 a[20:21], v110 offset:40960
  ds_read_b64_tr_b16 a[22:23], v110 offset:41984
  ds_read_b64_tr_b16 a[52:53], v111 offset:40960
  ds_read_b64_tr_b16 a[54:55], v111 offset:41984
  ds_read_b64_tr_b16 a[84:85], v112 offset:40960
  ds_read_b64_tr_b16 a[86:87], v112 offset:41984
  ds_read_b64_tr_b16 a[116:117], v113 offset:40960
  ds_read_b64_tr_b16 a[118:119], v113 offset:41984
  ds_read_b64_tr_b16 a[148:149], v114 offset:40960
  ds_read_b64_tr_b16 a[150:151], v114 offset:41984
  ds_read_b64_tr_b16 a[180:181], v115 offset:40960
  ds_read_b64_tr_b16 a[182:183], v115 offset:41984
  s_waitcnt lgkmcnt(0)
  ds_read_b64_tr_b16 a[24:25], v110 offset:49152
  ds_read_b64_tr_b16 a[26:27], v110 offset:50176
  ds_read_b64_tr_b16 a[56:57], v111 offset:49152
  ds_read_b64_tr_b16 a[58:59], v111 offset:50176
  ds_read_b64_tr_b16 a[88:89], v112 offset:49152
  ds_read_b64_tr_b16 a[90:91], v112 offset:50176
  ds_read_b64_tr_b16 a[120:121], v113 offset:49152
  ds_read_b64_tr_b16 a[122:123], v113 offset:50176
  ds_read_b64_tr_b16 a[152:153], v114 offset:49152
  ds_read_b64_tr_b16 a[154:155], v114 offset:50176
  ds_read_b64_tr_b16 a[184:185], v115 offset:49152
  ds_read_b64_tr_b16 a[186:187], v115 offset:50176
  s_waitcnt lgkmcnt(0)
  ds_read_b64_tr_b16 a[28:29], v110 offset:57344
  ds_read_b64_tr_b16 a[30:31], v110 offset:58368
  ds_read_b64_tr_b16 a[60:61], v111 offset:57344
  ds_read_b64_tr_b16 a[62:63], v111 offset:58368
  ds_read_b64_tr_b16 a[92:93], v112 offset:57344
  ds_read_b64_tr_b16 a[94:95], v112 offset:58368
  ds_read_b64_tr_b16 a[124:125], v113 offset:57344
  ds_read_b64_tr_b16 a[126:127], v113 offset:58368
  ds_read_b64_tr_b16 a[156:157], v114 offset:57344
  ds_read_b64_tr_b16 a[158:159], v114 offset:58368
  ds_read_b64_tr_b16 a[188:189], v115 offset:57344
  ds_read_b64_tr_b16 a[190:191], v115 offset:58368
  s_waitcnt lgkmcnt(0)
P0_RE:
  v_lshrrev_b32 v10, 3, v1
  v_and_b32 v7, 7, v1
  v_mul_u32_u24 v8, 144, v10
  v_lshl_add_u32 v8, v7, 4, v8
  v_lshlrev_b32 v10, 8, v10
  v_lshl_add_u32 v10, v7, 4, v10
  s_mul_i32 s23, s3, 1152
  s_add_u32 s23, s23, 147456
  v_add_u32 v8, s23, v8
  ds_read_b128 v[232:235], v8
  ds_read_b128 v[236:239], v8 offset:4608
  s_lshr_b32 s22, s2, 1
  s_mul_i32 s22, s22, 14336
  s_and_b32 s23, s2, 1
  s_lshl_b32 s23, s23, 7
  s_add_u32 s22, s22, s23
  s_lshl_b32 s23, s3, 11
  s_add_u32 s22, s22, s23
  s_add_u32 s22, s22, 16056320
  s_cmp_eq_u32 s3, 3
  s_cselect_b32 s23, 0x7fff0000, 0
  s_add_u32 s23, s23, 8192
  v_add_u32 v7, s23, v10
  s_waitcnt lgkmcnt(0)
  buffer_store_dwordx4 v[232:235], v10, s[12:15], s22 offen sc1
  buffer_store_dwordx4 v[236:239], v7, s[12:15], s22 offen sc1
  s_lshl_b32 s22, s2, 2
  s_add_u32 s22, s22, s3
  s_mov_b32 s23, 2147418112
  s_sub_u32 s70, s22, 0
  s_mul_i32 s71, s70, 3072
  s_add_u32 s71, s71, 76656640
  s_cmp_lt_u32 s70, 56
  s_cselect_b32 s23, s71, s23
  s_sub_u32 s70, s22, 56
  s_mul_i32 s71, s70, 3072
  s_add_u32 s71, s71, 78462976
  s_cmp_lt_u32 s70, 56
  s_cselect_b32 s23, s71, s23
  s_sub_u32 s70, s22, 112
  s_mul_i32 s71, s70, 3072
  s_add_u32 s71, s71, 83968000
  s_cmp_lt_u32 s70, 56
  s_cselect_b32 s23, s71, s23
  s_sub_u32 s70, s22, 168
  s_mul_i32 s71, s70, 3072
  s_add_u32 s71, s71, 80297984
  s_cmp_lt_u32 s70, 28
  s_cselect_b32 s23, s71, s23
  s_sub_u32 s70, s22, 196
  s_mul_i32 s71, s70, 3072
  s_add_u32 s71, s71, 82132992
  s_cmp_lt_u32 s70, 28
  s_cselect_b32 s23, s71, s23
  s_sub_u32 s70, s22, 224
  s_mul_i32 s71, s70, 3072
  s_add_u32 s71, s71, 85811200
  s_cmp_lt_u32 s70, 3
  s_cselect_b32 s23, s71, s23
  s_sub_u32 s70, s22, 227
  s_mul_i32 s71, s70, 3072
  s_add_u32 s71, s71, 85843968
  s_cmp_lt_u32 s70, 3
  s_cselect_b32 s23, s71, s23
  s_sub_u32 s70, s22, 230
  s_mul_i32 s71, s70, 3072
  s_add_u32 s71, s71, 85868544
  s_cmp_lt_u32 s70, 11
  s_cselect_b32 s23, s71, s23
  s_sub_u32 s70, s22, 241
  s_mul_i32 s71, s70, 3072
  s_add_u32 s71, s71, 85934080
  s_cmp_lt_u32 s70, 11
  s_cselect_b32 s23, s71, s23
  s_sub_u32 s70, s22, 252
  s_mul_i32 s71, s70, 3072
  s_add_u32 s71, s71, 85999616
  s_cmp_lt_u32 s70, 80
  s_cselect_b32 s23, s71, s23
  s_sub_u32 s70, s22, 332
  s_mul_i32 s71, s70, 3072
  s_add_u32 s71, s71, 88621056
  s_cmp_lt_u32 s70, 80
  s_cselect_b32 s23, s71, s23
  s_sub_u32 s70, s22, 412
  s_mul_i32 s71, s70, 3072
  s_add_u32 s71, s71, 91242496
  s_cmp_lt_u32 s70, 468
  s_cselect_b32 s23, s71, s23
  v_mov_b32 v228, -1
  v_mov_b32 v229, -1
  v_mov_b32 v230, -1
  v_mov_b32 v231, -1
  buffer_store_dwordx4 v[228:231], v4, s[12:15], s23 offen offset:0 sc1
  buffer_store_dwordx4 v[228:231], v4, s[12:15], s23 offen offset:1024 sc1
  buffer_store_dwordx4 v[228:231], v4, s[12:15], s23 offen offset:2048 sc1
  s_waitcnt vmcnt(6)
  s_barrier
  ds_read_b128 v[68:71], v11 offset:0
  ds_read_b128 v[72:75], v11 offset:8192
  s_waitcnt lgkmcnt(0)
  v_mfma_f32_16x16x32_bf16 v[20:23], v[68:71], a[0:3], 0
  ds_read_b128 v[76:79], v11 offset:1024
  v_mfma_f32_16x16x32_bf16 v[44:47], v[72:75], a[0:3], 0
  ds_read_b128 v[80:83], v11 offset:9216
  v_mfma_f32_16x16x32_bf16 v[24:27], v[68:71], a[32:35], 0
  v_mfma_f32_16x16x32_bf16 v[48:51], v[72:75], a[32:35], 0
  v_mfma_f32_16x16x32_bf16 v[28:31], v[68:71], a[64:67], 0
  v_mfma_f32_16x16x32_bf16 v[52:55], v[72:75], a[64:67], 0
  s_add_u32 s74, s56, 1048576
  s_add_u32 s75, s59, 65536
  s_add_u32 s76, s76, 64
  s_and_b32 s76, s76, 0x1ff
  s_lshl4_add_u32 m0, s76, s75
  s_add_u32 s77, s74, s76
  buffer_load_dwordx4 v5, s[24:27], s77 offen  lds
  v_mfma_f32_16x16x32_bf16 v[32:35], v[68:71], a[96:99], 0
  v_mfma_f32_16x16x32_bf16 v[56:59], v[72:75], a[96:99], 0
  v_mfma_f32_16x16x32_bf16 v[36:39], v[68:71], a[128:131], 0
  v_mfma_f32_16x16x32_bf16 v[60:63], v[72:75], a[128:131], 0
  s_add_u32 s76, s76, 64
  s_and_b32 s76, s76, 0x1ff
  s_lshl4_add_u32 m0, s76, s75
  s_add_u32 s77, s74, s76
  buffer_load_dwordx4 v5, s[24:27], s77 offen  lds
  v_mfma_f32_16x16x32_bf16 v[40:43], v[68:71], a[160:163], 0
  v_mfma_f32_16x16x32_bf16 v[64:67], v[72:75], a[160:163], 0
  s_waitcnt lgkmcnt(0)
  v_mfma_f32_16x16x32_bf16 v[20:23], v[76:79], a[4:7], v[20:23]
  ds_read_b128 v[68:71], v11 offset:2048
  v_mfma_f32_16x16x32_bf16 v[44:47], v[80:83], a[4:7], v[44:47]
  ds_read_b128 v[72:75], v11 offset:10240
  v_mfma_f32_16x16x32_bf16 v[24:27], v[76:79], a[36:39], v[24:27]
  v_mfma_f32_16x16x32_bf16 v[48:51], v[80:83], a[36:39], v[48:51]
  v_mfma_f32_16x16x32_bf16 v[28:31], v[76:79], a[68:71], v[28:31]
  v_mfma_f32_16x16x32_bf16 v[52:55], v[80:83], a[68:71], v[52:55]
  s_add_u32 s76, s76, 64
  s_and_b32 s76, s76, 0x1ff
  s_lshl4_add_u32 m0, s76, s75
  s_add_u32 s77, s74, s76
  buffer_load_dwordx4 v5, s[24:27], s77 offen  lds
  v_mfma_f32_16x16x32_bf16 v[32:35], v[76:79], a[100:103], v[32:35]
  v_mfma_f32_16x16x32_bf16 v[56:59], v[80:83], a[100:103], v[56:59]
  v_mfma_f32_16x16x32_bf16 v[36:39], v[76:79], a[132:135], v[36:39]
  v_mfma_f32_16x16x32_bf16 v[60:63], v[80:83], a[132:135], v[60:63]
  s_add_u32 s76, s76, 64
  s_and_b32 s76, s76, 0x1ff
  s_lshl4_add_u32 m0, s76, s75
  s_add_u32 s77, s74, s76
  buffer_load_dwordx4 v5, s[24:27], s77 offen  lds
  v_mfma_f32_16x16x32_bf16 v[40:43], v[76:79], a[164:167], v[40:43]
  v_mfma_f32_16x16x32_bf16 v[64:67], v[80:83], a[164:167], v[64:67]
  s_waitcnt lgkmcnt(0)
  v_mfma_f32_16x16x32_bf16 v[20:23], v[68:71], a[8:11], v[20:23]
  ds_read_b128 v[76:79], v11 offset:3072
  v_mfma_f32_16x16x32_bf16 v[44:47], v[72:75], a[8:11], v[44:47]
  ds_read_b128 v[80:83], v11 offset:11264
  v_mfma_f32_16x16x32_bf16 v[24:27], v[68:71], a[40:43], v[24:27]
  v_mfma_f32_16x16x32_bf16 v[48:51], v[72:75], a[40:43], v[48:51]
  v_mfma_f32_16x16x32_bf16 v[28:31], v[68:71], a[72:75], v[28:31]
  v_mfma_f32_16x16x32_bf16 v[52:55], v[72:75], a[72:75], v[52:55]
  s_add_u32 s76, s76, 64
  s_and_b32 s76, s76, 0x1ff
  s_lshl4_add_u32 m0, s76, s75
  s_add_u32 s77, s74, s76
  buffer_load_dwordx4 v5, s[24:27], s77 offen  lds
  v_mfma_f32_16x16x32_bf16 v[32:35], v[68:71], a[104:107], v[32:35]
  v_mfma_f32_16x16x32_bf16 v[56:59], v[72:75], a[104:107], v[56:59]
  v_mfma_f32_16x16x32_bf16 v[36:39], v[68:71], a[136:139], v[36:39]
  v_mfma_f32_16x16x32_bf16 v[60:63], v[72:75], a[136:139], v[60:63]
  s_add_u32 s76, s76, 64
  s_and_b32 s76, s76, 0x1ff
  s_lshl4_add_u32 m0, s76, s75
  s_add_u32 s77, s74, s76
  buffer_load_dwordx4 v5, s[24:27], s77 offen  lds
  v_mfma_f32_16x16x32_bf16 v[40:43], v[68:71], a[168:171], v[40:43]
  v_mfma_f32_16x16x32_bf16 v[64:67], v[72:75], a[168:171], v[64:67]
  s_waitcnt lgkmcnt(0)
  v_mfma_f32_16x16x32_bf16 v[20:23], v[76:79], a[12:15], v[20:23]
  ds_read_b128 v[68:71], v11 offset:4096
  v_mfma_f32_16x16x32_bf16 v[44:47], v[80:83], a[12:15], v[44:47]
  ds_read_b128 v[72:75], v11 offset:12288
  v_mfma_f32_16x16x32_bf16 v[24:27], v[76:79], a[44:47], v[24:27]
  v_mfma_f32_16x16x32_bf16 v[48:51], v[80:83], a[44:47], v[48:51]
  v_mfma_f32_16x16x32_bf16 v[28:31], v[76:79], a[76:79], v[28:31]
  v_mfma_f32_16x16x32_bf16 v[52:55], v[80:83], a[76:79], v[52:55]
  s_add_u32 s76, s76, 64
  s_and_b32 s76, s76, 0x1ff
  s_lshl4_add_u32 m0, s76, s75
  s_add_u32 s77, s74, s76
  buffer_load_dwordx4 v5, s[24:27], s77 offen  lds
  v_mfma_f32_16x16x32_bf16 v[32:35], v[76:79], a[108:111], v[32:35]
  v_mfma_f32_16x16x32_bf16 v[56:59], v[80:83], a[108:111], v[56:59]
  v_mfma_f32_16x16x32_bf16 v[36:39], v[76:79], a[140:143], v[36:39]
  v_mfma_f32_16x16x32_bf16 v[60:63], v[80:83], a[140:143], v[60:63]
  s_add_u32 s76, s76, 64
  s_and_b32 s76, s76, 0x1ff
  s_lshl4_add_u32 m0, s76, s75
  s_add_u32 s77, s74, s76
  buffer_load_dwordx4 v5, s[24:27], s77 offen  lds
  v_mfma_f32_16x16x32_bf16 v[40:43], v[76:79], a[172:175], v[40:43]
  v_mfma_f32_16x16x32_bf16 v[64:67], v[80:83], a[172:175], v[64:67]
  s_waitcnt lgkmcnt(0)
  v_mfma_f32_16x16x32_bf16 v[20:23], v[68:71], a[16:19], v[20:23]
  ds_read_b128 v[76:79], v11 offset:5120
  v_mfma_f32_16x16x32_bf16 v[44:47], v[72:75], a[16:19], v[44:47]
  ds_read_b128 v[80:83], v11 offset:13312
  v_mfma_f32_16x16x32_bf16 v[24:27], v[68:71], a[48:51], v[24:27]
  v_mfma_f32_16x16x32_bf16 v[48:51], v[72:75], a[48:51], v[48:51]
  v_mfma_f32_16x16x32_bf16 v[28:31], v[68:71], a[80:83], v[28:31]
  v_mfma_f32_16x16x32_bf16 v[52:55], v[72:75], a[80:83], v[52:55]
  s_add_u32 s74, s56, 1179648
  s_add_u32 s75, s59, 73728
  s_add_u32 s76, s76, 64
  s_and_b32 s76, s76, 0x1ff
  s_lshl4_add_u32 m0, s76, s75
  s_add_u32 s77, s74, s76
  buffer_load_dwordx4 v5, s[24:27], s77 offen  lds
  v_mfma_f32_16x16x32_bf16 v[32:35], v[68:71], a[112:115], v[32:35]
  v_mfma_f32_16x16x32_bf16 v[56:59], v[72:75], a[112:115], v[56:59]
  v_mfma_f32_16x16x32_bf16 v[36:39], v[68:71], a[144:147], v[36:39]
  v_mfma_f32_16x16x32_bf16 v[60:63], v[72:75], a[144:147], v[60:63]
  s_add_u32 s76, s76, 64
  s_and_b32 s76, s76, 0x1ff
  s_lshl4_add_u32 m0, s76, s75
  s_add_u32 s77, s74, s76
  buffer_load_dwordx4 v5, s[24:27], s77 offen  lds
  v_mfma_f32_16x16x32_bf16 v[40:43], v[68:71], a[176:179], v[40:43]
  v_mfma_f32_16x16x32_bf16 v[64:67], v[72:75], a[176:179], v[64:67]
  s_waitcnt lgkmcnt(0)
  v_mfma_f32_16x16x32_bf16 v[20:23], v[76:79], a[20:23], v[20:23]
  ds_read_b128 v[68:71], v11 offset:6144
  v_mfma_f32_16x16x32_bf16 v[44:47], v[80:83], a[20:23], v[44:47]
  ds_read_b128 v[72:75], v11 offset:14336
  v_mfma_f32_16x16x32_bf16 v[24:27], v[76:79], a[52:55], v[24:27]
  v_mfma_f32_16x16x32_bf16 v[48:51], v[80:83], a[52:55], v[48:51]
  v_mfma_f32_16x16x32_bf16 v[28:31], v[76:79], a[84:87], v[28:31]
  v_mfma_f32_16x16x32_bf16 v[52:55], v[80:83], a[84:87], v[52:55]
  s_add_u32 s76, s76, 64
  s_and_b32 s76, s76, 0x1ff
  s_lshl4_add_u32 m0, s76, s75
  s_add_u32 s77, s74, s76
  buffer_load_dwordx4 v5, s[24:27], s77 offen  lds
  v_mfma_f32_16x16x32_bf16 v[32:35], v[76:79], a[116:119], v[32:35]
  v_mfma_f32_16x16x32_bf16 v[56:59], v[80:83], a[116:119], v[56:59]
  v_mfma_f32_16x16x32_bf16 v[36:39], v[76:79], a[148:151], v[36:39]
  v_mfma_f32_16x16x32_bf16 v[60:63], v[80:83], a[148:151], v[60:63]
  s_add_u32 s76, s76, 64
  s_and_b32 s76, s76, 0x1ff
  s_lshl4_add_u32 m0, s76, s75
  s_add_u32 s77, s74, s76
  buffer_load_dwordx4 v5, s[24:27], s77 offen  lds
  v_mfma_f32_16x16x32_bf16 v[40:43], v[76:79], a[180:183], v[40:43]
  v_mfma_f32_16x16x32_bf16 v[64:67], v[80:83], a[180:183], v[64:67]
  s_waitcnt lgkmcnt(0)
  v_mfma_f32_16x16x32_bf16 v[20:23], v[68:71], a[24:27], v[20:23]
  ds_read_b128 v[76:79], v11 offset:7168
  v_mfma_f32_16x16x32_bf16 v[44:47], v[72:75], a[24:27], v[44:47]
  ds_read_b128 v[80:83], v11 offset:15360
  v_mfma_f32_16x16x32_bf16 v[24:27], v[68:71], a[56:59], v[24:27]
  v_mfma_f32_16x16x32_bf16 v[48:51], v[72:75], a[56:59], v[48:51]
  v_mfma_f32_16x16x32_bf16 v[28:31], v[68:71], a[88:91], v[28:31]
  v_mfma_f32_16x16x32_bf16 v[52:55], v[72:75], a[88:91], v[52:55]
  s_add_u32 s76, s76, 64
  s_and_b32 s76, s76, 0x1ff
  s_lshl4_add_u32 m0, s76, s75
  s_add_u32 s77, s74, s76
  buffer_load_dwordx4 v5, s[24:27], s77 offen  lds
  v_mfma_f32_16x16x32_bf16 v[32:35], v[68:71], a[120:123], v[32:35]
  v_mfma_f32_16x16x32_bf16 v[56:59], v[72:75], a[120:123], v[56:59]
  v_mfma_f32_16x16x32_bf16 v[36:39], v[68:71], a[152:155], v[36:39]
  v_mfma_f32_16x16x32_bf16 v[60:63], v[72:75], a[152:155], v[60:63]
  s_add_u32 s76, s76, 64
  s_and_b32 s76, s76, 0x1ff
  s_lshl4_add_u32 m0, s76, s75
  s_add_u32 s77, s74, s76
  buffer_load_dwordx4 v5, s[24:27], s77 offen  lds
  v_mfma_f32_16x16x32_bf16 v[40:43], v[68:71], a[184:187], v[40:43]
  v_mfma_f32_16x16x32_bf16 v[64:67], v[72:75], a[184:187], v[64:67]
  s_waitcnt lgkmcnt(0)
  v_mfma_f32_16x16x32_bf16 v[20:23], v[76:79], a[28:31], v[20:23]
  v_mfma_f32_16x16x32_bf16 v[44:47], v[80:83], a[28:31], v[44:47]
  s_add_u32 s76, s76, 64
  s_and_b32 s76, s76, 0x1ff
  s_lshl4_add_u32 m0, s76, s75
  s_add_u32 s77, s74, s76
  buffer_load_dwordx4 v5, s[24:27], s77 offen  lds
  v_mfma_f32_16x16x32_bf16 v[24:27], v[76:79], a[60:63], v[24:27]
  v_mfma_f32_16x16x32_bf16 v[48:51], v[80:83], a[60:63], v[48:51]
  v_mfma_f32_16x16x32_bf16 v[28:31], v[76:79], a[92:95], v[28:31]
  v_mfma_f32_16x16x32_bf16 v[52:55], v[80:83], a[92:95], v[52:55]
  s_add_u32 s76, s76, 64
  s_and_b32 s76, s76, 0x1ff
  s_lshl4_add_u32 m0, s76, s75
  s_add_u32 s77, s74, s76
  buffer_load_dwordx4 v5, s[24:27], s77 offen  lds
  v_mfma_f32_16x16x32_bf16 v[32:35], v[76:79], a[124:127], v[32:35]
  v_mfma_f32_16x16x32_bf16 v[56:59], v[80:83], a[124:127], v[56:59]
  v_mfma_f32_16x16x32_bf16 v[36:39], v[76:79], a[156:159], v[36:39]
  v_mfma_f32_16x16x32_bf16 v[60:63], v[80:83], a[156:159], v[60:63]
  v_mfma_f32_16x16x32_bf16 v[40:43], v[76:79], a[188:191], v[40:43]
  v_mfma_f32_16x16x32_bf16 v[64:67], v[80:83], a[188:191], v[64:67]
  v_pk_mul_f32 v[20:21], v[20:21], s[78:79] op_sel:[0,1] op_sel_hi:[1,1]
  v_pk_mul_f32 v[22:23], v[22:23], s[78:79] op_sel:[0,1] op_sel_hi:[1,1]
  v_cvt_pk_bf16_f32 v84, v20, v21
  v_cvt_pk_bf16_f32 v85, v22, v23
  v_pk_mul_f32 v[44:45], v[44:45], s[78:79] op_sel:[0,1] op_sel_hi:[1,1]
  v_pk_mul_f32 v[46:47], v[46:47], s[78:79] op_sel:[0,1] op_sel_hi:[1,1]
  v_cvt_pk_bf16_f32 v86, v44, v45
  v_cvt_pk_bf16_f32 v87, v46, v47
  v_pk_mul_f32 v[24:25], v[24:25], s[78:79] op_sel:[0,1] op_sel_hi:[1,1]
  v_pk_mul_f32 v[26:27], v[26:27], s[78:79] op_sel:[0,1] op_sel_hi:[1,1]
  v_cvt_pk_bf16_f32 v88, v24, v25
  v_cvt_pk_bf16_f32 v89, v26, v27
  v_pk_mul_f32 v[48:49], v[48:49], s[78:79] op_sel:[0,1] op_sel_hi:[1,1]
  v_pk_mul_f32 v[50:51], v[50:51], s[78:79] op_sel:[0,1] op_sel_hi:[1,1]
  v_cvt_pk_bf16_f32 v90, v48, v49
  v_cvt_pk_bf16_f32 v91, v50, v51
  v_pk_mul_f32 v[28:29], v[28:29], s[78:79] op_sel:[0,1] op_sel_hi:[1,1]
  v_pk_mul_f32 v[30:31], v[30:31], s[78:79] op_sel:[0,1] op_sel_hi:[1,1]
  v_cvt_pk_bf16_f32 v92, v28, v29
  v_cvt_pk_bf16_f32 v93, v30, v31
  v_pk_mul_f32 v[52:53], v[52:53], s[78:79] op_sel:[0,1] op_sel_hi:[1,1]
  v_pk_mul_f32 v[54:55], v[54:55], s[78:79] op_sel:[0,1] op_sel_hi:[1,1]
  v_cvt_pk_bf16_f32 v94, v52, v53
  v_cvt_pk_bf16_f32 v95, v54, v55
  v_pk_mul_f32 v[32:33], v[32:33], s[78:79] op_sel:[0,1] op_sel_hi:[1,1]
  v_pk_mul_f32 v[34:35], v[34:35], s[78:79] op_sel:[0,1] op_sel_hi:[1,1]
  v_cvt_pk_bf16_f32 v96, v32, v33
  v_cvt_pk_bf16_f32 v97, v34, v35
  v_pk_mul_f32 v[56:57], v[56:57], s[78:79] op_sel:[0,1] op_sel_hi:[1,1]
  v_pk_mul_f32 v[58:59], v[58:59], s[78:79] op_sel:[0,1] op_sel_hi:[1,1]
  v_cvt_pk_bf16_f32 v98, v56, v57
  v_cvt_pk_bf16_f32 v99, v58, v59
  v_pk_mul_f32 v[36:37], v[36:37], s[78:79] op_sel:[0,1] op_sel_hi:[1,1]
  v_pk_mul_f32 v[38:39], v[38:39], s[78:79] op_sel:[0,1] op_sel_hi:[1,1]
  v_cvt_pk_bf16_f32 v100, v36, v37
  v_cvt_pk_bf16_f32 v101, v38, v39
  v_pk_mul_f32 v[60:61], v[60:61], s[78:79] op_sel:[0,1] op_sel_hi:[1,1]
  v_pk_mul_f32 v[62:63], v[62:63], s[78:79] op_sel:[0,1] op_sel_hi:[1,1]
  v_cvt_pk_bf16_f32 v102, v60, v61
  v_cvt_pk_bf16_f32 v103, v62, v63
  v_pk_mul_f32 v[40:41], v[40:41], s[78:79] op_sel:[0,1] op_sel_hi:[1,1]
  v_pk_mul_f32 v[42:43], v[42:43], s[78:79] op_sel:[0,1] op_sel_hi:[1,1]
  v_cvt_pk_bf16_f32 v104, v40, v41
  v_cvt_pk_bf16_f32 v105, v42, v43
  v_pk_mul_f32 v[64:65], v[64:65], s[78:79] op_sel:[0,1] op_sel_hi:[1,1]
  v_pk_mul_f32 v[66:67], v[66:67], s[78:79] op_sel:[0,1] op_sel_hi:[1,1]
  v_cvt_pk_bf16_f32 v106, v64, v65
  v_cvt_pk_bf16_f32 v107, v66, v67
  s_waitcnt vmcnt(0)
  ds_read_b128 v[68:71], v108 offset:0
  ds_read_b128 v[72:75], v108 offset:8192
  s_waitcnt lgkmcnt(0)
  v_mfma_f32_16x16x32_bf16 v[20:23], v[68:71], a[0:3], 0
  ds_read_b128 v[76:79], v108 offset:1024
  v_mfma_f32_16x16x32_bf16 v[44:47], v[72:75], a[0:3], 0
  ds_read_b128 v[80:83], v108 offset:9216
  v_mfma_f32_16x16x32_bf16 v[24:27], v[68:71], a[32:35], 0
  v_mfma_f32_16x16x32_bf16 v[48:51], v[72:75], a[32:35], 0
  v_mfma_f32_16x16x32_bf16 v[28:31], v[68:71], a[64:67], 0
  v_mfma_f32_16x16x32_bf16 v[52:55], v[72:75], a[64:67], 0
  buffer_store_dwordx4 v[84:87], v4, s[12:15], s62 offen sc1
  s_add_u32 s62, s62, s68
  v_mfma_f32_16x16x32_bf16 v[32:35], v[68:71], a[96:99], 0
  v_mfma_f32_16x16x32_bf16 v[56:59], v[72:75], a[96:99], 0
  v_mfma_f32_16x16x32_bf16 v[36:39], v[68:71], a[128:131], 0
  v_mfma_f32_16x16x32_bf16 v[60:63], v[72:75], a[128:131], 0
  buffer_store_dwordx4 v[88:91], v4, s[12:15], s63 offen sc1
  s_add_u32 s63, s63, s68
  v_mfma_f32_16x16x32_bf16 v[40:43], v[68:71], a[160:163], 0
  v_mfma_f32_16x16x32_bf16 v[64:67], v[72:75], a[160:163], 0
  s_waitcnt lgkmcnt(0)
  v_mfma_f32_16x16x32_bf16 v[20:23], v[76:79], a[4:7], v[20:23]
  ds_read_b128 v[68:71], v108 offset:2048
  v_mfma_f32_16x16x32_bf16 v[44:47], v[80:83], a[4:7], v[44:47]
  ds_read_b128 v[72:75], v108 offset:10240
  v_mfma_f32_16x16x32_bf16 v[24:27], v[76:79], a[36:39], v[24:27]
  v_mfma_f32_16x16x32_bf16 v[48:51], v[80:83], a[36:39], v[48:51]
  v_mfma_f32_16x16x32_bf16 v[28:31], v[76:79], a[68:71], v[28:31]
  v_mfma_f32_16x16x32_bf16 v[52:55], v[80:83], a[68:71], v[52:55]
  buffer_store_dwordx4 v[92:95], v4, s[12:15], s64 offen sc1
  s_add_u32 s64, s64, s68
  v_mfma_f32_16x16x32_bf16 v[32:35], v[76:79], a[100:103], v[32:35]
  v_mfma_f32_16x16x32_bf16 v[56:59], v[80:83], a[100:103], v[56:59]
  v_mfma_f32_16x16x32_bf16 v[36:39], v[76:79], a[132:135], v[36:39]
  v_mfma_f32_16x16x32_bf16 v[60:63], v[80:83], a[132:135], v[60:63]
  buffer_store_dwordx4 v[96:99], v4, s[12:15], s65 offen sc1
  s_add_u32 s65, s65, s68
  v_mfma_f32_16x16x32_bf16 v[40:43], v[76:79], a[164:167], v[40:43]
  v_mfma_f32_16x16x32_bf16 v[64:67], v[80:83], a[164:167], v[64:67]
  s_waitcnt lgkmcnt(0)
  v_mfma_f32_16x16x32_bf16 v[20:23], v[68:71], a[8:11], v[20:23]
  ds_read_b128 v[76:79], v108 offset:3072
  v_mfma_f32_16x16x32_bf16 v[44:47], v[72:75], a[8:11], v[44:47]
  ds_read_b128 v[80:83], v108 offset:11264
  v_mfma_f32_16x16x32_bf16 v[24:27], v[68:71], a[40:43], v[24:27]
  v_mfma_f32_16x16x32_bf16 v[48:51], v[72:75], a[40:43], v[48:51]
  v_mfma_f32_16x16x32_bf16 v[28:31], v[68:71], a[72:75], v[28:31]
  v_mfma_f32_16x16x32_bf16 v[52:55], v[72:75], a[72:75], v[52:55]
  buffer_store_dwordx4 v[100:103], v4, s[12:15], s66 offen sc1
  s_add_u32 s66, s66, s68
  v_mfma_f32_16x16x32_bf16 v[32:35], v[68:71], a[104:107], v[32:35]
  v_mfma_f32_16x16x32_bf16 v[56:59], v[72:75], a[104:107], v[56:59]
  v_mfma_f32_16x16x32_bf16 v[36:39], v[68:71], a[136:139], v[36:39]
  v_mfma_f32_16x16x32_bf16 v[60:63], v[72:75], a[136:139], v[60:63]
  buffer_store_dwordx4 v[104:107], v4, s[12:15], s67 offen sc1
  s_add_u32 s67, s67, s68
  v_mfma_f32_16x16x32_bf16 v[40:43], v[68:71], a[168:171], v[40:43]
  v_mfma_f32_16x16x32_bf16 v[64:67], v[72:75], a[168:171], v[64:67]
  s_waitcnt lgkmcnt(0)
  v_mfma_f32_16x16x32_bf16 v[20:23], v[76:79], a[12:15], v[20:23]
  ds_read_b128 v[68:71], v108 offset:4096
  v_mfma_f32_16x16x32_bf16 v[44:47], v[80:83], a[12:15], v[44:47]
  ds_read_b128 v[72:75], v108 offset:12288
  v_mfma_f32_16x16x32_bf16 v[24:27], v[76:79], a[44:47], v[24:27]
  v_mfma_f32_16x16x32_bf16 v[48:51], v[80:83], a[44:47], v[48:51]
  v_mfma_f32_16x16x32_bf16 v[28:31], v[76:79], a[76:79], v[28:31]
  v_mfma_f32_16x16x32_bf16 v[52:55], v[80:83], a[76:79], v[52:55]
  s_add_u32 s74, s56, 2097152
  s_add_u32 s75, s59, 0
  s_add_u32 s76, s76, 64
  s_and_b32 s76, s76, 0x1ff
  s_lshl4_add_u32 m0, s76, s75
  s_add_u32 s77, s74, s76
  buffer_load_dwordx4 v5, s[24:27], s77 offen  lds
  v_mfma_f32_16x16x32_bf16 v[32:35], v[76:79], a[108:111], v[32:35]
  v_mfma_f32_16x16x32_bf16 v[56:59], v[80:83], a[108:111], v[56:59]
  v_mfma_f32_16x16x32_bf16 v[36:39], v[76:79], a[140:143], v[36:39]
  v_mfma_f32_16x16x32_bf16 v[60:63], v[80:83], a[140:143], v[60:63]
  s_add_u32 s76, s76, 64
  s_and_b32 s76, s76, 0x1ff
  s_lshl4_add_u32 m0, s76, s75
  s_add_u32 s77, s74, s76
  buffer_load_dwordx4 v5, s[24:27], s77 offen  lds
  v_mfma_f32_16x16x32_bf16 v[40:43], v[76:79], a[172:175], v[40:43]
  v_mfma_f32_16x16x32_bf16 v[64:67], v[80:83], a[172:175], v[64:67]
  s_waitcnt lgkmcnt(0)
  v_mfma_f32_16x16x32_bf16 v[20:23], v[68:71], a[16:19], v[20:23]
  ds_read_b128 v[76:79], v108 offset:5120
  v_mfma_f32_16x16x32_bf16 v[44:47], v[72:75], a[16:19], v[44:47]
  ds_read_b128 v[80:83], v108 offset:13312
  v_mfma_f32_16x16x32_bf16 v[24:27], v[68:71], a[48:51], v[24:27]
  v_mfma_f32_16x16x32_bf16 v[48:51], v[72:75], a[48:51], v[48:51]
  v_mfma_f32_16x16x32_bf16 v[28:31], v[68:71], a[80:83], v[28:31]
  v_mfma_f32_16x16x32_bf16 v[52:55], v[72:75], a[80:83], v[52:55]
  s_add_u32 s76, s76, 64
  s_and_b32 s76, s76, 0x1ff
  s_lshl4_add_u32 m0, s76, s75
  s_add_u32 s77, s74, s76
  buffer_load_dwordx4 v5, s[24:27], s77 offen  lds
  v_mfma_f32_16x16x32_bf16 v[32:35], v[68:71], a[112:115], v[32:35]
  v_mfma_f32_16x16x32_bf16 v[56:59], v[72:75], a[112:115], v[56:59]
  v_mfma_f32_16x16x32_bf16 v[36:39], v[68:71], a[144:147], v[36:39]
  v_mfma_f32_16x16x32_bf16 v[60:63], v[72:75], a[144:147], v[60:63]
  s_add_u32 s76, s76, 64
  s_and_b32 s76, s76, 0x1ff
  s_lshl4_add_u32 m0, s76, s75
  s_add_u32 s77, s74, s76
  buffer_load_dwordx4 v5, s[24:27], s77 offen  lds
  v_mfma_f32_16x16x32_bf16 v[40:43], v[68:71], a[176:179], v[40:43]
  v_mfma_f32_16x16x32_bf16 v[64:67], v[72:75], a[176:179], v[64:67]
  s_waitcnt lgkmcnt(0)
  v_mfma_f32_16x16x32_bf16 v[20:23], v[76:79], a[20:23], v[20:23]
  ds_read_b128 v[68:71], v108 offset:6144
  v_mfma_f32_16x16x32_bf16 v[44:47], v[80:83], a[20:23], v[44:47]
  ds_read_b128 v[72:75], v108 offset:14336
  v_mfma_f32_16x16x32_bf16 v[24:27], v[76:79], a[52:55], v[24:27]
  v_mfma_f32_16x16x32_bf16 v[48:51], v[80:83], a[52:55], v[48:51]
  v_mfma_f32_16x16x32_bf16 v[28:31], v[76:79], a[84:87], v[28:31]
  v_mfma_f32_16x16x32_bf16 v[52:55], v[80:83], a[84:87], v[52:55]
  s_add_u32 s76, s76, 64
  s_and_b32 s76, s76, 0x1ff
  s_lshl4_add_u32 m0, s76, s75
  s_add_u32 s77, s74, s76
  buffer_load_dwordx4 v5, s[24:27], s77 offen  lds
  v_mfma_f32_16x16x32_bf16 v[32:35], v[76:79], a[116:119], v[32:35]
  v_mfma_f32_16x16x32_bf16 v[56:59], v[80:83], a[116:119], v[56:59]
  v_mfma_f32_16x16x32_bf16 v[36:39], v[76:79], a[148:151], v[36:39]
  v_mfma_f32_16x16x32_bf16 v[60:63], v[80:83], a[148:151], v[60:63]
  s_add_u32 s76, s76, 64
  s_and_b32 s76, s76, 0x1ff
  s_lshl4_add_u32 m0, s76, s75
  s_add_u32 s77, s74, s76
  buffer_load_dwordx4 v5, s[24:27], s77 offen  lds
  v_mfma_f32_16x16x32_bf16 v[40:43], v[76:79], a[180:183], v[40:43]
  v_mfma_f32_16x16x32_bf16 v[64:67], v[80:83], a[180:183], v[64:67]
  s_waitcnt lgkmcnt(0)
  v_mfma_f32_16x16x32_bf16 v[20:23], v[68:71], a[24:27], v[20:23]
  ds_read_b128 v[76:79], v108 offset:7168
  v_mfma_f32_16x16x32_bf16 v[44:47], v[72:75], a[24:27], v[44:47]
  ds_read_b128 v[80:83], v108 offset:15360
  v_mfma_f32_16x16x32_bf16 v[24:27], v[68:71], a[56:59], v[24:27]
  v_mfma_f32_16x16x32_bf16 v[48:51], v[72:75], a[56:59], v[48:51]
  v_mfma_f32_16x16x32_bf16 v[28:31], v[68:71], a[88:91], v[28:31]
  v_mfma_f32_16x16x32_bf16 v[52:55], v[72:75], a[88:91], v[52:55]
  s_add_u32 s76, s76, 64
  s_and_b32 s76, s76, 0x1ff
  s_lshl4_add_u32 m0, s76, s75
  s_add_u32 s77, s74, s76
  buffer_load_dwordx4 v5, s[24:27], s77 offen  lds
  v_mfma_f32_16x16x32_bf16 v[32:35], v[68:71], a[120:123], v[32:35]
  v_mfma_f32_16x16x32_bf16 v[56:59], v[72:75], a[120:123], v[56:59]
  v_mfma_f32_16x16x32_bf16 v[36:39], v[68:71], a[152:155], v[36:39]
  v_mfma_f32_16x16x32_bf16 v[60:63], v[72:75], a[152:155], v[60:63]
  s_add_u32 s76, s76, 64
  s_and_b32 s76, s76, 0x1ff
  s_lshl4_add_u32 m0, s76, s75
  s_add_u32 s77, s74, s76
  buffer_load_dwordx4 v5, s[24:27], s77 offen  lds
  v_mfma_f32_16x16x32_bf16 v[40:43], v[68:71], a[184:187], v[40:43]
  v_mfma_f32_16x16x32_bf16 v[64:67], v[72:75], a[184:187], v[64:67]
  s_waitcnt lgkmcnt(0)
  v_mfma_f32_16x16x32_bf16 v[20:23], v[76:79], a[28:31], v[20:23]
  v_mfma_f32_16x16x32_bf16 v[44:47], v[80:83], a[28:31], v[44:47]
  s_add_u32 s74, s56, 2228224
  s_add_u32 s75, s59, 8192
  s_add_u32 s76, s76, 64
  s_and_b32 s76, s76, 0x1ff
  s_lshl4_add_u32 m0, s76, s75
  s_add_u32 s77, s74, s76
  buffer_load_dwordx4 v5, s[24:27], s77 offen  lds
  v_mfma_f32_16x16x32_bf16 v[24:27], v[76:79], a[60:63], v[24:27]
  v_mfma_f32_16x16x32_bf16 v[48:51], v[80:83], a[60:63], v[48:51]
  v_mfma_f32_16x16x32_bf16 v[28:31], v[76:79], a[92:95], v[28:31]
  v_mfma_f32_16x16x32_bf16 v[52:55], v[80:83], a[92:95], v[52:55]
  s_add_u32 s76, s76, 64
  s_and_b32 s76, s76, 0x1ff
  s_lshl4_add_u32 m0, s76, s75
  s_add_u32 s77, s74, s76
  buffer_load_dwordx4 v5, s[24:27], s77 offen  lds
  v_mfma_f32_16x16x32_bf16 v[32:35], v[76:79], a[124:127], v[32:35]
  v_mfma_f32_16x16x32_bf16 v[56:59], v[80:83], a[124:127], v[56:59]
  v_mfma_f32_16x16x32_bf16 v[36:39], v[76:79], a[156:159], v[36:39]
  v_mfma_f32_16x16x32_bf16 v[60:63], v[80:83], a[156:159], v[60:63]
  s_add_u32 s76, s76, 64
  s_and_b32 s76, s76, 0x1ff
  s_lshl4_add_u32 m0, s76, s75
  s_add_u32 s77, s74, s76
  buffer_load_dwordx4 v5, s[24:27], s77 offen  lds
  v_mfma_f32_16x16x32_bf16 v[40:43], v[76:79], a[188:191], v[40:43]
  v_mfma_f32_16x16x32_bf16 v[64:67], v[80:83], a[188:191], v[64:67]
  s_add_u32 s76, s76, 64
  s_and_b32 s76, s76, 0x1ff
  s_lshl4_add_u32 m0, s76, s75
  s_add_u32 s77, s74, s76
  buffer_load_dwordx4 v5, s[24:27], s77 offen  lds
  s_add_u32 s76, s76, 64
  s_and_b32 s76, s76, 0x1ff
  s_lshl4_add_u32 m0, s76, s75
  s_add_u32 s77, s74, s76
  buffer_load_dwordx4 v5, s[24:27], s77 offen  lds
  s_add_u32 s76, s76, 64
  s_and_b32 s76, s76, 0x1ff
  s_lshl4_add_u32 m0, s76, s75
  s_add_u32 s77, s74, s76
  buffer_load_dwordx4 v5, s[24:27], s77 offen  lds
  s_add_u32 s76, s76, 64
  s_and_b32 s76, s76, 0x1ff
  s_lshl4_add_u32 m0, s76, s75
  s_add_u32 s77, s74, s76
  buffer_load_dwordx4 v5, s[24:27], s77 offen  lds
  s_add_u32 s76, s76, 64
  s_and_b32 s76, s76, 0x1ff
  s_lshl4_add_u32 m0, s76, s75
  s_add_u32 s77, s74, s76
  buffer_load_dwordx4 v5, s[24:27], s77 offen  lds
  v_pk_mul_f32 v[20:21], v[20:21], s[78:79] op_sel:[0,1] op_sel_hi:[1,1]
  v_pk_mul_f32 v[22:23], v[22:23], s[78:79] op_sel:[0,1] op_sel_hi:[1,1]
  v_cvt_pk_bf16_f32 v84, v20, v21
  v_cvt_pk_bf16_f32 v85, v22, v23
  v_pk_mul_f32 v[44:45], v[44:45], s[78:79] op_sel:[0,1] op_sel_hi:[1,1]
  v_pk_mul_f32 v[46:47], v[46:47], s[78:79] op_sel:[0,1] op_sel_hi:[1,1]
  v_cvt_pk_bf16_f32 v86, v44, v45
  v_cvt_pk_bf16_f32 v87, v46, v47
  v_pk_mul_f32 v[24:25], v[24:25], s[78:79] op_sel:[0,1] op_sel_hi:[1,1]
  v_pk_mul_f32 v[26:27], v[26:27], s[78:79] op_sel:[0,1] op_sel_hi:[1,1]
  v_cvt_pk_bf16_f32 v88, v24, v25
  v_cvt_pk_bf16_f32 v89, v26, v27
  v_pk_mul_f32 v[48:49], v[48:49], s[78:79] op_sel:[0,1] op_sel_hi:[1,1]
  v_pk_mul_f32 v[50:51], v[50:51], s[78:79] op_sel:[0,1] op_sel_hi:[1,1]
  v_cvt_pk_bf16_f32 v90, v48, v49
  v_cvt_pk_bf16_f32 v91, v50, v51
  v_pk_mul_f32 v[28:29], v[28:29], s[78:79] op_sel:[0,1] op_sel_hi:[1,1]
  v_pk_mul_f32 v[30:31], v[30:31], s[78:79] op_sel:[0,1] op_sel_hi:[1,1]
  v_cvt_pk_bf16_f32 v92, v28, v29
  v_cvt_pk_bf16_f32 v93, v30, v31
  v_pk_mul_f32 v[52:53], v[52:53], s[78:79] op_sel:[0,1] op_sel_hi:[1,1]
  v_pk_mul_f32 v[54:55], v[54:55], s[78:79] op_sel:[0,1] op_sel_hi:[1,1]
  v_cvt_pk_bf16_f32 v94, v52, v53
  v_cvt_pk_bf16_f32 v95, v54, v55
  v_pk_mul_f32 v[32:33], v[32:33], s[78:79] op_sel:[0,1] op_sel_hi:[1,1]
  v_pk_mul_f32 v[34:35], v[34:35], s[78:79] op_sel:[0,1] op_sel_hi:[1,1]
  v_cvt_pk_bf16_f32 v96, v32, v33
  v_cvt_pk_bf16_f32 v97, v34, v35
  v_pk_mul_f32 v[56:57], v[56:57], s[78:79] op_sel:[0,1] op_sel_hi:[1,1]
  v_pk_mul_f32 v[58:59], v[58:59], s[78:79] op_sel:[0,1] op_sel_hi:[1,1]
  v_cvt_pk_bf16_f32 v98, v56, v57
  v_cvt_pk_bf16_f32 v99, v58, v59
  v_pk_mul_f32 v[36:37], v[36:37], s[78:79] op_sel:[0,1] op_sel_hi:[1,1]
  v_pk_mul_f32 v[38:39], v[38:39], s[78:79] op_sel:[0,1] op_sel_hi:[1,1]
  v_cvt_pk_bf16_f32 v100, v36, v37
  v_cvt_pk_bf16_f32 v101, v38, v39
  v_pk_mul_f32 v[60:61], v[60:61], s[78:79] op_sel:[0,1] op_sel_hi:[1,1]
  v_pk_mul_f32 v[62:63], v[62:63], s[78:79] op_sel:[0,1] op_sel_hi:[1,1]
  v_cvt_pk_bf16_f32 v102, v60, v61
  v_cvt_pk_bf16_f32 v103, v62, v63
  v_pk_mul_f32 v[40:41], v[40:41], s[78:79] op_sel:[0,1] op_sel_hi:[1,1]
  v_pk_mul_f32 v[42:43], v[42:43], s[78:79] op_sel:[0,1] op_sel_hi:[1,1]
  v_cvt_pk_bf16_f32 v104, v40, v41
  v_cvt_pk_bf16_f32 v105, v42, v43
  v_pk_mul_f32 v[64:65], v[64:65], s[78:79] op_sel:[0,1] op_sel_hi:[1,1]
  v_pk_mul_f32 v[66:67], v[66:67], s[78:79] op_sel:[0,1] op_sel_hi:[1,1]
  v_cvt_pk_bf16_f32 v106, v64, v65
  v_cvt_pk_bf16_f32 v107, v66, v67
  s_waitcnt vmcnt(0)
  s_barrier
  s_add_u32 s70, s90, 1
  v_mov_b32 v10, s70
  s_cmp_eq_u32 s3, 0
  s_cselect_b32 s70, s69, 2147418112
  buffer_store_dword v10, off, s[12:15], s70 sc1
  ds_read_b128 v[68:71], v11 offset:0
  ds_read_b128 v[72:75], v11 offset:8192
  s_waitcnt lgkmcnt(0)
  v_mfma_f32_16x16x32_bf16 v[20:23], v[68:71], a[0:3], 0
  ds_read_b128 v[76:79], v11 offset:1024
  v_mfma_f32_16x16x32_bf16 v[44:47], v[72:75], a[0:3], 0
  ds_read_b128 v[80:83], v11 offset:9216
  v_mfma_f32_16x16x32_bf16 v[24:27], v[68:71], a[32:35], 0
  v_mfma_f32_16x16x32_bf16 v[48:51], v[72:75], a[32:35], 0
  v_mfma_f32_16x16x32_bf16 v[28:31], v[68:71], a[64:67], 0
  v_mfma_f32_16x16x32_bf16 v[52:55], v[72:75], a[64:67], 0
  buffer_store_dwordx4 v[84:87], v4, s[12:15], s62 offen sc1
  s_add_u32 s62, s62, s68
  v_mfma_f32_16x16x32_bf16 v[32:35], v[68:71], a[96:99], 0
  v_mfma_f32_16x16x32_bf16 v[56:59], v[72:75], a[96:99], 0
  v_mfma_f32_16x16x32_bf16 v[36:39], v[68:71], a[128:131], 0
  v_mfma_f32_16x16x32_bf16 v[60:63], v[72:75], a[128:131], 0
  buffer_store_dwordx4 v[88:91], v4, s[12:15], s63 offen sc1
  s_add_u32 s63, s63, s68
  v_mfma_f32_16x16x32_bf16 v[40:43], v[68:71], a[160:163], 0
  v_mfma_f32_16x16x32_bf16 v[64:67], v[72:75], a[160:163], 0
  s_waitcnt lgkmcnt(0)
  v_mfma_f32_16x16x32_bf16 v[20:23], v[76:79], a[4:7], v[20:23]
  ds_read_b128 v[68:71], v11 offset:2048
  v_mfma_f32_16x16x32_bf16 v[44:47], v[80:83], a[4:7], v[44:47]
  ds_read_b128 v[72:75], v11 offset:10240
  v_mfma_f32_16x16x32_bf16 v[24:27], v[76:79], a[36:39], v[24:27]
  v_mfma_f32_16x16x32_bf16 v[48:51], v[80:83], a[36:39], v[48:51]
  v_mfma_f32_16x16x32_bf16 v[28:31], v[76:79], a[68:71], v[28:31]
  v_mfma_f32_16x16x32_bf16 v[52:55], v[80:83], a[68:71], v[52:55]
  buffer_store_dwordx4 v[92:95], v4, s[12:15], s64 offen sc1
  s_add_u32 s64, s64, s68
  v_mfma_f32_16x16x32_bf16 v[32:35], v[76:79], a[100:103], v[32:35]
  v_mfma_f32_16x16x32_bf16 v[56:59], v[80:83], a[100:103], v[56:59]
  v_mfma_f32_16x16x32_bf16 v[36:39], v[76:79], a[132:135], v[36:39]
  v_mfma_f32_16x16x32_bf16 v[60:63], v[80:83], a[132:135], v[60:63]
  buffer_store_dwordx4 v[96:99], v4, s[12:15], s65 offen sc1
  s_add_u32 s65, s65, s68
  v_mfma_f32_16x16x32_bf16 v[40:43], v[76:79], a[164:167], v[40:43]
  v_mfma_f32_16x16x32_bf16 v[64:67], v[80:83], a[164:167], v[64:67]
  s_waitcnt lgkmcnt(0)
  v_mfma_f32_16x16x32_bf16 v[20:23], v[68:71], a[8:11], v[20:23]
  ds_read_b128 v[76:79], v11 offset:3072
  v_mfma_f32_16x16x32_bf16 v[44:47], v[72:75], a[8:11], v[44:47]
  ds_read_b128 v[80:83], v11 offset:11264
  v_mfma_f32_16x16x32_bf16 v[24:27], v[68:71], a[40:43], v[24:27]
  v_mfma_f32_16x16x32_bf16 v[48:51], v[72:75], a[40:43], v[48:51]
  v_mfma_f32_16x16x32_bf16 v[28:31], v[68:71], a[72:75], v[28:31]
  v_mfma_f32_16x16x32_bf16 v[52:55], v[72:75], a[72:75], v[52:55]
  buffer_store_dwordx4 v[100:103], v4, s[12:15], s66 offen sc1
  s_add_u32 s66, s66, s68
  v_mfma_f32_16x16x32_bf16 v[32:35], v[68:71], a[104:107], v[32:35]
  v_mfma_f32_16x16x32_bf16 v[56:59], v[72:75], a[104:107], v[56:59]
  v_mfma_f32_16x16x32_bf16 v[36:39], v[68:71], a[136:139], v[36:39]
  v_mfma_f32_16x16x32_bf16 v[60:63], v[72:75], a[136:139], v[60:63]
  buffer_store_dwordx4 v[104:107], v4, s[12:15], s67 offen sc1
  s_add_u32 s67, s67, s68
  v_mfma_f32_16x16x32_bf16 v[40:43], v[68:71], a[168:171], v[40:43]
  v_mfma_f32_16x16x32_bf16 v[64:67], v[72:75], a[168:171], v[64:67]
  s_waitcnt lgkmcnt(0)
  v_mfma_f32_16x16x32_bf16 v[20:23], v[76:79], a[12:15], v[20:23]
  ds_read_b128 v[68:71], v11 offset:4096
  v_mfma_f32_16x16x32_bf16 v[44:47], v[80:83], a[12:15], v[44:47]
  ds_read_b128 v[72:75], v11 offset:12288
  v_mfma_f32_16x16x32_bf16 v[24:27], v[76:79], a[44:47], v[24:27]
  v_mfma_f32_16x16x32_bf16 v[48:51], v[80:83], a[44:47], v[48:51]
  v_mfma_f32_16x16x32_bf16 v[28:31], v[76:79], a[76:79], v[28:31]
  v_mfma_f32_16x16x32_bf16 v[52:55], v[80:83], a[76:79], v[52:55]
  s_add_u32 s74, s56, 3145728
  s_add_u32 s75, s59, 65536
  s_add_u32 s76, s76, 64
  s_and_b32 s76, s76, 0x1ff
  s_lshl4_add_u32 m0, s76, s75
  s_add_u32 s77, s74, s76
  buffer_load_dwordx4 v5, s[24:27], s77 offen  lds
  v_mfma_f32_16x16x32_bf16 v[32:35], v[76:79], a[108:111], v[32:35]
  v_mfma_f32_16x16x32_bf16 v[56:59], v[80:83], a[108:111], v[56:59]
  v_mfma_f32_16x16x32_bf16 v[36:39], v[76:79], a[140:143], v[36:39]
  v_mfma_f32_16x16x32_bf16 v[60:63], v[80:83], a[140:143], v[60:63]
  s_add_u32 s76, s76, 64
  s_and_b32 s76, s76, 0x1ff
  s_lshl4_add_u32 m0, s76, s75
  s_add_u32 s77, s74, s76
  buffer_load_dwordx4 v5, s[24:27], s77 offen  lds
  v_mfma_f32_16x16x32_bf16 v[40:43], v[76:79], a[172:175], v[40:43]
  v_mfma_f32_16x16x32_bf16 v[64:67], v[80:83], a[172:175], v[64:67]
  s_waitcnt lgkmcnt(0)
  v_mfma_f32_16x16x32_bf16 v[20:23], v[68:71], a[16:19], v[20:23]
  ds_read_b128 v[76:79], v11 offset:5120
  v_mfma_f32_16x16x32_bf16 v[44:47], v[72:75], a[16:19], v[44:47]
  ds_read_b128 v[80:83], v11 offset:13312
  v_mfma_f32_16x16x32_bf16 v[24:27], v[68:71], a[48:51], v[24:27]
  v_mfma_f32_16x16x32_bf16 v[48:51], v[72:75], a[48:51], v[48:51]
  v_mfma_f32_16x16x32_bf16 v[28:31], v[68:71], a[80:83], v[28:31]
  v_mfma_f32_16x16x32_bf16 v[52:55], v[72:75], a[80:83], v[52:55]
  s_add_u32 s76, s76, 64
  s_and_b32 s76, s76, 0x1ff
  s_lshl4_add_u32 m0, s76, s75
  s_add_u32 s77, s74, s76
  buffer_load_dwordx4 v5, s[24:27], s77 offen  lds
  v_mfma_f32_16x16x32_bf16 v[32:35], v[68:71], a[112:115], v[32:35]
  v_mfma_f32_16x16x32_bf16 v[56:59], v[72:75], a[112:115], v[56:59]
  v_mfma_f32_16x16x32_bf16 v[36:39], v[68:71], a[144:147], v[36:39]
  v_mfma_f32_16x16x32_bf16 v[60:63], v[72:75], a[144:147], v[60:63]
  s_add_u32 s76, s76, 64
  s_and_b32 s76, s76, 0x1ff
  s_lshl4_add_u32 m0, s76, s75
  s_add_u32 s77, s74, s76
  buffer_load_dwordx4 v5, s[24:27], s77 offen  lds
  v_mfma_f32_16x16x32_bf16 v[40:43], v[68:71], a[176:179], v[40:43]
  v_mfma_f32_16x16x32_bf16 v[64:67], v[72:75], a[176:179], v[64:67]
  s_waitcnt lgkmcnt(0)
  v_mfma_f32_16x16x32_bf16 v[20:23], v[76:79], a[20:23], v[20:23]
  ds_read_b128 v[68:71], v11 offset:6144
  v_mfma_f32_16x16x32_bf16 v[44:47], v[80:83], a[20:23], v[44:47]
  ds_read_b128 v[72:75], v11 offset:14336
  v_mfma_f32_16x16x32_bf16 v[24:27], v[76:79], a[52:55], v[24:27]
  v_mfma_f32_16x16x32_bf16 v[48:51], v[80:83], a[52:55], v[48:51]
  v_mfma_f32_16x16x32_bf16 v[28:31], v[76:79], a[84:87], v[28:31]
  v_mfma_f32_16x16x32_bf16 v[52:55], v[80:83], a[84:87], v[52:55]
  s_add_u32 s76, s76, 64
  s_and_b32 s76, s76, 0x1ff
  s_lshl4_add_u32 m0, s76, s75
  s_add_u32 s77, s74, s76
  buffer_load_dwordx4 v5, s[24:27], s77 offen  lds
  v_mfma_f32_16x16x32_bf16 v[32:35], v[76:79], a[116:119], v[32:35]
  v_mfma_f32_16x16x32_bf16 v[56:59], v[80:83], a[116:119], v[56:59]
  v_mfma_f32_16x16x32_bf16 v[36:39], v[76:79], a[148:151], v[36:39]
  v_mfma_f32_16x16x32_bf16 v[60:63], v[80:83], a[148:151], v[60:63]
  s_add_u32 s76, s76, 64
  s_and_b32 s76, s76, 0x1ff
  s_lshl4_add_u32 m0, s76, s75
  s_add_u32 s77, s74, s76
  buffer_load_dwordx4 v5, s[24:27], s77 offen  lds
  v_mfma_f32_16x16x32_bf16 v[40:43], v[76:79], a[180:183], v[40:43]
  v_mfma_f32_16x16x32_bf16 v[64:67], v[80:83], a[180:183], v[64:67]
  s_waitcnt lgkmcnt(0)
  v_mfma_f32_16x16x32_bf16 v[20:23], v[68:71], a[24:27], v[20:23]
  ds_read_b128 v[76:79], v11 offset:7168
  v_mfma_f32_16x16x32_bf16 v[44:47], v[72:75], a[24:27], v[44:47]
  ds_read_b128 v[80:83], v11 offset:15360
  v_mfma_f32_16x16x32_bf16 v[24:27], v[68:71], a[56:59], v[24:27]
  v_mfma_f32_16x16x32_bf16 v[48:51], v[72:75], a[56:59], v[48:51]
  v_mfma_f32_16x16x32_bf16 v[28:31], v[68:71], a[88:91], v[28:31]
  v_mfma_f32_16x16x32_bf16 v[52:55], v[72:75], a[88:91], v[52:55]
  s_add_u32 s76, s76, 64
  s_and_b32 s76, s76, 0x1ff
  s_lshl4_add_u32 m0, s76, s75
  s_add_u32 s77, s74, s76
  buffer_load_dwordx4 v5, s[24:27], s77 offen  lds
  v_mfma_f32_16x16x32_bf16 v[32:35], v[68:71], a[120:123], v[32:35]
  v_mfma_f32_16x16x32_bf16 v[56:59], v[72:75], a[120:123], v[56:59]
  v_mfma_f32_16x16x32_bf16 v[36:39], v[68:71], a[152:155], v[36:39]
  v_mfma_f32_16x16x32_bf16 v[60:63], v[72:75], a[152:155], v[60:63]
  s_add_u32 s76, s76, 64
  s_and_b32 s76, s76, 0x1ff
  s_lshl4_add_u32 m0, s76, s75
  s_add_u32 s77, s74, s76
  buffer_load_dwordx4 v5, s[24:27], s77 offen  lds
  v_mfma_f32_16x16x32_bf16 v[40:43], v[68:71], a[184:187], v[40:43]
  v_mfma_f32_16x16x32_bf16 v[64:67], v[72:75], a[184:187], v[64:67]
  s_waitcnt lgkmcnt(0)
  v_mfma_f32_16x16x32_bf16 v[20:23], v[76:79], a[28:31], v[20:23]
  v_mfma_f32_16x16x32_bf16 v[44:47], v[80:83], a[28:31], v[44:47]
  s_add_u32 s74, s56, 3276800
  s_add_u32 s75, s59, 73728
  s_add_u32 s76, s76, 64
  s_and_b32 s76, s76, 0x1ff
  s_lshl4_add_u32 m0, s76, s75
  s_add_u32 s77, s74, s76
  buffer_load_dwordx4 v5, s[24:27], s77 offen  lds
  v_mfma_f32_16x16x32_bf16 v[24:27], v[76:79], a[60:63], v[24:27]
  v_mfma_f32_16x16x32_bf16 v[48:51], v[80:83], a[60:63], v[48:51]
  v_mfma_f32_16x16x32_bf16 v[28:31], v[76:79], a[92:95], v[28:31]
  v_mfma_f32_16x16x32_bf16 v[52:55], v[80:83], a[92:95], v[52:55]
  s_add_u32 s76, s76, 64
  s_and_b32 s76, s76, 0x1ff
  s_lshl4_add_u32 m0, s76, s75
  s_add_u32 s77, s74, s76
  buffer_load_dwordx4 v5, s[24:27], s77 offen  lds
  v_mfma_f32_16x16x32_bf16 v[32:35], v[76:79], a[124:127], v[32:35]
  v_mfma_f32_16x16x32_bf16 v[56:59], v[80:83], a[124:127], v[56:59]
  v_mfma_f32_16x16x32_bf16 v[36:39], v[76:79], a[156:159], v[36:39]
  v_mfma_f32_16x16x32_bf16 v[60:63], v[80:83], a[156:159], v[60:63]
  s_add_u32 s76, s76, 64
  s_and_b32 s76, s76, 0x1ff
  s_lshl4_add_u32 m0, s76, s75
  s_add_u32 s77, s74, s76
  buffer_load_dwordx4 v5, s[24:27], s77 offen  lds
  v_mfma_f32_16x16x32_bf16 v[40:43], v[76:79], a[188:191], v[40:43]
  v_mfma_f32_16x16x32_bf16 v[64:67], v[80:83], a[188:191], v[64:67]
  s_add_u32 s76, s76, 64
  s_and_b32 s76, s76, 0x1ff
  s_lshl4_add_u32 m0, s76, s75
  s_add_u32 s77, s74, s76
  buffer_load_dwordx4 v5, s[24:27], s77 offen  lds
  s_add_u32 s76, s76, 64
  s_and_b32 s76, s76, 0x1ff
  s_lshl4_add_u32 m0, s76, s75
  s_add_u32 s77, s74, s76
  buffer_load_dwordx4 v5, s[24:27], s77 offen  lds
  s_add_u32 s76, s76, 64
  s_and_b32 s76, s76, 0x1ff
  s_lshl4_add_u32 m0, s76, s75
  s_add_u32 s77, s74, s76
  buffer_load_dwordx4 v5, s[24:27], s77 offen  lds
  s_add_u32 s76, s76, 64
  s_and_b32 s76, s76, 0x1ff
  s_lshl4_add_u32 m0, s76, s75
  s_add_u32 s77, s74, s76
  buffer_load_dwordx4 v5, s[24:27], s77 offen  lds
  s_add_u32 s76, s76, 64
  s_and_b32 s76, s76, 0x1ff
  s_lshl4_add_u32 m0, s76, s75
  s_add_u32 s77, s74, s76
  buffer_load_dwordx4 v5, s[24:27], s77 offen  lds
  v_pk_mul_f32 v[20:21], v[20:21], s[78:79] op_sel:[0,1] op_sel_hi:[1,1]
  v_pk_mul_f32 v[22:23], v[22:23], s[78:79] op_sel:[0,1] op_sel_hi:[1,1]
  v_cvt_pk_bf16_f32 v84, v20, v21
  v_cvt_pk_bf16_f32 v85, v22, v23
  v_pk_mul_f32 v[44:45], v[44:45], s[78:79] op_sel:[0,1] op_sel_hi:[1,1]
  v_pk_mul_f32 v[46:47], v[46:47], s[78:79] op_sel:[0,1] op_sel_hi:[1,1]
  v_cvt_pk_bf16_f32 v86, v44, v45
  v_cvt_pk_bf16_f32 v87, v46, v47
  v_pk_mul_f32 v[24:25], v[24:25], s[78:79] op_sel:[0,1] op_sel_hi:[1,1]
  v_pk_mul_f32 v[26:27], v[26:27], s[78:79] op_sel:[0,1] op_sel_hi:[1,1]
  v_cvt_pk_bf16_f32 v88, v24, v25
  v_cvt_pk_bf16_f32 v89, v26, v27
  v_pk_mul_f32 v[48:49], v[48:49], s[78:79] op_sel:[0,1] op_sel_hi:[1,1]
  v_pk_mul_f32 v[50:51], v[50:51], s[78:79] op_sel:[0,1] op_sel_hi:[1,1]
  v_cvt_pk_bf16_f32 v90, v48, v49
  v_cvt_pk_bf16_f32 v91, v50, v51
  v_pk_mul_f32 v[28:29], v[28:29], s[78:79] op_sel:[0,1] op_sel_hi:[1,1]
  v_pk_mul_f32 v[30:31], v[30:31], s[78:79] op_sel:[0,1] op_sel_hi:[1,1]
  v_cvt_pk_bf16_f32 v92, v28, v29
  v_cvt_pk_bf16_f32 v93, v30, v31
  v_pk_mul_f32 v[52:53], v[52:53], s[78:79] op_sel:[0,1] op_sel_hi:[1,1]
  v_pk_mul_f32 v[54:55], v[54:55], s[78:79] op_sel:[0,1] op_sel_hi:[1,1]
  v_cvt_pk_bf16_f32 v94, v52, v53
  v_cvt_pk_bf16_f32 v95, v54, v55
  v_pk_mul_f32 v[32:33], v[32:33], s[78:79] op_sel:[0,1] op_sel_hi:[1,1]
  v_pk_mul_f32 v[34:35], v[34:35], s[78:79] op_sel:[0,1] op_sel_hi:[1,1]
  v_cvt_pk_bf16_f32 v96, v32, v33
  v_cvt_pk_bf16_f32 v97, v34, v35
  v_pk_mul_f32 v[56:57], v[56:57], s[78:79] op_sel:[0,1] op_sel_hi:[1,1]
  v_pk_mul_f32 v[58:59], v[58:59], s[78:79] op_sel:[0,1] op_sel_hi:[1,1]
  v_cvt_pk_bf16_f32 v98, v56, v57
  v_cvt_pk_bf16_f32 v99, v58, v59
  v_pk_mul_f32 v[36:37], v[36:37], s[78:79] op_sel:[0,1] op_sel_hi:[1,1]
  v_pk_mul_f32 v[38:39], v[38:39], s[78:79] op_sel:[0,1] op_sel_hi:[1,1]
  v_cvt_pk_bf16_f32 v100, v36, v37
  v_cvt_pk_bf16_f32 v101, v38, v39
  v_pk_mul_f32 v[60:61], v[60:61], s[78:79] op_sel:[0,1] op_sel_hi:[1,1]
  v_pk_mul_f32 v[62:63], v[62:63], s[78:79] op_sel:[0,1] op_sel_hi:[1,1]
  v_cvt_pk_bf16_f32 v102, v60, v61
  v_cvt_pk_bf16_f32 v103, v62, v63
  v_pk_mul_f32 v[40:41], v[40:41], s[78:79] op_sel:[0,1] op_sel_hi:[1,1]
  v_pk_mul_f32 v[42:43], v[42:43], s[78:79] op_sel:[0,1] op_sel_hi:[1,1]
  v_cvt_pk_bf16_f32 v104, v40, v41
  v_cvt_pk_bf16_f32 v105, v42, v43
  v_pk_mul_f32 v[64:65], v[64:65], s[78:79] op_sel:[0,1] op_sel_hi:[1,1]
  v_pk_mul_f32 v[66:67], v[66:67], s[78:79] op_sel:[0,1] op_sel_hi:[1,1]
  v_cvt_pk_bf16_f32 v106, v64, v65
  v_cvt_pk_bf16_f32 v107, v66, v67
  s_waitcnt vmcnt(0)
  s_barrier
  s_add_u32 s70, s90, 2
  v_mov_b32 v10, s70
  s_cmp_eq_u32 s3, 0
  s_cselect_b32 s70, s69, 2147418112
  buffer_store_dword v10, off, s[12:15], s70 sc1
  s_cmp_lt_u32 s3, 2
  s_cbranch_scc1 P0_K
  buffer_store_dwordx4 v[84:87], v4, s[12:15], s62 offen sc1
  s_add_u32 s62, s62, s68
  buffer_store_dwordx4 v[88:91], v4, s[12:15], s63 offen sc1
  s_add_u32 s63, s63, s68
  buffer_store_dwordx4 v[92:95], v4, s[12:15], s64 offen sc1
  s_add_u32 s64, s64, s68
  buffer_store_dwordx4 v[96:99], v4, s[12:15], s65 offen sc1
  s_add_u32 s65, s65, s68
  buffer_store_dwordx4 v[100:103], v4, s[12:15], s66 offen sc1
  s_add_u32 s66, s66, s68
  buffer_store_dwordx4 v[104:107], v4, s[12:15], s67 offen sc1
  s_add_u32 s67, s67, s68
  s_branch P0_L
P0_K:
  ds_read_b128 v[68:71], v108 offset:0
  ds_read_b128 v[72:75], v108 offset:8192
  s_waitcnt lgkmcnt(0)
  v_mfma_f32_16x16x32_bf16 v[20:23], v[68:71], a[0:3], 0
  ds_read_b128 v[76:79], v108 offset:1024
  v_mfma_f32_16x16x32_bf16 v[44:47], v[72:75], a[0:3], 0
  ds_read_b128 v[80:83], v108 offset:9216
  v_mfma_f32_16x16x32_bf16 v[24:27], v[68:71], a[32:35], 0
  v_mfma_f32_16x16x32_bf16 v[48:51], v[72:75], a[32:35], 0
  v_mfma_f32_16x16x32_bf16 v[28:31], v[68:71], a[64:67], 0
  v_mfma_f32_16x16x32_bf16 v[52:55], v[72:75], a[64:67], 0
  buffer_store_dwordx4 v[84:87], v4, s[12:15], s62 offen sc1
  s_add_u32 s62, s62, s68
  v_mfma_f32_16x16x32_bf16 v[32:35], v[68:71], a[96:99], 0
  v_mfma_f32_16x16x32_bf16 v[56:59], v[72:75], a[96:99], 0
  v_mfma_f32_16x16x32_bf16 v[36:39], v[68:71], a[128:131], 0
  v_mfma_f32_16x16x32_bf16 v[60:63], v[72:75], a[128:131], 0
  buffer_store_dwordx4 v[88:91], v4, s[12:15], s63 offen sc1
  s_add_u32 s63, s63, s68
  v_mfma_f32_16x16x32_bf16 v[40:43], v[68:71], a[160:163], 0
  v_mfma_f32_16x16x32_bf16 v[64:67], v[72:75], a[160:163], 0
  s_waitcnt lgkmcnt(0)
  v_mfma_f32_16x16x32_bf16 v[20:23], v[76:79], a[4:7], v[20:23]
  ds_read_b128 v[68:71], v108 offset:2048
  v_mfma_f32_16x16x32_bf16 v[44:47], v[80:83], a[4:7], v[44:47]
  ds_read_b128 v[72:75], v108 offset:10240
  v_mfma_f32_16x16x32_bf16 v[24:27], v[76:79], a[36:39], v[24:27]
  v_mfma_f32_16x16x32_bf16 v[48:51], v[80:83], a[36:39], v[48:51]
  v_mfma_f32_16x16x32_bf16 v[28:31], v[76:79], a[68:71], v[28:31]
  v_mfma_f32_16x16x32_bf16 v[52:55], v[80:83], a[68:71], v[52:55]
  buffer_store_dwordx4 v[92:95], v4, s[12:15], s64 offen sc1
  s_add_u32 s64, s64, s68
  v_mfma_f32_16x16x32_bf16 v[32:35], v[76:79], a[100:103], v[32:35]
  v_mfma_f32_16x16x32_bf16 v[56:59], v[80:83], a[100:103], v[56:59]
  v_mfma_f32_16x16x32_bf16 v[36:39], v[76:79], a[132:135], v[36:39]
  v_mfma_f32_16x16x32_bf16 v[60:63], v[80:83], a[132:135], v[60:63]
  buffer_store_dwordx4 v[96:99], v4, s[12:15], s65 offen sc1
  s_add_u32 s65, s65, s68
  v_mfma_f32_16x16x32_bf16 v[40:43], v[76:79], a[164:167], v[40:43]
  v_mfma_f32_16x16x32_bf16 v[64:67], v[80:83], a[164:167], v[64:67]
  s_waitcnt lgkmcnt(0)
  v_mfma_f32_16x16x32_bf16 v[20:23], v[68:71], a[8:11], v[20:23]
  ds_read_b128 v[76:79], v108 offset:3072
  v_mfma_f32_16x16x32_bf16 v[44:47], v[72:75], a[8:11], v[44:47]
  ds_read_b128 v[80:83], v108 offset:11264
  v_mfma_f32_16x16x32_bf16 v[24:27], v[68:71], a[40:43], v[24:27]
  v_mfma_f32_16x16x32_bf16 v[48:51], v[72:75], a[40:43], v[48:51]
  v_mfma_f32_16x16x32_bf16 v[28:31], v[68:71], a[72:75], v[28:31]
  v_mfma_f32_16x16x32_bf16 v[52:55], v[72:75], a[72:75], v[52:55]
  buffer_store_dwordx4 v[100:103], v4, s[12:15], s66 offen sc1
  s_add_u32 s66, s66, s68
  v_mfma_f32_16x16x32_bf16 v[32:35], v[68:71], a[104:107], v[32:35]
  v_mfma_f32_16x16x32_bf16 v[56:59], v[72:75], a[104:107], v[56:59]
  v_mfma_f32_16x16x32_bf16 v[36:39], v[68:71], a[136:139], v[36:39]
  v_mfma_f32_16x16x32_bf16 v[60:63], v[72:75], a[136:139], v[60:63]
  buffer_store_dwordx4 v[104:107], v4, s[12:15], s67 offen sc1
  s_add_u32 s67, s67, s68
  v_mfma_f32_16x16x32_bf16 v[40:43], v[68:71], a[168:171], v[40:43]
  v_mfma_f32_16x16x32_bf16 v[64:67], v[72:75], a[168:171], v[64:67]
  s_waitcnt lgkmcnt(0)
  v_mfma_f32_16x16x32_bf16 v[20:23], v[76:79], a[12:15], v[20:23]
  ds_read_b128 v[68:71], v108 offset:4096
  v_mfma_f32_16x16x32_bf16 v[44:47], v[80:83], a[12:15], v[44:47]
  ds_read_b128 v[72:75], v108 offset:12288
  v_mfma_f32_16x16x32_bf16 v[24:27], v[76:79], a[44:47], v[24:27]
  v_mfma_f32_16x16x32_bf16 v[48:51], v[80:83], a[44:47], v[48:51]
  v_mfma_f32_16x16x32_bf16 v[28:31], v[76:79], a[76:79], v[28:31]
  v_mfma_f32_16x16x32_bf16 v[52:55], v[80:83], a[76:79], v[52:55]
  v_mfma_f32_16x16x32_bf16 v[32:35], v[76:79], a[108:111], v[32:35]
  v_mfma_f32_16x16x32_bf16 v[56:59], v[80:83], a[108:111], v[56:59]
  v_mfma_f32_16x16x32_bf16 v[36:39], v[76:79], a[140:143], v[36:39]
  v_mfma_f32_16x16x32_bf16 v[60:63], v[80:83], a[140:143], v[60:63]
  v_mfma_f32_16x16x32_bf16 v[40:43], v[76:79], a[172:175], v[40:43]
  v_mfma_f32_16x16x32_bf16 v[64:67], v[80:83], a[172:175], v[64:67]
  s_waitcnt lgkmcnt(0)
  v_mfma_f32_16x16x32_bf16 v[20:23], v[68:71], a[16:19], v[20:23]
  ds_read_b128 v[76:79], v108 offset:5120
  v_mfma_f32_16x16x32_bf16 v[44:47], v[72:75], a[16:19], v[44:47]
  ds_read_b128 v[80:83], v108 offset:13312
  v_mfma_f32_16x16x32_bf16 v[24:27], v[68:71], a[48:51], v[24:27]
  v_mfma_f32_16x16x32_bf16 v[48:51], v[72:75], a[48:51], v[48:51]
  v_mfma_f32_16x16x32_bf16 v[28:31], v[68:71], a[80:83], v[28:31]
  v_mfma_f32_16x16x32_bf16 v[52:55], v[72:75], a[80:83], v[52:55]
  v_mfma_f32_16x16x32_bf16 v[32:35], v[68:71], a[112:115], v[32:35]
  v_mfma_f32_16x16x32_bf16 v[56:59], v[72:75], a[112:115], v[56:59]
  v_mfma_f32_16x16x32_bf16 v[36:39], v[68:71], a[144:147], v[36:39]
  v_mfma_f32_16x16x32_bf16 v[60:63], v[72:75], a[144:147], v[60:63]
  v_mfma_f32_16x16x32_bf16 v[40:43], v[68:71], a[176:179], v[40:43]
  v_mfma_f32_16x16x32_bf16 v[64:67], v[72:75], a[176:179], v[64:67]
  s_waitcnt lgkmcnt(0)
  v_mfma_f32_16x16x32_bf16 v[20:23], v[76:79], a[20:23], v[20:23]
  ds_read_b128 v[68:71], v108 offset:6144
  v_mfma_f32_16x16x32_bf16 v[44:47], v[80:83], a[20:23], v[44:47]
  ds_read_b128 v[72:75], v108 offset:14336
  v_mfma_f32_16x16x32_bf16 v[24:27], v[76:79], a[52:55], v[24:27]
  v_mfma_f32_16x16x32_bf16 v[48:51], v[80:83], a[52:55], v[48:51]
  v_mfma_f32_16x16x32_bf16 v[28:31], v[76:79], a[84:87], v[28:31]
  v_mfma_f32_16x16x32_bf16 v[52:55], v[80:83], a[84:87], v[52:55]
  v_mfma_f32_16x16x32_bf16 v[32:35], v[76:79], a[116:119], v[32:35]
  v_mfma_f32_16x16x32_bf16 v[56:59], v[80:83], a[116:119], v[56:59]
  v_mfma_f32_16x16x32_bf16 v[36:39], v[76:79], a[148:151], v[36:39]
  v_mfma_f32_16x16x32_bf16 v[60:63], v[80:83], a[148:151], v[60:63]
  v_mfma_f32_16x16x32_bf16 v[40:43], v[76:79], a[180:183], v[40:43]
  v_mfma_f32_16x16x32_bf16 v[64:67], v[80:83], a[180:183], v[64:67]
  s_waitcnt lgkmcnt(0)
  v_mfma_f32_16x16x32_bf16 v[20:23], v[68:71], a[24:27], v[20:23]
  ds_read_b128 v[76:79], v108 offset:7168
  v_mfma_f32_16x16x32_bf16 v[44:47], v[72:75], a[24:27], v[44:47]
  ds_read_b128 v[80:83], v108 offset:15360
  v_mfma_f32_16x16x32_bf16 v[24:27], v[68:71], a[56:59], v[24:27]
  v_mfma_f32_16x16x32_bf16 v[48:51], v[72:75], a[56:59], v[48:51]
  v_mfma_f32_16x16x32_bf16 v[28:31], v[68:71], a[88:91], v[28:31]
  v_mfma_f32_16x16x32_bf16 v[52:55], v[72:75], a[88:91], v[52:55]
  v_mfma_f32_16x16x32_bf16 v[32:35], v[68:71], a[120:123], v[32:35]
  v_mfma_f32_16x16x32_bf16 v[56:59], v[72:75], a[120:123], v[56:59]
  v_mfma_f32_16x16x32_bf16 v[36:39], v[68:71], a[152:155], v[36:39]
  v_mfma_f32_16x16x32_bf16 v[60:63], v[72:75], a[152:155], v[60:63]
  v_mfma_f32_16x16x32_bf16 v[40:43], v[68:71], a[184:187], v[40:43]
  v_mfma_f32_16x16x32_bf16 v[64:67], v[72:75], a[184:187], v[64:67]
  s_waitcnt lgkmcnt(0)
  v_mfma_f32_16x16x32_bf16 v[20:23], v[76:79], a[28:31], v[20:23]
  v_mfma_f32_16x16x32_bf16 v[44:47], v[80:83], a[28:31], v[44:47]
  v_mfma_f32_16x16x32_bf16 v[24:27], v[76:79], a[60:63], v[24:27]
  v_mfma_f32_16x16x32_bf16 v[48:51], v[80:83], a[60:63], v[48:51]
  v_mfma_f32_16x16x32_bf16 v[28:31], v[76:79], a[92:95], v[28:31]
  v_mfma_f32_16x16x32_bf16 v[52:55], v[80:83], a[92:95], v[52:55]
  v_mfma_f32_16x16x32_bf16 v[32:35], v[76:79], a[124:127], v[32:35]
  v_mfma_f32_16x16x32_bf16 v[56:59], v[80:83], a[124:127], v[56:59]
  v_mfma_f32_16x16x32_bf16 v[36:39], v[76:79], a[156:159], v[36:39]
  v_mfma_f32_16x16x32_bf16 v[60:63], v[80:83], a[156:159], v[60:63]
  v_mfma_f32_16x16x32_bf16 v[40:43], v[76:79], a[188:191], v[40:43]
  v_mfma_f32_16x16x32_bf16 v[64:67], v[80:83], a[188:191], v[64:67]
  v_pk_mul_f32 v[20:21], v[20:21], s[78:79] op_sel:[0,1] op_sel_hi:[1,1]
  v_pk_mul_f32 v[22:23], v[22:23], s[78:79] op_sel:[0,1] op_sel_hi:[1,1]
  v_cvt_pk_bf16_f32 v84, v20, v21
  v_cvt_pk_bf16_f32 v85, v22, v23
  v_pk_mul_f32 v[44:45], v[44:45], s[78:79] op_sel:[0,1] op_sel_hi:[1,1]
  v_pk_mul_f32 v[46:47], v[46:47], s[78:79] op_sel:[0,1] op_sel_hi:[1,1]
  v_cvt_pk_bf16_f32 v86, v44, v45
  v_cvt_pk_bf16_f32 v87, v46, v47
  v_pk_mul_f32 v[24:25], v[24:25], s[78:79] op_sel:[0,1] op_sel_hi:[1,1]
  v_pk_mul_f32 v[26:27], v[26:27], s[78:79] op_sel:[0,1] op_sel_hi:[1,1]
  v_cvt_pk_bf16_f32 v88, v24, v25
  v_cvt_pk_bf16_f32 v89, v26, v27
  v_pk_mul_f32 v[48:49], v[48:49], s[78:79] op_sel:[0,1] op_sel_hi:[1,1]
  v_pk_mul_f32 v[50:51], v[50:51], s[78:79] op_sel:[0,1] op_sel_hi:[1,1]
  v_cvt_pk_bf16_f32 v90, v48, v49
  v_cvt_pk_bf16_f32 v91, v50, v51
  v_pk_mul_f32 v[28:29], v[28:29], s[78:79] op_sel:[0,1] op_sel_hi:[1,1]
  v_pk_mul_f32 v[30:31], v[30:31], s[78:79] op_sel:[0,1] op_sel_hi:[1,1]
  v_cvt_pk_bf16_f32 v92, v28, v29
  v_cvt_pk_bf16_f32 v93, v30, v31
  v_pk_mul_f32 v[52:53], v[52:53], s[78:79] op_sel:[0,1] op_sel_hi:[1,1]
  v_pk_mul_f32 v[54:55], v[54:55], s[78:79] op_sel:[0,1] op_sel_hi:[1,1]
  v_cvt_pk_bf16_f32 v94, v52, v53
  v_cvt_pk_bf16_f32 v95, v54, v55
  v_pk_mul_f32 v[32:33], v[32:33], s[78:79] op_sel:[0,1] op_sel_hi:[1,1]
  v_pk_mul_f32 v[34:35], v[34:35], s[78:79] op_sel:[0,1] op_sel_hi:[1,1]
  v_cvt_pk_bf16_f32 v96, v32, v33
  v_cvt_pk_bf16_f32 v97, v34, v35
  v_pk_mul_f32 v[56:57], v[56:57], s[78:79] op_sel:[0,1] op_sel_hi:[1,1]
  v_pk_mul_f32 v[58:59], v[58:59], s[78:79] op_sel:[0,1] op_sel_hi:[1,1]
  v_cvt_pk_bf16_f32 v98, v56, v57
  v_cvt_pk_bf16_f32 v99, v58, v59
  v_pk_mul_f32 v[36:37], v[36:37], s[78:79] op_sel:[0,1] op_sel_hi:[1,1]
  v_pk_mul_f32 v[38:39], v[38:39], s[78:79] op_sel:[0,1] op_sel_hi:[1,1]
  v_cvt_pk_bf16_f32 v100, v36, v37
  v_cvt_pk_bf16_f32 v101, v38, v39
  v_pk_mul_f32 v[60:61], v[60:61], s[78:79] op_sel:[0,1] op_sel_hi:[1,1]
  v_pk_mul_f32 v[62:63], v[62:63], s[78:79] op_sel:[0,1] op_sel_hi:[1,1]
  v_cvt_pk_bf16_f32 v102, v60, v61
  v_cvt_pk_bf16_f32 v103, v62, v63
  v_pk_mul_f32 v[40:41], v[40:41], s[78:79] op_sel:[0,1] op_sel_hi:[1,1]
  v_pk_mul_f32 v[42:43], v[42:43], s[78:79] op_sel:[0,1] op_sel_hi:[1,1]
  v_cvt_pk_bf16_f32 v104, v40, v41
  v_cvt_pk_bf16_f32 v105, v42, v43
  v_pk_mul_f32 v[64:65], v[64:65], s[78:79] op_sel:[0,1] op_sel_hi:[1,1]
  v_pk_mul_f32 v[66:67], v[66:67], s[78:79] op_sel:[0,1] op_sel_hi:[1,1]
  v_cvt_pk_bf16_f32 v106, v64, v65
  v_cvt_pk_bf16_f32 v107, v66, v67
P0_L:
  s_waitcnt vmcnt(0)
  s_barrier
  s_add_u32 s70, s90, 3
  v_mov_b32 v10, s70
  s_cmp_eq_u32 s3, 0
  s_cselect_b32 s70, s69, 2147418112
  buffer_store_dword v10, off, s[12:15], s70 sc1
  s_cmp_ge_u32 s3, 2
  s_cbranch_scc1 P0_M
  buffer_store_dwordx4 v[84:87], v4, s[12:15], s62 offen sc1
  s_add_u32 s62, s62, s68
  buffer_store_dwordx4 v[88:91], v4, s[12:15], s63 offen sc1
  s_add_u32 s63, s63, s68
  buffer_store_dwordx4 v[92:95], v4, s[12:15], s64 offen sc1
  s_add_u32 s64, s64, s68
  buffer_store_dwordx4 v[96:99], v4, s[12:15], s65 offen sc1
  s_add_u32 s65, s65, s68
  buffer_store_dwordx4 v[100:103], v4, s[12:15], s66 offen sc1
  s_add_u32 s66, s66, s68
  buffer_store_dwordx4 v[104:107], v4, s[12:15], s67 offen sc1
  s_add_u32 s67, s67, s68
P0_M:
  s_waitcnt vmcnt(0)
  s_barrier
  s_add_u32 s70, s90, 4
  v_mov_b32 v10, s70
  s_cmp_eq_u32 s3, 0
  s_cselect_b32 s70, s69, 2147418112
  buffer_store_dword v10, off, s[12:15], s70 sc1
  s_branch P0_END
P0_W:
  s_cmp_ge_u32 s36, 28
  s_cbranch_scc1 P0_MEM
  s_lshl_b32 s36, s36, 2
  s_add_u32 s36, s36, s3
  s_cmp_ge_u32 s36, 56
  s_cselect_b32 s58, 1, 0
  s_cselect_b32 s60, s54, s52
  s_cselect_b32 s61, s55, s53
  s_mov_b32 s28, s60
  s_mov_b32 s29, s61
  s_mov_b32 s30, 0x188000
  s_mov_b32 s31, 0x20000
  s_mov_b32 s62, 3584
  s_cselect_b32 s62, 896, s62
  s_sub_u32 s37, s36, 56
  s_mul_i32 s38, s37, 37
  s_lshr_b32 s38, s38, 8
  s_mul_i32 s39, s38, 7
  s_sub_u32 s39, s37, s39
  s_lshr_b32 s63, s36, 1
  s_and_b32 s64, s36, 1
  s_cmp_eq_u32 s58, 1
  s_cselect_b32 s39, s39, s63
  s_cselect_b32 s38, s38, s64
  s_mul_i32 s63, s38, 224
  s_mul_i32 s63, s63, s62
  s_lshl_b32 s64, s39, 7
  s_add_u32 s63, s63, s64
  s_lshl_b32 s65, s62, 3
  v_lshrrev_b32 v7, 3, v1
  v_mul_lo_u32 v5, s62, v7
  v_bfe_u32 v7, v1, 1, 2
  v_xor_b32 v7, v7, v3
  v_lshl_add_u32 v5, v7, 5, v5
  v_and_b32 v7, 1, v1
  v_lshl_add_u32 v5, v7, 4, v5
  s_mul_i32 s59, s3, 28672
  s_add_u32 m0, s59, 0
  s_nop 0
  buffer_load_dwordx4 v5, s[28:31], s63 offen nt lds
  s_add_u32 s63, s63, s65
  s_add_u32 m0, s59, 1024
  s_nop 0
  buffer_load_dwordx4 v5, s[28:31], s63 offen nt lds
  s_add_u32 s63, s63, s65
  s_add_u32 m0, s59, 2048
  s_nop 0
  buffer_load_dwordx4 v5, s[28:31], s63 offen nt lds
  s_add_u32 s63, s63, s65
  s_add_u32 m0, s59, 3072
  s_nop 0
  buffer_load_dwordx4 v5, s[28:31], s63 offen nt lds
  s_add_u32 s63, s63, s65
  s_add_u32 m0, s59, 4096
  s_nop 0
  buffer_load_dwordx4 v5, s[28:31], s63 offen nt lds
  s_add_u32 s63, s63, s65
  s_add_u32 m0, s59, 5120
  s_nop 0
  buffer_load_dwordx4 v5, s[28:31], s63 offen nt lds
  s_add_u32 s63, s63, s65
  s_add_u32 m0, s59, 6144
  s_nop 0
  buffer_load_dwordx4 v5, s[28:31], s63 offen nt lds
  s_add_u32 s63, s63, s65
  s_add_u32 m0, s59, 7168
  s_nop 0
  buffer_load_dwordx4 v5, s[28:31], s63 offen nt lds
  s_add_u32 s63, s63, s65
  s_add_u32 m0, s59, 8192
  s_nop 0
  buffer_load_dwordx4 v5, s[28:31], s63 offen nt lds
  s_add_u32 s63, s63, s65
  s_add_u32 m0, s59, 9216
  s_nop 0
  buffer_load_dwordx4 v5, s[28:31], s63 offen nt lds
  s_add_u32 s63, s63, s65
  s_add_u32 m0, s59, 10240
  s_nop 0
  buffer_load_dwordx4 v5, s[28:31], s63 offen nt lds
  s_add_u32 s63, s63, s65
  s_add_u32 m0, s59, 11264
  s_nop 0
  buffer_load_dwordx4 v5, s[28:31], s63 offen nt lds
  s_add_u32 s63, s63, s65
  s_add_u32 m0, s59, 12288
  s_nop 0
  buffer_load_dwordx4 v5, s[28:31], s63 offen nt lds
  s_add_u32 s63, s63, s65
  s_add_u32 m0, s59, 13312
  s_nop 0
  buffer_load_dwordx4 v5, s[28:31], s63 offen nt lds
  s_add_u32 s63, s63, s65
  s_add_u32 m0, s59, 14336
  s_nop 0
  buffer_load_dwordx4 v5, s[28:31], s63 offen nt lds
  s_add_u32 s63, s63, s65
  s_add_u32 m0, s59, 15360
  s_nop 0
  buffer_load_dwordx4 v5, s[28:31], s63 offen nt lds
  s_add_u32 s63, s63, s65
  s_add_u32 m0, s59, 16384
  s_nop 0
  buffer_load_dwordx4 v5, s[28:31], s63 offen nt lds
  s_add_u32 s63, s63, s65
  s_add_u32 m0, s59, 17408
  s_nop 0
  buffer_load_dwordx4 v5, s[28:31], s63 offen nt lds
  s_add_u32 s63, s63, s65
  s_add_u32 m0, s59, 18432
  s_nop 0
  buffer_load_dwordx4 v5, s[28:31], s63 offen nt lds
  s_add_u32 s63, s63, s65
  s_add_u32 m0, s59, 19456
  s_nop 0
  buffer_load_dwordx4 v5, s[28:31], s63 offen nt lds
  s_add_u32 s63, s63, s65
  s_add_u32 m0, s59, 20480
  s_nop 0
  buffer_load_dwordx4 v5, s[28:31], s63 offen nt lds
  s_add_u32 s63, s63, s65
  s_add_u32 m0, s59, 21504
  s_nop 0
  buffer_load_dwordx4 v5, s[28:31], s63 offen nt lds
  s_add_u32 s63, s63, s65
  s_add_u32 m0, s59, 22528
  s_nop 0
  buffer_load_dwordx4 v5, s[28:31], s63 offen nt lds
  s_add_u32 s63, s63, s65
  s_add_u32 m0, s59, 23552
  s_nop 0
  buffer_load_dwordx4 v5, s[28:31], s63 offen nt lds
  s_add_u32 s63, s63, s65
  s_add_u32 m0, s59, 24576
  s_nop 0
  buffer_load_dwordx4 v5, s[28:31], s63 offen nt lds
  s_add_u32 s63, s63, s65
  s_add_u32 m0, s59, 25600
  s_nop 0
  buffer_load_dwordx4 v5, s[28:31], s63 offen nt lds
  s_add_u32 s63, s63, s65
  s_add_u32 m0, s59, 26624
  s_nop 0
  buffer_load_dwordx4 v5, s[28:31], s63 offen nt lds
  s_add_u32 s63, s63, s65
  s_add_u32 m0, s59, 27648
  s_nop 0
  buffer_load_dwordx4 v5, s[28:31], s63 offen nt lds
  v_lshlrev_b32 v8, 7, v6
  v_and_b32 v7, 3, v1
  v_lshl_add_u32 v8, v7, 3, v8
  v_add_u32 v8, s59, v8
  v_bfe_u32 v7, v1, 3, 2
  v_xor_b32 v10, 0, v7
  v_lshl_add_u32 v220, v10, 5, v8
  v_xor_b32 v10, 1, v7
  v_lshl_add_u32 v221, v10, 5, v8
  v_xor_b32 v10, 2, v7
  v_lshl_add_u32 v222, v10, 5, v8
  v_xor_b32 v10, 3, v7
  v_lshl_add_u32 v223, v10, 5, v8
  s_waitcnt vmcnt(28)
  v_mul_u32_u24 v10, 144, v1
  s_lshl_b32 s23, s3, 5
  s_add_u32 s23, s23, 147456
  v_add_u32 v10, s23, v10
  v_lshlrev_b32 v232, 16, v12
  v_and_b32 v233, 0xffff0000, v12
  v_lshlrev_b32 v234, 16, v13
  v_and_b32 v235, 0xffff0000, v13
  v_lshlrev_b32 v236, 16, v14
  v_and_b32 v237, 0xffff0000, v14
  v_lshlrev_b32 v238, 16, v15
  v_and_b32 v239, 0xffff0000, v15
  v_add_f32 v240, v232, v233
  v_add_f32 v240, v240, v234
  v_add_f32 v240, v240, v235
  v_add_f32 v240, v240, v236
  v_add_f32 v240, v240, v237
  v_add_f32 v240, v240, v238
  v_add_f32 v240, v240, v239
  s_nop 1
  v_add_f32_dpp v240, v240, v240 row_ror:8 row_mask:0xf bank_mask:0xf
  s_nop 1
  v_add_f32_dpp v240, v240, v240 row_ror:4 row_mask:0xf bank_mask:0xf
  s_nop 1
  v_add_f32_dpp v240, v240, v240 row_ror:2 row_mask:0xf bank_mask:0xf
  s_nop 1
  v_add_f32_dpp v240, v240, v240 row_ror:1 row_mask:0xf bank_mask:0xf
  v_mov_b32 v241, v240
  s_nop 1
  v_permlane16_swap_b32 v240, v241
  v_add_f32 v240, v240, v241
  v_mov_b32 v241, v240
  s_nop 1
  v_permlane32_swap_b32 v240, v241
  v_add_f32 v240, v240, v241
  v_mul_f32 v240, 0x3b124925, v240
  v_sub_f32 v232, v232, v240
  v_sub_f32 v233, v233, v240
  v_sub_f32 v234, v234, v240
  v_sub_f32 v235, v235, v240
  v_sub_f32 v236, v236, v240
  v_sub_f32 v237, v237, v240
  v_sub_f32 v238, v238, v240
  v_sub_f32 v239, v239, v240
  v_mul_f32 v240, v232, v232
  v_fmac_f32 v240, v233, v233
  v_fmac_f32 v240, v234, v234
  v_fmac_f32 v240, v235, v235
  v_fmac_f32 v240, v236, v236
  v_fmac_f32 v240, v237, v237
  v_fmac_f32 v240, v238, v238
  v_fmac_f32 v240, v239, v239
  v_mul_f32 v240, v240, v9
  s_nop 1
  v_add_f32_dpp v240, v240, v240 row_ror:8 row_mask:0xf bank_mask:0xf
  s_nop 1
  v_add_f32_dpp v240, v240, v240 row_ror:4 row_mask:0xf bank_mask:0xf
  s_nop 1
  v_add_f32_dpp v240, v240, v240 row_ror:2 row_mask:0xf bank_mask:0xf
  s_nop 1
  v_add_f32_dpp v240, v240, v240 row_ror:1 row_mask:0xf bank_mask:0xf
  v_mov_b32 v241, v240
  s_nop 1
  v_permlane16_swap_b32 v240, v241
  v_add_f32 v240, v240, v241
  v_mov_b32 v241, v240
  s_nop 1
  v_permlane32_swap_b32 v240, v241
  v_add_f32 v240, v240, v241
  v_mov_b32 v241, 0x3727c5ac
  v_fmac_f32 v241, 0x3b124925, v240
  v_rsq_f32 v240, v241
  s_nop 0
  v_mul_f32 v232, v232, v240
  v_mul_f32 v233, v233, v240
  v_mul_f32 v234, v234, v240
  v_mul_f32 v235, v235, v240
  v_mul_f32 v236, v236, v240
  v_mul_f32 v237, v237, v240
  v_mul_f32 v238, v238, v240
  v_mul_f32 v239, v239, v240
  v_cvt_pk_bf16_f32 v244, v232, v233
  v_cvt_pk_bf16_f32 v245, v234, v235
  v_cvt_pk_bf16_f32 v246, v236, v237
  v_cvt_pk_bf16_f32 v247, v238, v239
  ds_write_b128 v10, v[244:247] offset:0
  v_lshlrev_b32 v232, 16, v16
  v_and_b32 v233, 0xffff0000, v16
  v_lshlrev_b32 v234, 16, v17
  v_and_b32 v235, 0xffff0000, v17
  v_lshlrev_b32 v236, 16, v18
  v_and_b32 v237, 0xffff0000, v18
  v_lshlrev_b32 v238, 16, v19
  v_and_b32 v239, 0xffff0000, v19
  v_add_f32 v240, v232, v233
  v_add_f32 v240, v240, v234
  v_add_f32 v240, v240, v235
  v_add_f32 v240, v240, v236
  v_add_f32 v240, v240, v237
  v_add_f32 v240, v240, v238
  v_add_f32 v240, v240, v239
  s_nop 1
  v_add_f32_dpp v240, v240, v240 row_ror:8 row_mask:0xf bank_mask:0xf
  s_nop 1
  v_add_f32_dpp v240, v240, v240 row_ror:4 row_mask:0xf bank_mask:0xf
  s_nop 1
  v_add_f32_dpp v240, v240, v240 row_ror:2 row_mask:0xf bank_mask:0xf
  s_nop 1
  v_add_f32_dpp v240, v240, v240 row_ror:1 row_mask:0xf bank_mask:0xf
  v_mov_b32 v241, v240
  s_nop 1
  v_permlane16_swap_b32 v240, v241
  v_add_f32 v240, v240, v241
  v_mov_b32 v241, v240
  s_nop 1
  v_permlane32_swap_b32 v240, v241
  v_add_f32 v240, v240, v241
  v_mul_f32 v240, 0x3b124925, v240
  v_sub_f32 v232, v232, v240
  v_sub_f32 v233, v233, v240
  v_sub_f32 v234, v234, v240
  v_sub_f32 v235, v235, v240
  v_sub_f32 v236, v236, v240
  v_sub_f32 v237, v237, v240
  v_sub_f32 v238, v238, v240
  v_sub_f32 v239, v239, v240
  v_mul_f32 v240, v232, v232
  v_fmac_f32 v240, v233, v233
  v_fmac_f32 v240, v234, v234
  v_fmac_f32 v240, v235, v235
  v_fmac_f32 v240, v236, v236
  v_fmac_f32 v240, v237, v237
  v_fmac_f32 v240, v238, v238
  v_fmac_f32 v240, v239, v239
  v_mul_f32 v240, v240, v9
  s_nop 1
  v_add_f32_dpp v240, v240, v240 row_ror:8 row_mask:0xf bank_mask:0xf
  s_nop 1
  v_add_f32_dpp v240, v240, v240 row_ror:4 row_mask:0xf bank_mask:0xf
  s_nop 1
  v_add_f32_dpp v240, v240, v240 row_ror:2 row_mask:0xf bank_mask:0xf
  s_nop 1
  v_add_f32_dpp v240, v240, v240 row_ror:1 row_mask:0xf bank_mask:0xf
  v_mov_b32 v241, v240
  s_nop 1
  v_permlane16_swap_b32 v240, v241
  v_add_f32 v240, v240, v241
  v_mov_b32 v241, v240
  s_nop 1
  v_permlane32_swap_b32 v240, v241
  v_add_f32 v240, v240, v241
  v_mov_b32 v241, 0x3727c5ac
  v_fmac_f32 v241, 0x3b124925, v240
  v_rsq_f32 v240, v241
  s_nop 0
  v_mul_f32 v232, v232, v240
  v_mul_f32 v233, v233, v240
  v_mul_f32 v234, v234, v240
  v_mul_f32 v235, v235, v240
  v_mul_f32 v236, v236, v240
  v_mul_f32 v237, v237, v240
  v_mul_f32 v238, v238, v240
  v_mul_f32 v239, v239, v240
  v_cvt_pk_bf16_f32 v244, v232, v233
  v_cvt_pk_bf16_f32 v245, v234, v235
  v_cvt_pk_bf16_f32 v246, v236, v237
  v_cvt_pk_bf16_f32 v247, v238, v239
  ds_write_b128 v10, v[244:247] offset:16
  s_cmp_lg_u32 s3, 0
  s_cselect_b32 s23, 2147418112, 0
  s_cbranch_scc1 TAG_S2
TAG_L2:
  buffer_load_dword v251, off, s[92:95], s87 offset:128 sc1
  s_add_u32 s23, s23, 1
  s_cmp_gt_u32 s23, 131072
  s_mov_b32 s99, 19
  s_cbranch_scc1 FAIL
  s_waitcnt vmcnt(0)
  v_cmp_eq_u32 vcc, 0, v251
  s_cbranch_vccnz TAG_L2
TAG_K2:
  v_readfirstlane_b32 s90, v251
  v_add_u32 v251, s19, v251
  s_lshr_b32 s23, s2, 3
  s_lshl_b32 s23, s23, 7
  s_and_b32 s22, s2, 7
  s_lshl_b32 s22, s22, 2
  s_add_u32 s23, s23, s22
  s_add_u32 s23, s23, 17899520
TAG_S2:
  buffer_store_dword v251, off, s[12:15], s23 sc1
  s_waitcnt lgkmcnt(0)
  s_barrier
  v_lshrrev_b32 v10, 3, v1
  v_and_b32 v7, 7, v1
  v_mul_u32_u24 v8, 144, v10
  v_lshl_add_u32 v8, v7, 4, v8
  v_lshlrev_b32 v10, 8, v10
  v_lshl_add_u32 v10, v7, 4, v10
  s_mul_i32 s23, s3, 1152
  s_add_u32 s23, s23, 147456
  v_add_u32 v8, s23, v8
  ds_read_b128 v[232:235], v8
  ds_read_b128 v[236:239], v8 offset:4608
  s_lshr_b32 s22, s2, 1
  s_mul_i32 s22, s22, 14336
  s_and_b32 s23, s2, 1
  s_lshl_b32 s23, s23, 7
  s_add_u32 s22, s22, s23
  s_lshl_b32 s23, s3, 11
  s_add_u32 s22, s22, s23
  s_add_u32 s22, s22, 16056320
  s_cmp_eq_u32 s3, 3
  s_cselect_b32 s23, 0x7fff0000, 0
  s_add_u32 s23, s23, 8192
  v_add_u32 v7, s23, v10
  s_waitcnt lgkmcnt(0)
  buffer_store_dwordx4 v[232:235], v10, s[12:15], s22 offen sc1
  buffer_store_dwordx4 v[236:239], v7, s[12:15], s22 offen sc1
  s_mul_i32 s66, s39, 114688
  s_mul_i32 s67, s38, 28672
  s_add_u32 s66, s66, s67
  s_add_u32 s66, s66, 12845056
  s_lshl_b32 s70, s39, 1
  s_add_u32 s70, s70, 0
  s_cmp_ge_u32 s70, 7
  s_cselect_b32 s72, 7, 0
  s_cselect_b32 s71, 2, 0
  s_sub_u32 s70, s70, s72
  s_lshl_b32 s72, s70, 1
  s_add_u32 s72, s72, 0
  s_sub_u32 s74, s72, 8
  s_cmp_gt_u32 s70, 3
  s_cselect_b32 s72, s74, s72
  s_cselect_b32 s75, 1, 0
  s_cmp_eq_u32 s70, 3
  s_cselect_b32 s72, 6, s72
  s_cselect_b32 s75, 0, s75
  s_add_u32 s75, s75, s71
  s_mul_i32 s75, s75, 114688
  s_lshl_b32 s72, s72, 10
  s_add_u32 s75, s75, s72
  s_add_u32 s75, s75, 12902400
  s_add_u32 s72, s66, 0
  s_cmp_eq_u32 s58, 1
  s_cselect_b32 s76, s75, s72
  s_lshl_b32 s70, s39, 1
  s_add_u32 s70, s70, 0
  s_cmp_ge_u32 s70, 7
  s_cselect_b32 s72, 7, 0
  s_cselect_b32 s71, 2, 0
  s_sub_u32 s70, s70, s72
  s_lshl_b32 s72, s70, 1
  s_add_u32 s72, s72, 1
  s_sub_u32 s74, s72, 8
  s_cmp_gt_u32 s70, 3
  s_cselect_b32 s72, s74, s72
  s_cselect_b32 s75, 1, 0
  s_cmp_eq_u32 s70, 3
  s_cselect_b32 s72, 6, s72
  s_cselect_b32 s75, 1, s75
  s_add_u32 s75, s75, s71
  s_mul_i32 s75, s75, 114688
  s_lshl_b32 s72, s72, 10
  s_add_u32 s75, s75, s72
  s_add_u32 s75, s75, 12902400
  s_add_u32 s72, s66, 1024
  s_cmp_eq_u32 s58, 1
  s_cselect_b32 s77, s75, s72
  s_lshl_b32 s70, s39, 1
  s_add_u32 s70, s70, 1
  s_cmp_ge_u32 s70, 7
  s_cselect_b32 s72, 7, 0
  s_cselect_b32 s71, 2, 0
  s_sub_u32 s70, s70, s72
  s_lshl_b32 s72, s70, 1
  s_add_u32 s72, s72, 0
  s_sub_u32 s74, s72, 8
  s_cmp_gt_u32 s70, 3
  s_cselect_b32 s72, s74, s72
  s_cselect_b32 s75, 1, 0
  s_cmp_eq_u32 s70, 3
  s_cselect_b32 s72, 6, s72
  s_cselect_b32 s75, 0, s75
  s_add_u32 s75, s75, s71
  s_mul_i32 s75, s75, 114688
  s_lshl_b32 s72, s72, 10
  s_add_u32 s75, s75, s72
  s_add_u32 s75, s75, 12902400
  s_add_u32 s72, s66, 2048
  s_cmp_eq_u32 s58, 1
  s_cselect_b32 s78, s75, s72
  s_lshl_b32 s70, s39, 1
  s_add_u32 s70, s70, 1
  s_cmp_ge_u32 s70, 7
  s_cselect_b32 s72, 7, 0
  s_cselect_b32 s71, 2, 0
  s_sub_u32 s70, s70, s72
  s_lshl_b32 s72, s70, 1
  s_add_u32 s72, s72, 1
  s_sub_u32 s74, s72, 8
  s_cmp_gt_u32 s70, 3
  s_cselect_b32 s72, s74, s72
  s_cselect_b32 s75, 1, 0
  s_cmp_eq_u32 s70, 3
  s_cselect_b32 s72, 6, s72
  s_cselect_b32 s75, 1, s75
  s_add_u32 s75, s75, s71
  s_mul_i32 s75, s75, 114688
  s_lshl_b32 s72, s72, 10
  s_add_u32 s75, s75, s72
  s_add_u32 s75, s75, 12902400
  s_add_u32 s72, s66, 3072
  s_cmp_eq_u32 s58, 1
  s_cselect_b32 s79, s75, s72
  s_mul_i32 s73, s38, 7
  ds_read_b64_tr_b16 v[20:21], v220 offset:0
  ds_read_b64_tr_b16 v[22:23], v220 offset:2048
  ds_read_b64_tr_b16 v[24:25], v221 offset:0
  ds_read_b64_tr_b16 v[26:27], v221 offset:2048
  ds_read_b64_tr_b16 v[28:29], v222 offset:0
  ds_read_b64_tr_b16 v[30:31], v222 offset:2048
  ds_read_b64_tr_b16 v[32:33], v223 offset:0
  ds_read_b64_tr_b16 v[34:35], v223 offset:2048
  s_add_u32 s70, s73, 0
  s_lshr_b32 s71, s70, 3
  s_mul_i32 s71, s71, 458752
  s_and_b32 s72, s70, 1
  s_lshl_b32 s72, s72, 2
  s_bfe_u32 s70, s70, 0x20001
  s_add_u32 s70, s70, s72
  s_mul_i32 s70, s70, 7168
  s_add_u32 s71, s71, s70
  s_cmp_eq_u32 s58, 1
  s_cselect_b32 s71, s71, 0
  s_add_u32 s74, s71, s76
  s_waitcnt lgkmcnt(6)
  buffer_store_dwordx4 v[20:23], v4, s[12:15], s74 offen sc1
  s_add_u32 s74, s71, s77
  s_waitcnt lgkmcnt(4)
  buffer_store_dwordx4 v[24:27], v4, s[12:15], s74 offen sc1
  s_add_u32 s74, s71, s78
  s_waitcnt lgkmcnt(2)
  buffer_store_dwordx4 v[28:31], v4, s[12:15], s74 offen sc1
  s_add_u32 s74, s71, s79
  s_waitcnt lgkmcnt(0)
  buffer_store_dwordx4 v[32:35], v4, s[12:15], s74 offen sc1
  ds_read_b64_tr_b16 v[36:37], v220 offset:4096
  ds_read_b64_tr_b16 v[38:39], v220 offset:6144
  ds_read_b64_tr_b16 v[40:41], v221 offset:4096
  ds_read_b64_tr_b16 v[42:43], v221 offset:6144
  ds_read_b64_tr_b16 v[44:45], v222 offset:4096
  ds_read_b64_tr_b16 v[46:47], v222 offset:6144
  ds_read_b64_tr_b16 v[48:49], v223 offset:4096
  ds_read_b64_tr_b16 v[50:51], v223 offset:6144
  s_add_u32 s70, s73, 1
  s_lshr_b32 s71, s70, 3
  s_mul_i32 s71, s71, 458752
  s_and_b32 s72, s70, 1
  s_lshl_b32 s72, s72, 2
  s_bfe_u32 s70, s70, 0x20001
  s_add_u32 s70, s70, s72
  s_mul_i32 s70, s70, 7168
  s_add_u32 s71, s71, s70
  s_cmp_eq_u32 s58, 1
  s_cselect_b32 s71, s71, 4096
  s_add_u32 s74, s71, s76
  s_waitcnt lgkmcnt(6)
  buffer_store_dwordx4 v[36:39], v4, s[12:15], s74 offen sc1
  s_add_u32 s74, s71, s77
  s_waitcnt lgkmcnt(4)
  buffer_store_dwordx4 v[40:43], v4, s[12:15], s74 offen sc1
  s_add_u32 s74, s71, s78
  s_waitcnt lgkmcnt(2)
  buffer_store_dwordx4 v[44:47], v4, s[12:15], s74 offen sc1
  s_add_u32 s74, s71, s79
  s_waitcnt lgkmcnt(0)
  buffer_store_dwordx4 v[48:51], v4, s[12:15], s74 offen sc1
  ds_read_b64_tr_b16 v[52:53], v220 offset:8192
  ds_read_b64_tr_b16 v[54:55], v220 offset:10240
  ds_read_b64_tr_b16 v[56:57], v221 offset:8192
  ds_read_b64_tr_b16 v[58:59], v221 offset:10240
  ds_read_b64_tr_b16 v[60:61], v222 offset:8192
  ds_read_b64_tr_b16 v[62:63], v222 offset:10240
  ds_read_b64_tr_b16 v[64:65], v223 offset:8192
  ds_read_b64_tr_b16 v[66:67], v223 offset:10240
  s_add_u32 s70, s73, 2
  s_lshr_b32 s71, s70, 3
  s_mul_i32 s71, s71, 458752
  s_and_b32 s72, s70, 1
  s_lshl_b32 s72, s72, 2
  s_bfe_u32 s70, s70, 0x20001
  s_add_u32 s70, s70, s72
  s_mul_i32 s70, s70, 7168
  s_add_u32 s71, s71, s70
  s_cmp_eq_u32 s58, 1
  s_cselect_b32 s71, s71, 8192
  s_add_u32 s74, s71, s76
  s_waitcnt lgkmcnt(6)
  buffer_store_dwordx4 v[52:55], v4, s[12:15], s74 offen sc1
  s_add_u32 s74, s71, s77
  s_waitcnt lgkmcnt(4)
  buffer_store_dwordx4 v[56:59], v4, s[12:15], s74 offen sc1
  s_add_u32 s74, s71, s78
  s_waitcnt lgkmcnt(2)
  buffer_store_dwordx4 v[60:63], v4, s[12:15], s74 offen sc1
  s_add_u32 s74, s71, s79
  s_waitcnt lgkmcnt(0)
  buffer_store_dwordx4 v[64:67], v4, s[12:15], s74 offen sc1
  ds_read_b64_tr_b16 v[68:69], v220 offset:12288
  ds_read_b64_tr_b16 v[70:71], v220 offset:14336
  ds_read_b64_tr_b16 v[72:73], v221 offset:12288
  ds_read_b64_tr_b16 v[74:75], v221 offset:14336
  ds_read_b64_tr_b16 v[76:77], v222 offset:12288
  ds_read_b64_tr_b16 v[78:79], v222 offset:14336
  ds_read_b64_tr_b16 v[80:81], v223 offset:12288
  ds_read_b64_tr_b16 v[82:83], v223 offset:14336
  s_add_u32 s70, s73, 3
  s_lshr_b32 s71, s70, 3
  s_mul_i32 s71, s71, 458752
  s_and_b32 s72, s70, 1
  s_lshl_b32 s72, s72, 2
  s_bfe_u32 s70, s70, 0x20001
  s_add_u32 s70, s70, s72
  s_mul_i32 s70, s70, 7168
  s_add_u32 s71, s71, s70
  s_cmp_eq_u32 s58, 1
  s_cselect_b32 s71, s71, 12288
  s_add_u32 s74, s71, s76
  s_waitcnt lgkmcnt(6)
  buffer_store_dwordx4 v[68:71], v4, s[12:15], s74 offen sc1
  s_add_u32 s74, s71, s77
  s_waitcnt lgkmcnt(4)
  buffer_store_dwordx4 v[72:75], v4, s[12:15], s74 offen sc1
  s_add_u32 s74, s71, s78
  s_waitcnt lgkmcnt(2)
  buffer_store_dwordx4 v[76:79], v4, s[12:15], s74 offen sc1
  s_add_u32 s74, s71, s79
  s_waitcnt lgkmcnt(0)
  buffer_store_dwordx4 v[80:83], v4, s[12:15], s74 offen sc1
  ds_read_b64_tr_b16 v[84:85], v220 offset:16384
  ds_read_b64_tr_b16 v[86:87], v220 offset:18432
  ds_read_b64_tr_b16 v[88:89], v221 offset:16384
  ds_read_b64_tr_b16 v[90:91], v221 offset:18432
  ds_read_b64_tr_b16 v[92:93], v222 offset:16384
  ds_read_b64_tr_b16 v[94:95], v222 offset:18432
  ds_read_b64_tr_b16 v[96:97], v223 offset:16384
  ds_read_b64_tr_b16 v[98:99], v223 offset:18432
  s_add_u32 s70, s73, 4
  s_lshr_b32 s71, s70, 3
  s_mul_i32 s71, s71, 458752
  s_and_b32 s72, s70, 1
  s_lshl_b32 s72, s72, 2
  s_bfe_u32 s70, s70, 0x20001
  s_add_u32 s70, s70, s72
  s_mul_i32 s70, s70, 7168
  s_add_u32 s71, s71, s70
  s_cmp_eq_u32 s58, 1
  s_cselect_b32 s71, s71, 16384
  s_add_u32 s74, s71, s76
  s_waitcnt lgkmcnt(6)
  buffer_store_dwordx4 v[84:87], v4, s[12:15], s74 offen sc1
  s_add_u32 s74, s71, s77
  s_waitcnt lgkmcnt(4)
  buffer_store_dwordx4 v[88:91], v4, s[12:15], s74 offen sc1
  s_add_u32 s74, s71, s78
  s_waitcnt lgkmcnt(2)
  buffer_store_dwordx4 v[92:95], v4, s[12:15], s74 offen sc1
  s_add_u32 s74, s71, s79
  s_waitcnt lgkmcnt(0)
  buffer_store_dwordx4 v[96:99], v4, s[12:15], s74 offen sc1
  ds_read_b64_tr_b16 v[100:101], v220 offset:20480
  ds_read_b64_tr_b16 v[102:103], v220 offset:22528
  ds_read_b64_tr_b16 v[104:105], v221 offset:20480
  ds_read_b64_tr_b16 v[106:107], v221 offset:22528
  ds_read_b64_tr_b16 v[108:109], v222 offset:20480
  ds_read_b64_tr_b16 v[110:111], v222 offset:22528
  ds_read_b64_tr_b16 v[112:113], v223 offset:20480
  ds_read_b64_tr_b16 v[114:115], v223 offset:22528
  s_add_u32 s70, s73, 5
  s_lshr_b32 s71, s70, 3
  s_mul_i32 s71, s71, 458752
  s_and_b32 s72, s70, 1
  s_lshl_b32 s72, s72, 2
  s_bfe_u32 s70, s70, 0x20001
  s_add_u32 s70, s70, s72
  s_mul_i32 s70, s70, 7168
  s_add_u32 s71, s71, s70
  s_cmp_eq_u32 s58, 1
  s_cselect_b32 s71, s71, 20480
  s_add_u32 s74, s71, s76
  s_waitcnt lgkmcnt(6)
  buffer_store_dwordx4 v[100:103], v4, s[12:15], s74 offen sc1
  s_add_u32 s74, s71, s77
  s_waitcnt lgkmcnt(4)
  buffer_store_dwordx4 v[104:107], v4, s[12:15], s74 offen sc1
  s_add_u32 s74, s71, s78
  s_waitcnt lgkmcnt(2)
  buffer_store_dwordx4 v[108:111], v4, s[12:15], s74 offen sc1
  s_add_u32 s74, s71, s79
  s_waitcnt lgkmcnt(0)
  buffer_store_dwordx4 v[112:115], v4, s[12:15], s74 offen sc1
  ds_read_b64_tr_b16 v[116:117], v220 offset:24576
  ds_read_b64_tr_b16 v[118:119], v220 offset:26624
  ds_read_b64_tr_b16 v[120:121], v221 offset:24576
  ds_read_b64_tr_b16 v[122:123], v221 offset:26624
  ds_read_b64_tr_b16 v[124:125], v222 offset:24576
  ds_read_b64_tr_b16 v[126:127], v222 offset:26624
  ds_read_b64_tr_b16 v[128:129], v223 offset:24576
  ds_read_b64_tr_b16 v[130:131], v223 offset:26624
  s_add_u32 s70, s73, 6
  s_lshr_b32 s71, s70, 3
  s_mul_i32 s71, s71, 458752
  s_and_b32 s72, s70, 1
  s_lshl_b32 s72, s72, 2
  s_bfe_u32 s70, s70, 0x20001
  s_add_u32 s70, s70, s72
  s_mul_i32 s70, s70, 7168
  s_add_u32 s71, s71, s70
  s_cmp_eq_u32 s58, 1
  s_cselect_b32 s71, s71, 24576
  s_add_u32 s74, s71, s76
  s_waitcnt lgkmcnt(6)
  buffer_store_dwordx4 v[116:119], v4, s[12:15], s74 offen sc1
  s_add_u32 s74, s71, s77
  s_waitcnt lgkmcnt(4)
  buffer_store_dwordx4 v[120:123], v4, s[12:15], s74 offen sc1
  s_add_u32 s74, s71, s78
  s_waitcnt lgkmcnt(2)
  buffer_store_dwordx4 v[124:127], v4, s[12:15], s74 offen sc1
  s_add_u32 s74, s71, s79
  s_waitcnt lgkmcnt(0)
  buffer_store_dwordx4 v[128:131], v4, s[12:15], s74 offen sc1
  s_lshl_b32 s22, s2, 2
  s_add_u32 s22, s22, s3
  s_mov_b32 s23, 2147418112
  s_sub_u32 s70, s22, 0
  s_mul_i32 s71, s70, 3072
  s_add_u32 s71, s71, 76656640
  s_cmp_lt_u32 s70, 56
  s_cselect_b32 s23, s71, s23
  s_sub_u32 s70, s22, 56
  s_mul_i32 s71, s70, 3072
  s_add_u32 s71, s71, 78462976
  s_cmp_lt_u32 s70, 56
  s_cselect_b32 s23, s71, s23
  s_sub_u32 s70, s22, 112
  s_mul_i32 s71, s70, 3072
  s_add_u32 s71, s71, 83968000
  s_cmp_lt_u32 s70, 56
  s_cselect_b32 s23, s71, s23
  s_sub_u32 s70, s22, 168
  s_mul_i32 s71, s70, 3072
  s_add_u32 s71, s71, 80297984
  s_cmp_lt_u32 s70, 28
  s_cselect_b32 s23, s71, s23
  s_sub_u32 s70, s22, 196
  s_mul_i32 s71, s70, 3072
  s_add_u32 s71, s71, 82132992
  s_cmp_lt_u32 s70, 28
  s_cselect_b32 s23, s71, s23
  s_sub_u32 s70, s22, 224
  s_mul_i32 s71, s70, 3072
  s_add_u32 s71, s71, 85811200
  s_cmp_lt_u32 s70, 3
  s_cselect_b32 s23, s71, s23
  s_sub_u32 s70, s22, 227
  s_mul_i32 s71, s70, 3072
  s_add_u32 s71, s71, 85843968
  s_cmp_lt_u32 s70, 3
  s_cselect_b32 s23, s71, s23
  s_sub_u32 s70, s22, 230
  s_mul_i32 s71, s70, 3072
  s_add_u32 s71, s71, 85868544
  s_cmp_lt_u32 s70, 11
  s_cselect_b32 s23, s71, s23
  s_sub_u32 s70, s22, 241
  s_mul_i32 s71, s70, 3072
  s_add_u32 s71, s71, 85934080
  s_cmp_lt_u32 s70, 11
  s_cselect_b32 s23, s71, s23
  s_sub_u32 s70, s22, 252
  s_mul_i32 s71, s70, 3072
  s_add_u32 s71, s71, 85999616
  s_cmp_lt_u32 s70, 80
  s_cselect_b32 s23, s71, s23
  s_sub_u32 s70, s22, 332
  s_mul_i32 s71, s70, 3072
  s_add_u32 s71, s71, 88621056
  s_cmp_lt_u32 s70, 80
  s_cselect_b32 s23, s71, s23
  s_sub_u32 s70, s22, 412
  s_mul_i32 s71, s70, 3072
  s_add_u32 s71, s71, 91242496
  s_cmp_lt_u32 s70, 468
  s_cselect_b32 s23, s71, s23
  v_mov_b32 v228, -1
  v_mov_b32 v229, -1
  v_mov_b32 v230, -1
  v_mov_b32 v231, -1
  buffer_store_dwordx4 v[228:231], v4, s[12:15], s23 offen offset:0 sc1
  buffer_store_dwordx4 v[228:231], v4, s[12:15], s23 offen offset:1024 sc1
  buffer_store_dwordx4 v[228:231], v4, s[12:15], s23 offen offset:2048 sc1
  s_branch P0_END
P0_MEM:
  s_lshl_b32 s22, s2, 2
  s_add_u32 s22, s22, s3
  s_mov_b32 s23, 2147418112
  s_sub_u32 s70, s22, 0
  s_mul_i32 s71, s70, 3072
  s_add_u32 s71, s71, 76656640
  s_cmp_lt_u32 s70, 56
  s_cselect_b32 s23, s71, s23
  s_sub_u32 s70, s22, 56
  s_mul_i32 s71, s70, 3072
  s_add_u32 s71, s71, 78462976
  s_cmp_lt_u32 s70, 56
  s_cselect_b32 s23, s71, s23
  s_sub_u32 s70, s22, 112
  s_mul_i32 s71, s70, 3072
  s_add_u32 s71, s71, 83968000
  s_cmp_lt_u32 s70, 56
  s_cselect_b32 s23, s71, s23
  s_sub_u32 s70, s22, 168
  s_mul_i32 s71, s70, 3072
  s_add_u32 s71, s71, 80297984
  s_cmp_lt_u32 s70, 28
  s_cselect_b32 s23, s71, s23
  s_sub_u32 s70, s22, 196
  s_mul_i32 s71, s70, 3072
  s_add_u32 s71, s71, 82132992
  s_cmp_lt_u32 s70, 28
  s_cselect_b32 s23, s71, s23
  s_sub_u32 s70, s22, 224
  s_mul_i32 s71, s70, 3072
  s_add_u32 s71, s71, 85811200
  s_cmp_lt_u32 s70, 3
  s_cselect_b32 s23, s71, s23
  s_sub_u32 s70, s22, 227
  s_mul_i32 s71, s70, 3072
  s_add_u32 s71, s71, 85843968
  s_cmp_lt_u32 s70, 3
  s_cselect_b32 s23, s71, s23
  s_sub_u32 s70, s22, 230
  s_mul_i32 s71, s70, 3072
  s_add_u32 s71, s71, 85868544
  s_cmp_lt_u32 s70, 11
  s_cselect_b32 s23, s71, s23
  s_sub_u32 s70, s22, 241
  s_mul_i32 s71, s70, 3072
  s_add_u32 s71, s71, 85934080
  s_cmp_lt_u32 s70, 11
  s_cselect_b32 s23, s71, s23
  s_sub_u32 s70, s22, 252
  s_mul_i32 s71, s70, 3072
  s_add_u32 s71, s71, 85999616
  s_cmp_lt_u32 s70, 80
  s_cselect_b32 s23, s71, s23
  s_sub_u32 s70, s22, 332
  s_mul_i32 s71, s70, 3072
  s_add_u32 s71, s71, 88621056
  s_cmp_lt_u32 s70, 80
  s_cselect_b32 s23, s71, s23
  s_sub_u32 s70, s22, 412
  s_mul_i32 s71, s70, 3072
  s_add_u32 s71, s71, 91242496
  s_cmp_lt_u32 s70, 468
  s_cselect_b32 s23, s71, s23
  v_mov_b32 v228, -1
  v_mov_b32 v229, -1
  v_mov_b32 v230, -1
  v_mov_b32 v231, -1
  buffer_store_dwordx4 v[228:231], v4, s[12:15], s23 offen offset:0 sc1
  buffer_store_dwordx4 v[228:231], v4, s[12:15], s23 offen offset:1024 sc1
  buffer_store_dwordx4 v[228:231], v4, s[12:15], s23 offen offset:2048 sc1
  s_waitcnt vmcnt(3)
  v_mul_u32_u24 v10, 144, v1
  s_lshl_b32 s23, s3, 5
  s_add_u32 s23, s23, 147456
  v_add_u32 v10, s23, v10
  v_lshlrev_b32 v232, 16, v12
  v_and_b32 v233, 0xffff0000, v12
  v_lshlrev_b32 v234, 16, v13
  v_and_b32 v235, 0xffff0000, v13
  v_lshlrev_b32 v236, 16, v14
  v_and_b32 v237, 0xffff0000, v14
  v_lshlrev_b32 v238, 16, v15
  v_and_b32 v239, 0xffff0000, v15
  v_add_f32 v240, v232, v233
  v_add_f32 v240, v240, v234
  v_add_f32 v240, v240, v235
  v_add_f32 v240, v240, v236
  v_add_f32 v240, v240, v237
  v_add_f32 v240, v240, v238
  v_add_f32 v240, v240, v239
  s_nop 1
  v_add_f32_dpp v240, v240, v240 row_ror:8 row_mask:0xf bank_mask:0xf
  s_nop 1
  v_add_f32_dpp v240, v240, v240 row_ror:4 row_mask:0xf bank_mask:0xf
  s_nop 1
  v_add_f32_dpp v240, v240, v240 row_ror:2 row_mask:0xf bank_mask:0xf
  s_nop 1
  v_add_f32_dpp v240, v240, v240 row_ror:1 row_mask:0xf bank_mask:0xf
  v_mov_b32 v241, v240
  s_nop 1
  v_permlane16_swap_b32 v240, v241
  v_add_f32 v240, v240, v241
  v_mov_b32 v241, v240
  s_nop 1
  v_permlane32_swap_b32 v240, v241
  v_add_f32 v240, v240, v241
  v_mul_f32 v240, 0x3b124925, v240
  v_sub_f32 v232, v232, v240
  v_sub_f32 v233, v233, v240
  v_sub_f32 v234, v234, v240
  v_sub_f32 v235, v235, v240
  v_sub_f32 v236, v236, v240
  v_sub_f32 v237, v237, v240
  v_sub_f32 v238, v238, v240
  v_sub_f32 v239, v239, v240
  v_mul_f32 v240, v232, v232
  v_fmac_f32 v240, v233, v233
  v_fmac_f32 v240, v234, v234
  v_fmac_f32 v240, v235, v235
  v_fmac_f32 v240, v236, v236
  v_fmac_f32 v240, v237, v237
  v_fmac_f32 v240, v238, v238
  v_fmac_f32 v240, v239, v239
  v_mul_f32 v240, v240, v9
  s_nop 1
  v_add_f32_dpp v240, v240, v240 row_ror:8 row_mask:0xf bank_mask:0xf
  s_nop 1
  v_add_f32_dpp v240, v240, v240 row_ror:4 row_mask:0xf bank_mask:0xf
  s_nop 1
  v_add_f32_dpp v240, v240, v240 row_ror:2 row_mask:0xf bank_mask:0xf
  s_nop 1
  v_add_f32_dpp v240, v240, v240 row_ror:1 row_mask:0xf bank_mask:0xf
  v_mov_b32 v241, v240
  s_nop 1
  v_permlane16_swap_b32 v240, v241
  v_add_f32 v240, v240, v241
  v_mov_b32 v241, v240
  s_nop 1
  v_permlane32_swap_b32 v240, v241
  v_add_f32 v240, v240, v241
  v_mov_b32 v241, 0x3727c5ac
  v_fmac_f32 v241, 0x3b124925, v240
  v_rsq_f32 v240, v241
  s_nop 0
  v_mul_f32 v232, v232, v240
  v_mul_f32 v233, v233, v240
  v_mul_f32 v234, v234, v240
  v_mul_f32 v235, v235, v240
  v_mul_f32 v236, v236, v240
  v_mul_f32 v237, v237, v240
  v_mul_f32 v238, v238, v240
  v_mul_f32 v239, v239, v240
  v_cvt_pk_bf16_f32 v244, v232, v233
  v_cvt_pk_bf16_f32 v245, v234, v235
  v_cvt_pk_bf16_f32 v246, v236, v237
  v_cvt_pk_bf16_f32 v247, v238, v239
  ds_write_b128 v10, v[244:247] offset:0
  v_lshlrev_b32 v232, 16, v16
  v_and_b32 v233, 0xffff0000, v16
  v_lshlrev_b32 v234, 16, v17
  v_and_b32 v235, 0xffff0000, v17
  v_lshlrev_b32 v236, 16, v18
  v_and_b32 v237, 0xffff0000, v18
  v_lshlrev_b32 v238, 16, v19
  v_and_b32 v239, 0xffff0000, v19
  v_add_f32 v240, v232, v233
  v_add_f32 v240, v240, v234
  v_add_f32 v240, v240, v235
  v_add_f32 v240, v240, v236
  v_add_f32 v240, v240, v237
  v_add_f32 v240, v240, v238
  v_add_f32 v240, v240, v239
  s_nop 1
  v_add_f32_dpp v240, v240, v240 row_ror:8 row_mask:0xf bank_mask:0xf
  s_nop 1
  v_add_f32_dpp v240, v240, v240 row_ror:4 row_mask:0xf bank_mask:0xf
  s_nop 1
  v_add_f32_dpp v240, v240, v240 row_ror:2 row_mask:0xf bank_mask:0xf
  s_nop 1
  v_add_f32_dpp v240, v240, v240 row_ror:1 row_mask:0xf bank_mask:0xf
  v_mov_b32 v241, v240
  s_nop 1
  v_permlane16_swap_b32 v240, v241
  v_add_f32 v240, v240, v241
  v_mov_b32 v241, v240
  s_nop 1
  v_permlane32_swap_b32 v240, v241
  v_add_f32 v240, v240, v241
  v_mul_f32 v240, 0x3b124925, v240
  v_sub_f32 v232, v232, v240
  v_sub_f32 v233, v233, v240
  v_sub_f32 v234, v234, v240
  v_sub_f32 v235, v235, v240
  v_sub_f32 v236, v236, v240
  v_sub_f32 v237, v237, v240
  v_sub_f32 v238, v238, v240
  v_sub_f32 v239, v239, v240
  v_mul_f32 v240, v232, v232
  v_fmac_f32 v240, v233, v233
  v_fmac_f32 v240, v234, v234
  v_fmac_f32 v240, v235, v235
  v_fmac_f32 v240, v236, v236
  v_fmac_f32 v240, v237, v237
  v_fmac_f32 v240, v238, v238
  v_fmac_f32 v240, v239, v239
  v_mul_f32 v240, v240, v9
  s_nop 1
  v_add_f32_dpp v240, v240, v240 row_ror:8 row_mask:0xf bank_mask:0xf
  s_nop 1
  v_add_f32_dpp v240, v240, v240 row_ror:4 row_mask:0xf bank_mask:0xf
  s_nop 1
  v_add_f32_dpp v240, v240, v240 row_ror:2 row_mask:0xf bank_mask:0xf
  s_nop 1
  v_add_f32_dpp v240, v240, v240 row_ror:1 row_mask:0xf bank_mask:0xf
  v_mov_b32 v241, v240
  s_nop 1
  v_permlane16_swap_b32 v240, v241
  v_add_f32 v240, v240, v241
  v_mov_b32 v241, v240
  s_nop 1
  v_permlane32_swap_b32 v240, v241
  v_add_f32 v240, v240, v241
  v_mov_b32 v241, 0x3727c5ac
  v_fmac_f32 v241, 0x3b124925, v240
  v_rsq_f32 v240, v241
  s_nop 0
  v_mul_f32 v232, v232, v240
  v_mul_f32 v233, v233, v240
  v_mul_f32 v234, v234, v240
  v_mul_f32 v235, v235, v240
  v_mul_f32 v236, v236, v240
  v_mul_f32 v237, v237, v240
  v_mul_f32 v238, v238, v240
  v_mul_f32 v239, v239, v240
  v_cvt_pk_bf16_f32 v244, v232, v233
  v_cvt_pk_bf16_f32 v245, v234, v235
  v_cvt_pk_bf16_f32 v246, v236, v237
  v_cvt_pk_bf16_f32 v247, v238, v239
  ds_write_b128 v10, v[244:247] offset:16
  s_cmp_lg_u32 s3, 0
  s_cselect_b32 s23, 2147418112, 0
  s_cbranch_scc1 TAG_S3
TAG_L3:
  buffer_load_dword v251, off, s[92:95], s87 offset:128 sc1
  s_add_u32 s23, s23, 1
  s_cmp_gt_u32 s23, 131072
  s_mov_b32 s99, 19
  s_cbranch_scc1 FAIL
  s_waitcnt vmcnt(0)
  v_cmp_eq_u32 vcc, 0, v251
  s_cbranch_vccnz TAG_L3
TAG_K3:
  v_readfirstlane_b32 s90, v251
  v_add_u32 v251, s19, v251
  s_lshr_b32 s23, s2, 3
  s_lshl_b32 s23, s23, 7
  s_and_b32 s22, s2, 7
  s_lshl_b32 s22, s22, 2
  s_add_u32 s23, s23, s22
  s_add_u32 s23, s23, 17899520
TAG_S3:
  buffer_store_dword v251, off, s[12:15], s23 sc1
  s_waitcnt lgkmcnt(0)
  s_barrier
  v_lshrrev_b32 v10, 3, v1
  v_and_b32 v7, 7, v1
  v_mul_u32_u24 v8, 144, v10
  v_lshl_add_u32 v8, v7, 4, v8
  v_lshlrev_b32 v10, 8, v10
  v_lshl_add_u32 v10, v7, 4, v10
  s_mul_i32 s23, s3, 1152
  s_add_u32 s23, s23, 147456
  v_add_u32 v8, s23, v8
  ds_read_b128 v[232:235], v8
  ds_read_b128 v[236:239], v8 offset:4608
  s_lshr_b32 s22, s2, 1
  s_mul_i32 s22, s22, 14336
  s_and_b32 s23, s2, 1
  s_lshl_b32 s23, s23, 7
  s_add_u32 s22, s22, s23
  s_lshl_b32 s23, s3, 11
  s_add_u32 s22, s22, s23
  s_add_u32 s22, s22, 16056320
  s_cmp_eq_u32 s3, 3
  s_cselect_b32 s23, 0x7fff0000, 0
  s_add_u32 s23, s23, 8192
  v_add_u32 v7, s23, v10
  s_waitcnt lgkmcnt(0)
  buffer_store_dwordx4 v[232:235], v10, s[12:15], s22 offen sc1
  buffer_store_dwordx4 v[236:239], v7, s[12:15], s22 offen sc1
  s_cmp_lg_u32 s36, 31
  s_cbranch_scc1 P0_END
  s_mov_b32 s28, s42
  s_mov_b32 s29, s43
  s_mov_b32 s30, 0x1c00
  s_mov_b32 s31, 0x20000
  v_lshrrev_b32 v32, 2, v0
  v_and_b32 v33, 3, v0
  v_bfe_u32 v34, v32, 1, 3
  v_and_b32 v35, 1, v32
  v_lshrrev_b32 v36, 4, v32
  v_mul_u32_u24 v37, 896, v34
  v_lshrrev_b32 v38, 1, v36
  v_lshl_add_u32 v37, v38, 6, v37
  v_and_b32 v38, 1, v33
  v_lshl_add_u32 v37, v38, 5, v37
  v_and_b32 v38, 1, v36
  v_lshl_add_u32 v37, v38, 4, v37
  v_lshrrev_b32 v38, 1, v33
  v_lshl_add_u32 v37, v38, 3, v37
  v_lshl_add_u32 v37, v35, 2, v37
  buffer_load_dword v40, v37, s[28:31], 0 offen offset:0
  buffer_load_dword v41, v37, s[28:31], 0 offen offset:128
  buffer_load_dword v42, v37, s[28:31], 0 offen offset:256
  buffer_load_dword v43, v37, s[28:31], 0 offen offset:384
  buffer_load_dword v44, v37, s[28:31], 0 offen offset:512
  buffer_load_dword v45, v37, s[28:31], 0 offen offset:640
  buffer_load_dword v46, v37, s[28:31], 0 offen offset:768
  v_bfe_u32 v33, v0, 2, 3
  v_mul_u32_u24 v35, 896, v33
  v_lshrrev_b32 v36, 7, v0
  v_lshl_add_u32 v35, v36, 6, v35
  v_bfe_u32 v36, v0, 1, 1
  v_lshl_add_u32 v35, v36, 5, v35
  v_bfe_u32 v36, v0, 5, 2
  v_lshl_add_u32 v35, v36, 3, v35
  v_and_b32 v36, 1, v0
  v_lshl_add_u32 v35, v36, 2, v35
  buffer_load_dword v48, v35, s[28:31], 0 offen offset:0
  buffer_load_dword v49, v35, s[28:31], 0 offen offset:128
  buffer_load_dword v50, v35, s[28:31], 0 offen offset:256
  buffer_load_dword v51, v35, s[28:31], 0 offen offset:384
  buffer_load_dword v52, v35, s[28:31], 0 offen offset:512
  buffer_load_dword v53, v35, s[28:31], 0 offen offset:640
  buffer_load_dword v54, v35, s[28:31], 0 offen offset:768
  v_lshlrev_b32 v32, 2, v0
  s_waitcnt vmcnt(0)
  s_mov_b32 s70, 76627968
  buffer_store_dword v40, v32, s[12:15], s70 offen sc1
  s_mov_b32 s70, 76628992
  buffer_store_dword v41, v32, s[12:15], s70 offen sc1
  s_mov_b32 s70, 76630016
  buffer_store_dword v42, v32, s[12:15], s70 offen sc1
  s_mov_b32 s70, 76631040
  buffer_store_dword v43, v32, s[12:15], s70 offen sc1
  s_mov_b32 s70, 76632064
  buffer_store_dword v44, v32, s[12:15], s70 offen sc1
  s_mov_b32 s70, 76633088
  buffer_store_dword v45, v32, s[12:15], s70 offen sc1
  s_mov_b32 s70, 76634112
  buffer_store_dword v46, v32, s[12:15], s70 offen sc1
  s_mov_b32 s70, 76635136
  buffer_store_dword v48, v32, s[12:15], s70 offen sc1
  s_mov_b32 s70, 76636160
  buffer_store_dword v49, v32, s[12:15], s70 offen sc1
  s_mov_b32 s70, 76637184
  buffer_store_dword v50, v32, s[12:15], s70 offen sc1
  s_mov_b32 s70, 76638208
  buffer_store_dword v51, v32, s[12:15], s70 offen sc1
  s_mov_b32 s70, 76639232
  buffer_store_dword v52, v32, s[12:15], s70 offen sc1
  s_mov_b32 s70, 76640256
  buffer_store_dword v53, v32, s[12:15], s70 offen sc1
  s_mov_b32 s70, 76641280
  buffer_store_dword v54, v32, s[12:15], s70 offen sc1
  s_mov_b32 s70, 76642304
  buffer_store_dword v40, v32, s[12:15], s70 offen sc1
  s_mov_b32 s70, 76643328
  buffer_store_dword v41, v32, s[12:15], s70 offen sc1
  s_mov_b32 s70, 76644352
  buffer_store_dword v42, v32, s[12:15], s70 offen sc1
  s_mov_b32 s70, 76645376
  buffer_store_dword v43, v32, s[12:15], s70 offen sc1
  s_mov_b32 s70, 76646400
  buffer_store_dword v44, v32, s[12:15], s70 offen sc1
  s_mov_b32 s70, 76647424
  buffer_store_dword v45, v32, s[12:15], s70 offen sc1
  s_mov_b32 s70, 76648448
  buffer_store_dword v46, v32, s[12:15], s70 offen sc1
  s_mov_b32 s70, 76649472
  buffer_store_dword v48, v32, s[12:15], s70 offen sc1
  s_mov_b32 s70, 76650496
  buffer_store_dword v49, v32, s[12:15], s70 offen sc1
  s_mov_b32 s70, 76651520
  buffer_store_dword v50, v32, s[12:15], s70 offen sc1
  s_mov_b32 s70, 76652544
  buffer_store_dword v51, v32, s[12:15], s70 offen sc1
  s_mov_b32 s70, 76653568
  buffer_store_dword v52, v32, s[12:15], s70 offen sc1
  s_mov_b32 s70, 76654592
  buffer_store_dword v53, v32, s[12:15], s70 offen sc1
  s_mov_b32 s70, 76655616
  buffer_store_dword v54, v32, s[12:15], s70 offen sc1
  s_mov_b32 s70, 85803008
  buffer_store_dword v40, v32, s[12:15], s70 offen sc1
  s_mov_b32 s70, 85804032
  buffer_store_dword v41, v32, s[12:15], s70 offen sc1
  s_mov_b32 s70, 85805056
  buffer_store_dword v42, v32, s[12:15], s70 offen sc1
  s_mov_b32 s70, 85806080
  buffer_store_dword v43, v32, s[12:15], s70 offen sc1
  s_mov_b32 s70, 85807104
  buffer_store_dword v44, v32, s[12:15], s70 offen sc1
  s_mov_b32 s70, 85808128
  buffer_store_dword v45, v32, s[12:15], s70 offen sc1
  s_mov_b32 s70, 85809152
  buffer_store_dword v46, v32, s[12:15], s70 offen sc1
  s_mov_b32 s70, 85835776
  buffer_store_dword v40, v32, s[12:15], s70 offen sc1
  s_mov_b32 s70, 85836800
  buffer_store_dword v41, v32, s[12:15], s70 offen sc1
  s_mov_b32 s70, 85837824
  buffer_store_dword v42, v32, s[12:15], s70 offen sc1
  s_mov_b32 s70, 85838848
  buffer_store_dword v43, v32, s[12:15], s70 offen sc1
  s_mov_b32 s70, 85839872
  buffer_store_dword v44, v32, s[12:15], s70 offen sc1
  s_mov_b32 s70, 85840896
  buffer_store_dword v45, v32, s[12:15], s70 offen sc1
  s_mov_b32 s70, 85841920
  buffer_store_dword v46, v32, s[12:15], s70 offen sc1
P0_END:
  s_waitcnt vmcnt(0)
  s_barrier
  s_cmp_lg_u32 s3, 0
  s_cbranch_scc1 TK_WAIT
  v_mov_b32 v251, s90
  s_lshr_b32 s20, s2, 3
  s_lshl_b32 s20, s20, 7
  s_and_b32 s21, s2, 7
  s_lshl_b32 s21, s21, 2
  s_add_u32 s20, s20, s21
  s_add_u32 s20, s20, 17895424
  buffer_store_dword v251, off, s[12:15], s20 sc1
  v_lshrrev_b32 v16, 1, v1
  v_lshlrev_b32 v16, 7, v16
  v_and_b32 v17, 1, v1
  v_lshl_add_u32 v16, v17, 4, v16
  s_mov_b32 s58, 17899520
  s_mov_b32 s59, 0
TA_L:
  buffer_load_dwordx4 v[12:15], v16, s[12:15], s58 offen sc1
  s_add_u32 s59, s59, 1
  s_cmp_gt_u32 s59, 131072
  s_mov_b32 s99, 17
  s_cbranch_scc1 FAIL
  s_waitcnt vmcnt(0)
  v_subrev_u32 v12, s90, v12
  v_subrev_u32 v13, s90, v13
  v_subrev_u32 v14, s90, v14
  v_subrev_u32 v15, s90, v15
  s_mov_b32 s21, 0
  v_cmp_eq_u32 vcc, s19, v12
  s_bcnt1_i32_b64 s20, vcc
  s_add_u32 s21, s21, s20
  v_cmp_eq_u32 vcc, s19, v13
  s_bcnt1_i32_b64 s20, vcc
  s_add_u32 s21, s21, s20
  v_cmp_eq_u32 vcc, s19, v14
  s_bcnt1_i32_b64 s20, vcc
  s_add_u32 s21, s21, s20
  v_cmp_eq_u32 vcc, s19, v15
  s_bcnt1_i32_b64 s20, vcc
  s_add_u32 s21, s21, s20
  s_cmp_eq_u32 s21, 32
  s_cbranch_scc1 TA_OK
  v_or3_b32 v17, v12, v13, v14
  v_or_b32 v17, v17, v15
  v_cmp_lt_u32 vcc, 7, v17
  s_cbranch_vccz TA_OK
  s_sleep 1
  s_branch TA_L
TA_OK:
  s_mov_b32 s91, 0
  v_cmp_eq_u32 vcc, s19, v12
  s_add_u32 s20, s2, 3
  s_lshr_b32 s20, s20, 2
  s_bfm_b64 s[56:57], s20, 0
  s_cmp_eq_u32 s20, 64
  s_cselect_b64 s[56:57], -1, s[56:57]
  s_and_b64 s[56:57], s[56:57], vcc
  s_bcnt1_i32_b64 s20, s[56:57]
  s_add_u32 s91, s91, s20
  v_cmp_eq_u32 vcc, s19, v13
  s_add_u32 s20, s2, 2
  s_lshr_b32 s20, s20, 2
  s_bfm_b64 s[56:57], s20, 0
  s_cmp_eq_u32 s20, 64
  s_cselect_b64 s[56:57], -1, s[56:57]
  s_and_b64 s[56:57], s[56:57], vcc
  s_bcnt1_i32_b64 s20, s[56:57]
  s_add_u32 s91, s91, s20
  v_cmp_eq_u32 vcc, s19, v14
  s_add_u32 s20, s2, 1
  s_lshr_b32 s20, s20, 2
  s_bfm_b64 s[56:57], s20, 0
  s_cmp_eq_u32 s20, 64
  s_cselect_b64 s[56:57], -1, s[56:57]
  s_and_b64 s[56:57], s[56:57], vcc
  s_bcnt1_i32_b64 s20, s[56:57]
  s_add_u32 s91, s91, s20
  v_cmp_eq_u32 vcc, s19, v15
  s_add_u32 s20, s2, 0
  s_lshr_b32 s20, s20, 2
  s_bfm_b64 s[56:57], s20, 0
  s_cmp_eq_u32 s20, 64
  s_cselect_b64 s[56:57], -1, s[56:57]
  s_and_b64 s[56:57], s[56:57], vcc
  s_bcnt1_i32_b64 s20, s[56:57]
  s_add_u32 s91, s91, s20
  v_mov_b32 v3, 0
  v_mov_b32 v12, s91
  v_mov_b32 v13, s90
  ds_write_b64 v3, v[12:13]
  s_waitcnt lgkmcnt(0)
TK_WAIT:
  s_barrier
  v_mov_b32 v3, 0
  ds_read_b64 v[12:13], v3
  s_waitcnt lgkmcnt(0)
  v_readfirstlane_b32 s91, v12
  v_readfirstlane_b32 s90, v13
  s_barrier
  s_mov_b32 s20, s91
  s_cmp_ge_u32 s20, 32
  s_cbranch_scc1 END
  s_cmp_ge_u32 s19, 2
  s_cbranch_scc1 NOT_R
  s_mov_b32 s16, s19
  s_mov_b32 s17, s20
  s_cmp_lt_u32 s20, 16
  s_cbranch_scc1 RA
  s_sub_u32 s17, s20, 16
  s_cmp_lt_u32 s20, 30
  s_cbranch_scc1 RB
  s_sub_u32 s17, s20, 30
  s_branch PF
NOT_R:
  s_cmp_ge_u32 s19, 4
  s_cbranch_scc1 NOT_PA
  s_and_b32 s17, s20, 7
  s_and_b32 s21, s19, 1
  s_lshl_b32 s21, s21, 3
  s_add_u32 s17, s17, s21
  s_lshr_b32 s16, s20, 4
  s_bfe_u32 s18, s20, 0x10003
  s_branch PA
NOT_PA:
  s_and_b32 s21, s19, 1
  s_cmp_lt_u32 s20, 25
  s_cbranch_scc1 PB_MID
  s_mul_i32 s17, s21, 7
  s_add_u32 s17, s17, s20
  s_sub_u32 s17, s17, 25
  s_mov_b32 s16, 0
  s_cmp_lt_u32 s19, 6
  s_cselect_b32 s18, 1, 0
  s_branch PB
PB_MID:
  s_cmp_ge_u32 s19, 6
  s_cbranch_scc1 PB_HI
  s_cmp_ge_u32 s20, 22
  s_cbranch_scc1 PB_LO
  s_mov_b32 s16, s21
  s_mul_i32 s18, s20, 37
  s_lshr_b32 s18, s18, 8
  s_mul_i32 s22, s18, 7
  s_sub_u32 s17, s20, s22
  s_cmp_eq_u32 s20, 21
  s_cselect_b32 s17, 7, s17
  s_cselect_b32 s18, 0, s18
  s_branch FF
PB_LO:
  s_mul_i32 s21, s21, 3
  s_add_u32 s21, s21, 28
  s_add_u32 s21, s21, s20
  s_branch PB_IDX
PB_HI:
  s_mul_i32 s21, s21, 25
  s_add_u32 s21, s21, s20
PB_IDX:
  s_lshr_b32 s17, s21, 2
  s_and_b32 s22, s21, 3
  s_sub_u32 s18, s22, 1
  s_cmp_eq_u32 s22, 0
  s_cselect_b32 s16, 0, 1
  s_cselect_b32 s18, 2, s18
  s_branch PB
FAIL:
  s_lshl_b32 s99, s99, 2
  v_mov_b32 v3, s2
  v_add_u32 v3, 1, v3
  buffer_store_dword v3, off, s[92:95], s99 offset:160
END:
  s_endpgm
RA:
  v_lshlrev_b32 v2, 4, v1
  s_lshl_b32 s34, s17, 2
  s_add_u32 s34, s34, s3
  s_mul_i32 s20, s34, 100352
  s_lshl_b32 s56, s17, 1
  v_mov_b32 v12, s56
  v_and_b32 v13, 15, v1
  v_min_u32 v13, 4, v13
  v_lshlrev_b32 v13, 2, v13
  v_lshl_add_u32 v12, v12, 7, v13
  s_mov_b32 s58, 17903616
  s_mov_b32 s59, 0
  s_mov_b32 s56, 0x7f
  s_sleep 32
  s_sleep 32
  s_sleep 32
  s_sleep 32
RA_WL:
  buffer_load_dword v13, v12, s[12:15], s58 offen sc1
  s_add_u32 s59, s59, 1
  s_cmp_gt_u32 s59, 131072
  s_mov_b32 s99, 18
  s_cbranch_scc1 FAIL
  s_waitcnt vmcnt(0)
  v_subrev_u32 v13, s90, v13
  v_cmp_gt_u32 vcc, 8, v13
  s_nop 1
  v_cndmask_b32 v13, 0, v13, vcc
  s_mov_b32 s55, 0
  v_cmp_gt_u32 vcc, 1, v13
  s_cmp_eq_u64 vcc, 0
  s_cselect_b32 s55, 3, s55
  v_cmp_gt_u32 vcc, 2, v13
  s_cmp_eq_u64 vcc, 0
  s_cselect_b32 s55, 15, s55
  v_cmp_gt_u32 vcc, 3, v13
  s_cmp_eq_u64 vcc, 0
  s_cselect_b32 s55, 63, s55
  v_cmp_gt_u32 vcc, 4, v13
  s_cmp_eq_u64 vcc, 0
  s_cselect_b32 s55, 127, s55
  s_lshl_b32 s54, s55, 7
  s_or_b32 s55, s55, s54
  s_lshl_b32 s54, s3, 1
  s_lshr_b32 s55, s55, s54
  s_and_b32 s55, s55, s56
  s_andn2_b32 s56, s56, s55
  s_bitcmp1_b32 s55, 0
  s_cbranch_scc0 RA_WS0
  s_lshl_b32 s53, s3, 1
  s_add_u32 s54, s53, 0
  s_cmp_ge_u32 s54, 7
  s_cselect_b32 s54, 7, 0
  s_sub_u32 s53, s53, s54
  s_mul_i32 s53, s53, 14336
  s_add_u32 s53, s53, s20
  s_add_u32 s57, s53, 0
  buffer_load_dwordx4 a[0:3], v2, s[12:15], s57 offen offset:0
  buffer_load_dwordx4 a[4:7], v2, s[12:15], s57 offen offset:1024
  buffer_load_dwordx4 a[8:11], v2, s[12:15], s57 offen offset:2048
  buffer_load_dwordx4 a[12:15], v2, s[12:15], s57 offen offset:3072
  s_add_u32 s57, s53, 4096
  buffer_load_dwordx4 a[16:19], v2, s[12:15], s57 offen offset:0
  buffer_load_dwordx4 a[20:23], v2, s[12:15], s57 offen offset:1024
  buffer_load_dwordx4 a[24:27], v2, s[12:15], s57 offen offset:2048
  buffer_load_dwordx4 a[28:31], v2, s[12:15], s57 offen offset:3072
  s_add_u32 s57, s53, 8192
  buffer_load_dwordx4 a[32:35], v2, s[12:15], s57 offen offset:0
  buffer_load_dwordx4 a[36:39], v2, s[12:15], s57 offen offset:1024
  buffer_load_dwordx4 a[40:43], v2, s[12:15], s57 offen offset:2048
  buffer_load_dwordx4 a[44:47], v2, s[12:15], s57 offen offset:3072
  s_add_u32 s57, s53, 12288
  buffer_load_dwordx4 a[48:51], v2, s[12:15], s57 offen offset:0
  buffer_load_dwordx4 a[52:55], v2, s[12:15], s57 offen offset:1024
RA_WS0:
  s_bitcmp1_b32 s55, 1
  s_cbranch_scc0 RA_WS1
  s_lshl_b32 s53, s3, 1
  s_add_u32 s54, s53, 1
  s_cmp_ge_u32 s54, 7
  s_cselect_b32 s54, 7, 0
  s_sub_u32 s53, s53, s54
  s_mul_i32 s53, s53, 14336
  s_add_u32 s53, s53, s20
  s_add_u32 s57, s53, 12288
  buffer_load_dwordx4 a[56:59], v2, s[12:15], s57 offen offset:2048
  buffer_load_dwordx4 a[60:63], v2, s[12:15], s57 offen offset:3072
  s_add_u32 s57, s53, 16384
  buffer_load_dwordx4 a[64:67], v2, s[12:15], s57 offen offset:0
  buffer_load_dwordx4 a[68:71], v2, s[12:15], s57 offen offset:1024
  buffer_load_dwordx4 a[72:75], v2, s[12:15], s57 offen offset:2048
  buffer_load_dwordx4 a[76:79], v2, s[12:15], s57 offen offset:3072
  s_add_u32 s57, s53, 20480
  buffer_load_dwordx4 a[80:83], v2, s[12:15], s57 offen offset:0
  buffer_load_dwordx4 a[84:87], v2, s[12:15], s57 offen offset:1024
  buffer_load_dwordx4 a[88:91], v2, s[12:15], s57 offen offset:2048
  buffer_load_dwordx4 a[92:95], v2, s[12:15], s57 offen offset:3072
  s_add_u32 s57, s53, 24576
  buffer_load_dwordx4 a[96:99], v2, s[12:15], s57 offen offset:0
  buffer_load_dwordx4 a[100:103], v2, s[12:15], s57 offen offset:1024
  buffer_load_dwordx4 a[104:107], v2, s[12:15], s57 offen offset:2048
  buffer_load_dwordx4 a[108:111], v2, s[12:15], s57 offen offset:3072
RA_WS1:
  s_bitcmp1_b32 s55, 2
  s_cbranch_scc0 RA_WS2
  s_lshl_b32 s53, s3, 1
  s_add_u32 s54, s53, 2
  s_cmp_ge_u32 s54, 7
  s_cselect_b32 s54, 7, 0
  s_sub_u32 s53, s53, s54
  s_mul_i32 s53, s53, 14336
  s_add_u32 s53, s53, s20
  s_add_u32 s57, s53, 28672
  buffer_load_dwordx4 a[112:115], v2, s[12:15], s57 offen offset:0
  buffer_load_dwordx4 a[116:119], v2, s[12:15], s57 offen offset:1024
  buffer_load_dwordx4 a[120:123], v2, s[12:15], s57 offen offset:2048
  buffer_load_dwordx4 a[124:127], v2, s[12:15], s57 offen offset:3072
  s_add_u32 s57, s53, 32768
  buffer_load_dwordx4 a[128:131], v2, s[12:15], s57 offen offset:0
  buffer_load_dwordx4 a[132:135], v2, s[12:15], s57 offen offset:1024
  buffer_load_dwordx4 a[136:139], v2, s[12:15], s57 offen offset:2048
  buffer_load_dwordx4 a[140:143], v2, s[12:15], s57 offen offset:3072
  s_add_u32 s57, s53, 36864
  buffer_load_dwordx4 a[144:147], v2, s[12:15], s57 offen offset:0
  buffer_load_dwordx4 a[148:151], v2, s[12:15], s57 offen offset:1024
  buffer_load_dwordx4 a[152:155], v2, s[12:15], s57 offen offset:2048
  buffer_load_dwordx4 a[156:159], v2, s[12:15], s57 offen offset:3072
  s_add_u32 s57, s53, 40960
  buffer_load_dwordx4 a[160:163], v2, s[12:15], s57 offen offset:0
  buffer_load_dwordx4 a[164:167], v2, s[12:15], s57 offen offset:1024
RA_WS2:
  s_bitcmp1_b32 s55, 3
  s_cbranch_scc0 RA_WS3
  s_lshl_b32 s53, s3, 1
  s_add_u32 s54, s53, 3
  s_cmp_ge_u32 s54, 7
  s_cselect_b32 s54, 7, 0
  s_sub_u32 s53, s53, s54
  s_mul_i32 s53, s53, 14336
  s_add_u32 s53, s53, s20
  s_add_u32 s57, s53, 40960
  buffer_load_dwordx4 a[168:171], v2, s[12:15], s57 offen offset:2048
  buffer_load_dwordx4 a[172:175], v2, s[12:15], s57 offen offset:3072
  s_add_u32 s57, s53, 45056
  buffer_load_dwordx4 a[176:179], v2, s[12:15], s57 offen offset:0
  buffer_load_dwordx4 a[180:183], v2, s[12:15], s57 offen offset:1024
  buffer_load_dwordx4 a[184:187], v2, s[12:15], s57 offen offset:2048
  buffer_load_dwordx4 a[188:191], v2, s[12:15], s57 offen offset:3072
  s_add_u32 s57, s53, 49152
  buffer_load_dwordx4 a[192:195], v2, s[12:15], s57 offen offset:0
  buffer_load_dwordx4 a[196:199], v2, s[12:15], s57 offen offset:1024
  buffer_load_dwordx4 a[200:203], v2, s[12:15], s57 offen offset:2048
  buffer_load_dwordx4 a[204:207], v2, s[12:15], s57 offen offset:3072
  s_add_u32 s57, s53, 53248
  buffer_load_dwordx4 a[208:211], v2, s[12:15], s57 offen offset:0
  buffer_load_dwordx4 a[212:215], v2, s[12:15], s57 offen offset:1024
  buffer_load_dwordx4 a[216:219], v2, s[12:15], s57 offen offset:2048
  buffer_load_dwordx4 a[220:223], v2, s[12:15], s57 offen offset:3072
RA_WS3:
  s_bitcmp1_b32 s55, 4
  s_cbranch_scc0 RA_WS4
  s_lshl_b32 s53, s3, 1
  s_add_u32 s54, s53, 4
  s_cmp_ge_u32 s54, 7
  s_cselect_b32 s54, 7, 0
  s_sub_u32 s53, s53, s54
  s_mul_i32 s53, s53, 14336
  s_add_u32 s53, s53, s20
  s_add_u32 s57, s53, 57344
  buffer_load_dwordx4 a[224:227], v2, s[12:15], s57 offen offset:0
  buffer_load_dwordx4 a[228:231], v2, s[12:15], s57 offen offset:1024
  buffer_load_dwordx4 a[232:235], v2, s[12:15], s57 offen offset:2048
  buffer_load_dwordx4 a[236:239], v2, s[12:15], s57 offen offset:3072
  s_add_u32 s57, s53, 61440
  buffer_load_dwordx4 a[240:243], v2, s[12:15], s57 offen offset:0
  buffer_load_dwordx4 a[244:247], v2, s[12:15], s57 offen offset:1024
  buffer_load_dwordx4 a[248:251], v2, s[12:15], s57 offen offset:2048
  buffer_load_dwordx4 a[252:255], v2, s[12:15], s57 offen offset:3072
  s_add_u32 s57, s53, 65536
  buffer_load_dwordx4 v[120:123], v2, s[12:15], s57 offen offset:0
  buffer_load_dwordx4 v[124:127], v2, s[12:15], s57 offen offset:1024
  buffer_load_dwordx4 v[128:131], v2, s[12:15], s57 offen offset:2048
  buffer_load_dwordx4 v[132:135], v2, s[12:15], s57 offen offset:3072
  s_add_u32 s57, s53, 69632
  buffer_load_dwordx4 v[136:139], v2, s[12:15], s57 offen offset:0
  buffer_load_dwordx4 v[140:143], v2, s[12:15], s57 offen offset:1024
RA_WS4:
  s_bitcmp1_b32 s55, 5
  s_cbranch_scc0 RA_WS5
  s_lshl_b32 s53, s3, 1
  s_add_u32 s54, s53, 5
  s_cmp_ge_u32 s54, 7
  s_cselect_b32 s54, 7, 0
  s_sub_u32 s53, s53, s54
  s_mul_i32 s53, s53, 14336
  s_add_u32 s53, s53, s20
  s_add_u32 s57, s53, 69632
  buffer_load_dwordx4 v[144:147], v2, s[12:15], s57 offen offset:2048
  buffer_load_dwordx4 v[148:151], v2, s[12:15], s57 offen offset:3072
  s_add_u32 s57, s53, 73728
  buffer_load_dwordx4 v[152:155], v2, s[12:15], s57 offen offset:0
  buffer_load_dwordx4 v[156:159], v2, s[12:15], s57 offen offset:1024
  buffer_load_dwordx4 v[160:163], v2, s[12:15], s57 offen offset:2048
  buffer_load_dwordx4 v[164:167], v2, s[12:15], s57 offen offset:3072
  s_add_u32 s57, s53, 77824
  buffer_load_dwordx4 v[168:171], v2, s[12:15], s57 offen offset:0
  buffer_load_dwordx4 v[172:175], v2, s[12:15], s57 offen offset:1024
  buffer_load_dwordx4 v[176:179], v2, s[12:15], s57 offen offset:2048
  buffer_load_dwordx4 v[180:183], v2, s[12:15], s57 offen offset:3072
  s_add_u32 s57, s53, 81920
  buffer_load_dwordx4 v[184:187], v2, s[12:15], s57 offen offset:0
  buffer_load_dwordx4 v[188:191], v2, s[12:15], s57 offen offset:1024
  buffer_load_dwordx4 v[192:195], v2, s[12:15], s57 offen offset:2048
  buffer_load_dwordx4 v[196:199], v2, s[12:15], s57 offen offset:3072
RA_WS5:
  s_bitcmp1_b32 s55, 6
  s_cbranch_scc0 RA_WS6
  s_lshl_b32 s53, s3, 1
  s_add_u32 s54, s53, 6
  s_cmp_ge_u32 s54, 7
  s_cselect_b32 s54, 7, 0
  s_sub_u32 s53, s53, s54
  s_mul_i32 s53, s53, 14336
  s_add_u32 s53, s53, s20
  s_add_u32 s57, s53, 86016
  buffer_load_dwordx4 v[200:203], v2, s[12:15], s57 offen offset:0
  buffer_load_dwordx4 v[204:207], v2, s[12:15], s57 offen offset:1024
  buffer_load_dwordx4 v[208:211], v2, s[12:15], s57 offen offset:2048
  buffer_load_dwordx4 v[212:215], v2, s[12:15], s57 offen offset:3072
  s_add_u32 s57, s53, 90112
  buffer_load_dwordx4 v[216:219], v2, s[12:15], s57 offen offset:0
  buffer_load_dwordx4 v[220:223], v2, s[12:15], s57 offen offset:1024
  buffer_load_dwordx4 v[224:227], v2, s[12:15], s57 offen offset:2048
  buffer_load_dwordx4 v[228:231], v2, s[12:15], s57 offen offset:3072
  s_add_u32 s57, s53, 94208
  buffer_load_dwordx4 v[232:235], v2, s[12:15], s57 offen offset:0
  buffer_load_dwordx4 v[236:239], v2, s[12:15], s57 offen offset:1024
  buffer_load_dwordx4 v[240:243], v2, s[12:15], s57 offen offset:2048
  buffer_load_dwordx4 v[244:247], v2, s[12:15], s57 offen offset:3072
  s_add_u32 s57, s53, 98304
  buffer_load_dwordx4 v[248:251], v2, s[12:15], s57 offen offset:0
  buffer_load_dwordx4 v[252:255], v2, s[12:15], s57 offen offset:1024
RA_WS6:
  s_cmp_eq_u32 s56, 0
  s_cbranch_scc1 RA_WE
  s_sleep 3
  s_branch RA_WL
RA_WE:
  s_waitcnt vmcnt(0)
  s_cmp_lg_u32 s3, 0
  s_cbranch_scc1 RA_TA_B
  v_lshrrev_b32 v16, 1, v1
  v_lshlrev_b32 v16, 7, v16
  v_and_b32 v17, 1, v1
  v_lshl_add_u32 v16, v17, 4, v16
  s_mov_b32 s58, 17895424
  s_mov_b32 s59, 0
RA_TA_L:
  buffer_load_dwordx4 v[12:15], v16, s[12:15], s58 offen sc1
  s_add_u32 s59, s59, 1
  s_cmp_gt_u32 s59, 131072
  s_mov_b32 s99, 18
  s_cbranch_scc1 FAIL
  s_waitcnt vmcnt(0)
  v_xor_b32 v12, s90, v12
  v_xor_b32 v13, s90, v13
  v_xor_b32 v14, s90, v14
  v_xor_b32 v15, s90, v15
  v_or3_b32 v12, v12, v13, v14
  v_or_b32 v12, v12, v15
  v_cmp_ne_u32 vcc, 0, v12
  s_cbranch_vccz RA_TA_B
  s_sleep 4
  s_branch RA_TA_L
RA_TA_B:
  s_barrier
  v_lshlrev_b32 v2, 4, v1
  s_lshl_b32 s20, s3, 1
  s_add_u32 s20, s20, 0
  s_cmp_ge_u32 s20, 7
  s_cselect_b32 s21, 7, 0
  s_sub_u32 s20, s20, s21
  s_lshl_b32 s20, s20, 10
  v_add_u32 v3, s20, v2
  s_lshl_b32 s20, s3, 1
  s_add_u32 s20, s20, 1
  s_cmp_ge_u32 s20, 7
  s_cselect_b32 s21, 7, 0
  s_sub_u32 s20, s20, s21
  s_lshl_b32 s20, s20, 10
  v_add_u32 v4, s20, v2
  s_lshl_b32 s20, s3, 1
  s_add_u32 s20, s20, 2
  s_cmp_ge_u32 s20, 7
  s_cselect_b32 s21, 7, 0
  s_sub_u32 s20, s20, s21
  s_lshl_b32 s20, s20, 10
  v_add_u32 v32, s20, v2
  s_lshl_b32 s20, s3, 1
  s_add_u32 s20, s20, 3
  s_cmp_ge_u32 s20, 7
  s_cselect_b32 s21, 7, 0
  s_sub_u32 s20, s20, s21
  s_lshl_b32 s20, s20, 10
  v_add_u32 v33, s20, v2
  s_lshl_b32 s20, s3, 1
  s_add_u32 s20, s20, 4
  s_cmp_ge_u32 s20, 7
  s_cselect_b32 s21, 7, 0
  s_sub_u32 s20, s20, s21
  s_lshl_b32 s20, s20, 10
  v_add_u32 v34, s20, v2
  s_lshl_b32 s20, s3, 1
  s_add_u32 s20, s20, 5
  s_cmp_ge_u32 s20, 7
  s_cselect_b32 s21, 7, 0
  s_sub_u32 s20, s20, s21
  s_lshl_b32 s20, s20, 10
  v_add_u32 v35, s20, v2
  s_lshl_b32 s20, s3, 1
  s_add_u32 s20, s20, 6
  s_cmp_ge_u32 s20, 7
  s_cselect_b32 s21, 7, 0
  s_sub_u32 s20, s20, s21
  s_lshl_b32 s20, s20, 10
  v_add_u32 v36, s20, v2
  v_and_b32 v6, 1, v1
  v_cmp_eq_u32 vcc, 0, v6
  v_mov_b32 v5, 0xeeee
  v_mov_b32 v6, 0x4444
  v_cndmask_b32 v5, v5, v6, vcc
  v_and_b32 v6, 14, v1
  v_lshlrev_b32 v8, 4, v6
  v_lshrrev_b32 v6, 5, v1
  v_lshl_add_u32 v8, v6, 8, v8
  v_bfe_u32 v6, v1, 4, 1
  v_lshl_add_u32 v8, v6, 3, v8
  s_lshr_b32 s27, s3, 1
  s_mul_i32 s27, s27, 7
  s_add_u32 s27, s27, 3
  s_and_b32 s28, s3, 1
  s_lshl_b32 s29, s27, 10
  s_lshl_b32 s30, s28, 3
  s_add_u32 s29, s29, s30
  v_add_u32 v38, s29, v2
  s_lshl_b32 s29, s27, 9
  s_lshl_b32 s30, s28, 2
  s_add_u32 s29, s29, s30
  v_add_u32 v39, s29, v8
  s_mul_i32 s27, s3, 7
  s_add_u32 s27, s27, 1
  s_lshr_b32 s27, s27, 1
  s_lshl_b32 s28, s27, 10
  s_lshl_b32 s27, s27, 9
  v_add_u32 v7, s28, v2
  v_add_u32 v8, s27, v8
  v_lshrrev_b32 v6, 4, v1
  v_lshlrev_b32 v6, 1, v6
  v_and_b32 v40, 7, v1
  v_sub_u32 v6, v40, v6
  v_mov_b32 v40, 0x3f803f80
  v_cmp_eq_u32 vcc, 0, v6
  s_nop 1
  v_cndmask_b32 v112, 0, v40, vcc
  v_cmp_eq_u32 vcc, 1, v6
  s_nop 1
  v_cndmask_b32 v113, 0, v40, vcc
  v_bfe_u32 v40, v1, 3, 1
  v_cmp_eq_u32 s[36:37], 1, v40
  v_lshlrev_b32 v6, 1, v40
  v_and_b32 v40, 1, v1
  v_lshl_add_u32 v6, v40, 2, v6
  v_lshrrev_b32 v40, 5, v1
  v_lshl_add_u32 v6, v40, 3, v6
  v_bfe_u32 v40, v1, 1, 2
  v_lshl_add_u32 v6, v40, 4, v6
  v_lshrrev_b32 v41, 4, v1
  v_xor_b32 v40, v40, v41
  v_and_b32 v40, 1, v40
  v_add_u32 v6, v6, v40
  s_lshl_b32 s27, s3, 10
  s_add_u32 s27, s27, 22272
  v_lshl_add_u32 v9, v6, 4, s27
  s_lshl_b32 s27, s3, 8
  s_add_u32 s27, s27, 26368
  v_lshl_add_u32 v114, v6, 2, s27
  v_bfe_u32 v6, v1, 4, 1
  v_xor_b32 v6, v6, v1
  v_lshlrev_b32 v10, 4, v6
  v_add_u32 v10, 22272, v10
  v_lshlrev_b32 v115, 2, v6
  v_add_u32 v115, 26368, v115
  v_lshlrev_b32 v6, 3, v1
  s_lshr_b32 s27, s17, 2
  s_mul_i32 s27, s27, 3072
  s_bfe_u32 s28, s17, 0x10001
  s_and_b32 s29, s17, 1
  s_lshl_b32 s30, s28, 10
  s_lshl_b32 s31, s29, 9
  s_add_u32 s30, s30, s31
  s_add_u32 s30, s30, s27
  v_add_u32 v11, s30, v6
  s_lshl_b32 s30, s28, 9
  s_lshl_b32 s31, s29, 2
  s_add_u32 s30, s30, s31
  s_add_u32 s30, s30, s27
  s_add_u32 s30, s30, 2048
  v_add_u32 v0, s30, v6
  s_mul_i32 s44, s16, 32768
  s_add_u32 s44, s44, 85803008
  s_mov_b32 s22, 16056320
  s_cmp_eq_u32 s16, 1
  s_cselect_b32 s22, 78462976, s22
  s_mul_i32 s45, s16, 65536
  s_add_u32 s45, s45, 85868544
  s_mov_b32 s24, 0
  v_mov_b32 v1, 0x42800000
  v_mov_b32 v116, -1
  v_mov_b32 v117, -1
  s_lshl_b32 s38, s3, 13
  s_add_u32 s38, s38, 32768
  v_add_u32 v37, s38, v2
  s_and_b32 s39, s3, 1
  s_lshl_b32 s39, s39, 3
  s_mov_b32 s46, s22
  s_add_u32 s47, s22, 14336
  s_sub_u32 s48, s46, s39
  s_sub_u32 s49, s47, s39
  s_add_u32 m0, s38, 0
  s_nop 0
  buffer_load_dwordx4 v7, s[12:15], s46 offen offset:0 sc1 lds
  buffer_load_dwordx4 v7, s[12:15], s46 offen offset:1024 sc1 lds
  buffer_load_dwordx4 v7, s[12:15], s46 offen offset:2048 sc1 lds
  s_add_u32 m0, s38, 3072
  s_nop 0
  buffer_load_dwordx4 v38, s[12:15], s48 offen offset:0 sc1 lds
  s_add_u32 m0, s38, 4096
  s_nop 0
  buffer_load_dwordx4 v7, s[12:15], s47 offen offset:0 sc1 lds
  buffer_load_dwordx4 v7, s[12:15], s47 offen offset:1024 sc1 lds
  buffer_load_dwordx4 v7, s[12:15], s47 offen offset:2048 sc1 lds
  s_add_u32 m0, s38, 7168
  s_nop 0
  buffer_load_dwordx4 v38, s[12:15], s49 offen offset:0 sc1 lds
  s_mul_i32 s40, s16, 29360128
  s_add_u32 s40, s40, 17907712
  s_mul_i32 s43, s34, 28
  s_waitcnt vmcnt(0)
RA_STEP:
  s_mov_b32 s26, 0
  s_add_u32 s27, s22, 14336
  s_waitcnt vmcnt(2)
  s_cmp_eq_u32 s3, 0
  s_cbranch_scc1 RA_K2
  s_waitcnt vmcnt(0)
RA_K2:
  v_add_u32 v6, s39, v37
  s_add_u32 s46, s22, 28672
  s_add_u32 s47, s46, 14336
  s_sub_u32 s48, s46, s39
  s_sub_u32 s49, s47, s39
  ds_read_b128 v[84:87], v37 offset:0
  ds_read_b128 v[88:91], v37 offset:1024
  ds_read_b128 v[92:95], v37 offset:2048
  ds_read_b64 v[96:97], v6 offset:3072
  ds_read_b128 v[98:101], v37 offset:4096
  ds_read_b128 v[102:105], v37 offset:5120
  ds_read_b128 v[106:109], v37 offset:6144
  ds_read_b64 v[110:111], v6 offset:7168
  v_lshrrev_b32 v12, 4, v2
  v_min_u32 v12, 27, v12
  v_add_u32 v12, s43, v12
  v_mul_u32_u24 v13, 32768, v12
  v_lshrrev_b32 v13, 20, v13
  v_mul_u32_u24 v13, 32, v13
  v_add_lshl_u32 v12, v12, v13, 7
  buffer_load_dword v40, v12, s[12:15], s40 offen sc1
  s_add_u32 s40, s40, 458752
  s_add_u32 s21, s24, 0
  s_and_b32 s21, s21, 3
  s_lshl_b32 s21, s21, 13
  s_add_u32 s21, s21, s44
  s_add_u32 s23, s24, 0
  s_and_b32 s23, s23, 3
  s_lshl_b32 s23, s23, 14
  s_add_u32 s23, s23, s45
  s_add_u32 s41, s24, 2
  s_and_b32 s41, s41, 3
  s_lshl_b32 s41, s41, 14
  s_add_u32 s41, s41, s45
  s_cmp_eq_u32 s3, 0
  s_cselect_b32 s41, s41, 2147418112
  s_bitcmp0_b32 s17, 0
  s_cselect_b32 s42, s41, 2147418112
  v_mov_b32 v116, -1
  v_mov_b32 v117, -1
  buffer_store_dwordx2 v[116:117], v11, s[12:15], s41 offen
  buffer_store_dwordx2 v[116:117], v0, s[12:15], s42 offen
  v_mov_b32 v56, 0
  v_mov_b32 v57, 0
  v_mov_b32 v58, 0
  v_mov_b32 v59, 0
  v_mov_b32 v60, 0
  v_mov_b32 v61, 0
  v_mov_b32 v62, 0
  v_mov_b32 v63, 0
  v_mov_b32 v64, 0
  v_mov_b32 v65, 0
  v_mov_b32 v66, 0
  v_mov_b32 v67, 0
  v_mov_b32 v68, 0
  v_mov_b32 v69, 0
  v_mov_b32 v70, 0
  v_mov_b32 v71, 0
  v_mov_b32 v72, 0
  v_mov_b32 v73, 0
  v_mov_b32 v74, 0
  v_mov_b32 v75, 0
  v_mov_b32 v76, 0
  v_mov_b32 v77, 0
  v_mov_b32 v78, 0
  v_mov_b32 v79, 0
  v_mov_b32 v80, 0
  v_mov_b32 v81, 0
  v_mov_b32 v82, 0
  v_mov_b32 v83, 0
  s_waitcnt lgkmcnt(0)
  v_max3_u32 v6, v84, v85, v86
  v_max3_u32 v6, v6, v87, v88
  v_max3_u32 v6, v6, v89, v90
  v_max3_u32 v6, v6, v91, v92
  v_max3_u32 v6, v6, v93, v94
  v_max3_u32 v6, v6, v95, v96
  v_max3_u32 v6, v6, v97, v98
  v_max3_u32 v6, v6, v99, v100
  v_max3_u32 v6, v6, v101, v102
  v_max3_u32 v6, v6, v103, v104
  v_max3_u32 v6, v6, v105, v106
  v_max3_u32 v6, v6, v107, v108
  v_max3_u32 v6, v6, v109, v110
  v_max_u32 v6, v6, v111
  v_cmp_eq_u32 vcc, -1, v6
  s_cbranch_vccnz RA_KL
RA_KOK:
  s_sleep 9
  s_mov_b32 s25, 0
  buffer_load_dwordx4 v[40:43], v3, s[12:15], s21 offen sc1
  buffer_load_dwordx4 v[44:47], v4, s[12:15], s21 offen sc1
  s_nop 15
  s_nop 15
  s_nop 7
  buffer_load_dwordx4 v[48:51], v3, s[12:15], s21 offen sc1
  buffer_load_dwordx4 v[52:55], v4, s[12:15], s21 offen sc1
RA_M_L:
  s_waitcnt vmcnt(2)
  ds_write_b128 v3, v[40:43]
  v_max3_u32 v6, v40, v41, v42
  ds_write_b128 v4, v[44:47]
  v_max3_u32 v6, v6, v43, v44
  v_max3_u32 v6, v6, v45, v46
  v_max_u32 v6, v6, v47
  v_cmp_eq_u32 vcc, -1, v6
  s_cbranch_vccz RA_M_OK0
  buffer_load_dwordx4 v[40:43], v3, s[12:15], s21 offen sc1
  buffer_load_dwordx4 v[44:47], v4, s[12:15], s21 offen sc1
  s_waitcnt vmcnt(2)
  ds_write_b128 v3, v[48:51]
  v_max3_u32 v6, v48, v49, v50
  ds_write_b128 v4, v[52:55]
  v_max3_u32 v6, v6, v51, v52
  v_max3_u32 v6, v6, v53, v54
  v_max_u32 v6, v6, v55
  v_cmp_eq_u32 vcc, -1, v6
  s_cbranch_vccz RA_M_OK1
  buffer_load_dwordx4 v[48:51], v3, s[12:15], s21 offen sc1
  buffer_load_dwordx4 v[52:55], v4, s[12:15], s21 offen sc1
  s_add_u32 s25, s25, 1
  s_cmp_gt_u32 s25, 131072
  s_mov_b32 s99, 1
  s_cbranch_scc1 FAIL
  s_branch RA_M_L
RA_M_OK0:
  v_smfmac_f32_16x16x64_bf16 v[56:59], v[40:43], a[0:7], v5
  v_smfmac_f32_16x16x64_bf16 v[60:63], v[40:43], a[8:15], v5
  v_smfmac_f32_16x16x64_bf16 v[64:67], v[40:43], a[16:23], v5
  v_smfmac_f32_16x16x64_bf16 v[68:71], v[40:43], a[24:31], v5
  v_smfmac_f32_16x16x64_bf16 v[72:75], v[40:43], a[32:39], v5
  v_smfmac_f32_16x16x64_bf16 v[76:79], v[40:43], a[40:47], v5
  s_waitcnt lgkmcnt(0)
  s_barrier
  ds_read_b128 v[12:15], v32
  v_smfmac_f32_16x16x64_bf16 v[80:83], v[40:43], a[48:55], v5
  ds_read_b128 v[16:19], v33
  v_smfmac_f32_16x16x64_bf16 v[56:59], v[44:47], a[56:63], v5
  ds_read_b128 v[20:23], v34
  v_smfmac_f32_16x16x64_bf16 v[60:63], v[44:47], a[64:71], v5
  ds_read_b128 v[24:27], v35
  v_smfmac_f32_16x16x64_bf16 v[64:67], v[44:47], a[72:79], v5
  ds_read_b128 v[28:31], v36
  v_smfmac_f32_16x16x64_bf16 v[68:71], v[44:47], a[80:87], v5
  v_smfmac_f32_16x16x64_bf16 v[72:75], v[44:47], a[88:95], v5
  v_smfmac_f32_16x16x64_bf16 v[76:79], v[44:47], a[96:103], v5
  v_smfmac_f32_16x16x64_bf16 v[80:83], v[44:47], a[104:111], v5
  s_branch RA_M_DONE
RA_M_OK1:
  v_smfmac_f32_16x16x64_bf16 v[56:59], v[48:51], a[0:7], v5
  v_smfmac_f32_16x16x64_bf16 v[60:63], v[48:51], a[8:15], v5
  v_smfmac_f32_16x16x64_bf16 v[64:67], v[48:51], a[16:23], v5
  v_smfmac_f32_16x16x64_bf16 v[68:71], v[48:51], a[24:31], v5
  v_smfmac_f32_16x16x64_bf16 v[72:75], v[48:51], a[32:39], v5
  v_smfmac_f32_16x16x64_bf16 v[76:79], v[48:51], a[40:47], v5
  s_waitcnt lgkmcnt(0)
  s_barrier
  ds_read_b128 v[12:15], v32
  v_smfmac_f32_16x16x64_bf16 v[80:83], v[48:51], a[48:55], v5
  ds_read_b128 v[16:19], v33
  v_smfmac_f32_16x16x64_bf16 v[56:59], v[52:55], a[56:63], v5
  ds_read_b128 v[20:23], v34
  v_smfmac_f32_16x16x64_bf16 v[60:63], v[52:55], a[64:71], v5
  ds_read_b128 v[24:27], v35
  v_smfmac_f32_16x16x64_bf16 v[64:67], v[52:55], a[72:79], v5
  ds_read_b128 v[28:31], v36
  v_smfmac_f32_16x16x64_bf16 v[68:71], v[52:55], a[80:87], v5
  v_smfmac_f32_16x16x64_bf16 v[72:75], v[52:55], a[88:95], v5
  v_smfmac_f32_16x16x64_bf16 v[76:79], v[52:55], a[96:103], v5
  v_smfmac_f32_16x16x64_bf16 v[80:83], v[52:55], a[104:111], v5
RA_M_DONE:
  s_waitcnt lgkmcnt(0)
  v_smfmac_f32_16x16x64_bf16 v[56:59], v[12:15], a[112:119], v5
  s_add_u32 m0, s38, 0
  v_smfmac_f32_16x16x64_bf16 v[56:59], v[16:19], a[168:175], v5
  buffer_load_dwordx4 v7, s[12:15], s46 offen offset:0 sc1 lds
  v_smfmac_f32_16x16x64_bf16 v[56:59], v[20:23], a[224:231], v5
  v_add_u32 v6, 1024, v8
  v_smfmac_f32_16x16x64_bf16 v[56:59], v[24:27], v[144:151], v5
  v_smfmac_f32_16x16x64_bf16 v[56:59], v[28:31], v[200:207], v5
  v_smfmac_f32_16x16x64_bf16 v[64:67], v[12:15], a[128:135], v5
  v_smfmac_f32_16x16x64_bf16 v[64:67], v[16:19], a[184:191], v5
  v_cvt_pk_bf16_f32 v117, v58, v59
  v_smfmac_f32_16x16x64_bf16 v[60:63], v[12:15], a[120:127], v5
  v_cvt_pk_bf16_f32 v116, v56, v57
  v_smfmac_f32_16x16x64_bf16 v[64:67], v[20:23], a[240:247], v5
  buffer_load_dwordx4 v7, s[12:15], s46 offen offset:1024 sc1 lds
  v_smfmac_f32_16x16x64_bf16 v[64:67], v[24:27], v[160:167], v5
  v_smfmac_f32_16x16x64_bf16 v[60:63], v[16:19], a[176:183], v5
  v_smfmac_f32_16x16x64_bf16 v[60:63], v[20:23], a[232:239], v5
  v_smfmac_f32_16x16x64_bf16 v[64:67], v[28:31], v[216:223], v5
  s_waitcnt vmcnt(2)
  ds_read2_b32 v[40:41], v8 offset0:0 offset1:4
  v_smfmac_f32_16x16x64_bf16 v[60:63], v[24:27], v[152:159], v5
  buffer_load_dwordx4 v7, s[12:15], s46 offen offset:2048 sc1 lds
  v_mfma_f32_16x16x16_bf16 v[56:59], v[116:117], v[112:113], 0
  v_cvt_pk_bf16_f32 v116, v64, v65
  v_cvt_pk_bf16_f32 v117, v66, v67
  v_smfmac_f32_16x16x64_bf16 v[60:63], v[28:31], v[208:215], v5
  s_add_u32 m0, s38, 3072
  v_smfmac_f32_16x16x64_bf16 v[68:71], v[12:15], a[136:143], v5
  v_cvt_pk_bf16_f32 v56, v56, v57
  v_smfmac_f32_16x16x64_bf16 v[68:71], v[16:19], a[192:199], v5
  v_cvt_pk_bf16_f32 v57, v58, v59
  v_smfmac_f32_16x16x64_bf16 v[72:75], v[12:15], a[144:151], v5
  v_cvt_pk_bf16_f32 v118, v60, v61
  v_smfmac_f32_16x16x64_bf16 v[72:75], v[16:19], a[200:207], v5
  v_cvt_pk_bf16_f32 v119, v62, v63
  v_smfmac_f32_16x16x64_bf16 v[72:75], v[20:23], v[120:127], v5
  buffer_load_dwordx4 v38, s[12:15], s48 offen offset:0 sc1 lds
  v_smfmac_f32_16x16x64_bf16 v[68:71], v[20:23], a[248:255], v5
  s_add_u32 m0, s38, 4096
  v_smfmac_f32_16x16x64_bf16 v[72:75], v[24:27], v[176:183], v5
  ds_read2_b32 v[42:43], v8 offset0:1 offset1:5
  v_smfmac_f32_16x16x64_bf16 v[68:71], v[24:27], v[168:175], v5
  ds_read2_b32 v[44:45], v8 offset0:128 offset1:132
  v_mfma_f32_16x16x16_bf16 v[64:67], v[116:117], v[112:113], 0
  ds_read2_b32 v[46:47], v8 offset0:129 offset1:133
  ds_read2_b32 v[48:49], v6 offset0:0 offset1:4
  v_smfmac_f32_16x16x64_bf16 v[68:71], v[28:31], v[224:231], v5
  buffer_load_dwordx4 v7, s[12:15], s47 offen offset:0 sc1 lds
  v_smfmac_f32_16x16x64_bf16 v[76:79], v[12:15], a[152:159], v5
  v_cvt_pk_bf16_f32 v64, v64, v65
  v_smfmac_f32_16x16x64_bf16 v[72:75], v[28:31], v[232:239], v5
  v_cvt_pk_bf16_f32 v65, v66, v67
  v_smfmac_f32_16x16x64_bf16 v[76:79], v[16:19], a[208:215], v5
  ds_read2_b32 v[50:51], v6 offset0:1 offset1:5
  v_smfmac_f32_16x16x64_bf16 v[76:79], v[20:23], v[128:135], v5
  v_cvt_pk_bf16_f32 v117, v74, v75
  v_mfma_f32_16x16x16_bf16 v[60:63], v[118:119], v[112:113], 0
  v_cvt_pk_bf16_f32 v119, v70, v71
  v_cvt_pk_bf16_f32 v116, v72, v73
  v_smfmac_f32_16x16x64_bf16 v[76:79], v[24:27], v[184:191], v5
  v_cvt_pk_bf16_f32 v118, v68, v69
  v_smfmac_f32_16x16x64_bf16 v[76:79], v[28:31], v[240:247], v5
  v_cvt_pk_bf16_f32 v59, v62, v63
  v_mfma_f32_16x16x16_bf16 v[72:75], v[116:117], v[112:113], 0
  v_cvt_pk_bf16_f32 v58, v60, v61
  ds_read2_b32 v[52:53], v39 offset0:0 offset1:4
  v_mfma_f32_16x16x16_bf16 v[68:71], v[118:119], v[112:113], 0
  v_cvt_pk_bf16_f32 v119, v78, v79
  v_cvt_pk_bf16_f32 v118, v76, v77
  v_smfmac_f32_16x16x64_bf16 v[80:83], v[12:15], a[160:167], v5
  v_cvt_pk_bf16_f32 v72, v72, v73
  v_smfmac_f32_16x16x64_bf16 v[80:83], v[16:19], a[216:223], v5
  v_cvt_pk_bf16_f32 v73, v74, v75
  v_smfmac_f32_16x16x64_bf16 v[80:83], v[20:23], v[136:143], v5
  v_cvt_pk_bf16_f32 v67, v70, v71
  v_smfmac_f32_16x16x64_bf16 v[80:83], v[24:27], v[192:199], v5
  buffer_load_dwordx4 v7, s[12:15], s47 offen offset:1024 sc1 lds
  v_mfma_f32_16x16x16_bf16 v[76:79], v[118:119], v[112:113], 0
  v_cvt_pk_bf16_f32 v66, v68, v69
  v_smfmac_f32_16x16x64_bf16 v[80:83], v[28:31], v[248:255], v5
  v_mfma_f32_16x16x32_bf16 v[68:71], v[98:101], v[56:59], 0
  v_cvt_pk_bf16_f32 v75, v78, v79
  v_cvt_pk_bf16_f32 v74, v76, v77
  v_mfma_f32_16x16x32_bf16 v[68:71], v[102:105], v[64:67], v[68:71]
  v_cvt_pk_bf16_f32 v117, v82, v83
  v_cvt_pk_bf16_f32 v116, v80, v81
  s_waitcnt lgkmcnt(0)
  v_mfma_f32_16x16x32_bf16 v[76:79], v[40:43], v[56:59], 0
  buffer_load_dwordx4 v7, s[12:15], s47 offen offset:2048 sc1 lds
  s_add_u32 m0, s38, 7168
  v_mfma_f32_16x16x16_bf16 v[80:83], v[116:117], v[112:113], 0
  s_add_u32 s24, s24, 1
  s_add_u32 s22, s22, 28672
  v_mfma_f32_16x16x32_bf16 v[60:63], v[84:87], v[56:59], 0
  v_mfma_f32_16x16x32_bf16 v[60:63], v[88:91], v[64:67], v[60:63]
  v_cvt_pk_bf16_f32 v80, v80, v81
  v_cvt_pk_bf16_f32 v81, v82, v83
  v_mfma_f32_16x16x32_bf16 v[68:71], v[106:109], v[72:75], v[68:71]
  v_mfma_f32_16x16x32_bf16 v[76:79], v[44:47], v[64:67], v[76:79]
  buffer_load_dwordx4 v38, s[12:15], s49 offen offset:0 sc1 lds
  v_mfma_f32_16x16x32_bf16 v[76:79], v[48:51], v[72:75], v[76:79]
  v_mfma_f32_16x16x32_bf16 v[60:63], v[92:95], v[72:75], v[60:63]
  v_mfma_f32_16x16x16_bf16 v[76:79], v[52:53], v[80:81], v[76:79]
  v_mfma_f32_16x16x16_bf16 v[60:63], v[96:97], v[80:81], v[60:63]
  v_mfma_f32_16x16x16_bf16 v[68:71], v[110:111], v[80:81], v[68:71]
  v_cndmask_b32 v76, v76, v78, s[36:37]
  ds_write_b32 v114, v76
  s_nop 1
  v_cndmask_b32 v60, v60, v62, s[36:37]
  v_cndmask_b32 v61, v61, v63, s[36:37]
  ds_write_b64 v9, v[60:61] offset:0
  s_nop 0
  v_cndmask_b32 v69, v69, v71, s[36:37]
  v_cndmask_b32 v68, v68, v70, s[36:37]
  ds_write_b64 v9, v[68:69] offset:8
  s_cmp_lg_u32 s3, 0
  s_waitcnt lgkmcnt(0)
  s_barrier
  s_cbranch_scc1 RA_NEXT
  ds_read2st64_b32 v[72:73], v115 offset0:0 offset1:1
  ds_read2st64_b32 v[74:75], v115 offset0:2 offset1:3
  ds_read_b128 v[56:59], v10 offset:0
  ds_read_b128 v[60:63], v10 offset:1024
  ds_read_b128 v[64:67], v10 offset:2048
  ds_read_b128 v[68:71], v10 offset:3072
  s_waitcnt lgkmcnt(4)
  v_pk_add_f32 v[72:73], v[72:73], v[74:75]
  s_waitcnt lgkmcnt(2)
  v_pk_add_f32 v[56:57], v[56:57], v[60:61]
  v_add_f32 v72, v72, v73
  v_pk_add_f32 v[58:59], v[58:59], v[62:63]
  v_exp_f32 v74, v72
  s_waitcnt lgkmcnt(0)
  v_pk_add_f32 v[64:65], v[64:65], v[68:69]
  v_pk_add_f32 v[66:67], v[66:67], v[70:71]
  v_pk_add_f32 v[56:57], v[56:57], v[64:65]
  v_pk_add_f32 v[58:59], v[58:59], v[66:67]
  v_exp_f32 v60, v56
  v_exp_f32 v61, v57
  v_max3_f32 v76, |v56|, |v57|, |v72|
  v_exp_f32 v62, v58
  v_max3_f32 v76, |v58|, |v59|, v76
  v_exp_f32 v63, v59
  v_cmp_nle_f32 vcc, v76, v1
  v_add_f32 v77, v60, v61
  s_cbranch_vccnz RA_SHIFT
RA_SUM:
  v_add_f32 v76, v74, v62
  v_add_f32 v77, v77, v63
  v_add_f32 v76, v76, v77
  s_nop 1
  v_add_f32_dpp v76, v76, v76 quad_perm:[1,0,3,2] row_mask:0xf bank_mask:0xf
  s_nop 1
  v_add_f32_dpp v76, v76, v76 quad_perm:[2,3,0,1] row_mask:0xf bank_mask:0xf
  s_nop 1
  v_add_f32_dpp v76, v76, v76 row_ror:8 row_mask:0xf bank_mask:0xf
  v_rcp_f32 v76, v76
  s_nop 0
  v_pk_mul_f32 v[60:61], v[60:61], v[76:77] op_sel_hi:[1,0]
  v_pk_mul_f32 v[62:63], v[62:63], v[76:77] op_sel_hi:[1,0]
  v_mul_f32 v74, v74, v76
  v_cvt_pk_bf16_f32 v64, v60, v61
  v_cvt_pk_bf16_f32 v65, v62, v63
  buffer_store_dwordx2 v[64:65], v11, s[12:15], s23 offen
  v_cvt_pk_bf16_f32 v66, v74, v74
  buffer_store_dword v66, v0, s[12:15], s23 offen
RA_NEXT:
RA_N2:
  s_barrier
  s_cmp_lt_u32 s24, 63
  s_cbranch_scc1 RA_STEP
  s_endpgm
RA_KL:
  buffer_load_dwordx4 v[84:87], v7, s[12:15], s22 offen offset:0 sc1
  buffer_load_dwordx4 v[88:91], v7, s[12:15], s22 offen offset:1024 sc1
  buffer_load_dwordx4 v[92:95], v7, s[12:15], s22 offen offset:2048 sc1
  buffer_load_dwordx2 v[96:97], v38, s[12:15], s22 offen sc1
  buffer_load_dwordx4 v[98:101], v7, s[12:15], s27 offen offset:0 sc1
  buffer_load_dwordx4 v[102:105], v7, s[12:15], s27 offen offset:1024 sc1
  buffer_load_dwordx4 v[106:109], v7, s[12:15], s27 offen offset:2048 sc1
  buffer_load_dwordx2 v[110:111], v38, s[12:15], s27 offen sc1
  s_add_u32 s26, s26, 1
  s_cmp_gt_u32 s26, 131072
  s_mov_b32 s99, 2
  s_cbranch_scc1 FAIL
  s_waitcnt vmcnt(0)
  v_max3_u32 v6, v84, v85, v86
  v_max3_u32 v6, v6, v87, v88
  v_max3_u32 v6, v6, v89, v90
  v_max3_u32 v6, v6, v91, v92
  v_max3_u32 v6, v6, v93, v94
  v_max3_u32 v6, v6, v95, v96
  v_max3_u32 v6, v6, v97, v98
  v_max3_u32 v6, v6, v99, v100
  v_max3_u32 v6, v6, v101, v102
  v_max3_u32 v6, v6, v103, v104
  v_max3_u32 v6, v6, v105, v106
  v_max3_u32 v6, v6, v107, v108
  v_max3_u32 v6, v6, v109, v110
  v_max_u32 v6, v6, v111
  v_cmp_eq_u32 vcc, -1, v6
  s_cbranch_vccnz RA_KL
  s_branch RA_KOK
RA_SHIFT:
  v_max3_f32 v76, v56, v57, v58
  v_max3_f32 v76, v59, v72, v76
  s_nop 1
  v_max_f32_dpp v76, v76, v76 quad_perm:[1,0,3,2] row_mask:0xf bank_mask:0xf
  s_nop 1
  v_max_f32_dpp v76, v76, v76 quad_perm:[2,3,0,1] row_mask:0xf bank_mask:0xf
  s_nop 1
  v_max_f32_dpp v76, v76, v76 row_ror:8 row_mask:0xf bank_mask:0xf
  v_sub_f32 v60, v56, v76
  v_sub_f32 v61, v57, v76
  v_sub_f32 v62, v58, v76
  v_sub_f32 v63, v59, v76
  v_sub_f32 v74, v72, v76
  v_exp_f32 v60, v60
  v_exp_f32 v61, v61
  v_exp_f32 v62, v62
  v_exp_f32 v63, v63
  v_exp_f32 v74, v74
  v_add_f32 v77, v60, v61
  s_branch RA_SUM
RB:
  v_lshlrev_b32 v2, 4, v1
  s_lshl_b32 s30, s17, 2
  s_add_u32 s30, s30, s3
  s_mul_i32 s20, s30, 114688
  s_add_u32 s20, s20, 6422528
  s_mul_i32 s31, s3, 14336
  s_add_u32 s31, s31, 16384
  v_add_u32 v10, s31, v2
  v_lshrrev_b32 v12, 4, v1
  s_lshl_b32 s56, s3, 2
  v_add_u32 v12, s56, v12
  v_lshl_add_u32 v12, v12, 1, 1
  v_and_b32 v13, 15, v1
  v_min_u32 v13, 4, v13
  v_lshlrev_b32 v13, 2, v13
  v_lshl_add_u32 v12, v12, 7, v13
  s_mov_b32 s58, 17903616
  s_mov_b32 s59, 0
  s_mov_b32 s56, 0x7f
  s_sleep 32
  s_sleep 32
  s_sleep 32
  s_sleep 32
RB_WL:
  buffer_load_dword v13, v12, s[12:15], s58 offen sc1
  s_add_u32 s59, s59, 1
  s_cmp_gt_u32 s59, 131072
  s_mov_b32 s99, 18
  s_cbranch_scc1 FAIL
  s_waitcnt vmcnt(0)
  v_subrev_u32 v13, s90, v13
  v_cmp_gt_u32 vcc, 8, v13
  s_nop 1
  v_cndmask_b32 v13, 0, v13, vcc
  s_mov_b32 s55, 0
  v_cmp_gt_u32 vcc, 1, v13
  s_cmp_eq_u64 vcc, 0
  s_cselect_b32 s55, 3, s55
  v_cmp_gt_u32 vcc, 2, v13
  s_cmp_eq_u64 vcc, 0
  s_cselect_b32 s55, 15, s55
  v_cmp_gt_u32 vcc, 3, v13
  s_cmp_eq_u64 vcc, 0
  s_cselect_b32 s55, 63, s55
  v_cmp_gt_u32 vcc, 4, v13
  s_cmp_eq_u64 vcc, 0
  s_cselect_b32 s55, 127, s55
  s_lshl_b32 s54, s55, 7
  s_or_b32 s55, s55, s54
  s_lshl_b32 s54, s3, 1
  s_lshr_b32 s55, s55, s54
  s_and_b32 s55, s55, s56
  s_andn2_b32 s56, s56, s55
  s_bitcmp1_b32 s55, 0
  s_cbranch_scc0 RB_WS0
  s_lshl_b32 s53, s3, 1
  s_add_u32 s54, s53, 0
  s_cmp_ge_u32 s54, 7
  s_cselect_b32 s54, 7, 0
  s_sub_u32 s53, s53, s54
  s_mul_i32 s53, s53, 16384
  s_add_u32 s53, s53, s20
  s_add_u32 s57, s53, 0
  buffer_load_dwordx4 a[0:3], v2, s[12:15], s57 offen offset:0
  buffer_load_dwordx4 a[4:7], v2, s[12:15], s57 offen offset:1024
  buffer_load_dwordx4 a[8:11], v2, s[12:15], s57 offen offset:2048
  buffer_load_dwordx4 a[12:15], v2, s[12:15], s57 offen offset:3072
  s_add_u32 s57, s53, 4096
  buffer_load_dwordx4 a[16:19], v2, s[12:15], s57 offen offset:0
  buffer_load_dwordx4 a[20:23], v2, s[12:15], s57 offen offset:1024
  buffer_load_dwordx4 a[24:27], v2, s[12:15], s57 offen offset:2048
  buffer_load_dwordx4 a[28:31], v2, s[12:15], s57 offen offset:3072
  s_add_u32 s57, s53, 8192
  buffer_load_dwordx4 a[32:35], v2, s[12:15], s57 offen offset:0
  buffer_load_dwordx4 a[36:39], v2, s[12:15], s57 offen offset:1024
  buffer_load_dwordx4 a[40:43], v2, s[12:15], s57 offen offset:2048
  buffer_load_dwordx4 a[44:47], v2, s[12:15], s57 offen offset:3072
  s_add_u32 s57, s53, 12288
  buffer_load_dwordx4 a[48:51], v2, s[12:15], s57 offen offset:0
  buffer_load_dwordx4 a[52:55], v2, s[12:15], s57 offen offset:1024
  buffer_load_dwordx4 a[56:59], v2, s[12:15], s57 offen offset:2048
  buffer_load_dwordx4 a[60:63], v2, s[12:15], s57 offen offset:3072
RB_WS0:
  s_bitcmp1_b32 s55, 1
  s_cbranch_scc0 RB_WS1
  s_lshl_b32 s53, s3, 1
  s_add_u32 s54, s53, 1
  s_cmp_ge_u32 s54, 7
  s_cselect_b32 s54, 7, 0
  s_sub_u32 s53, s53, s54
  s_mul_i32 s53, s53, 16384
  s_add_u32 s53, s53, s20
  s_add_u32 s57, s53, 16384
  buffer_load_dwordx4 a[64:67], v2, s[12:15], s57 offen offset:0
  buffer_load_dwordx4 a[68:71], v2, s[12:15], s57 offen offset:1024
  buffer_load_dwordx4 a[72:75], v2, s[12:15], s57 offen offset:2048
  buffer_load_dwordx4 a[76:79], v2, s[12:15], s57 offen offset:3072
  s_add_u32 s57, s53, 20480
  buffer_load_dwordx4 a[80:83], v2, s[12:15], s57 offen offset:0
  buffer_load_dwordx4 a[84:87], v2, s[12:15], s57 offen offset:1024
  buffer_load_dwordx4 a[88:91], v2, s[12:15], s57 offen offset:2048
  buffer_load_dwordx4 a[92:95], v2, s[12:15], s57 offen offset:3072
  s_add_u32 s57, s53, 24576
  buffer_load_dwordx4 a[96:99], v2, s[12:15], s57 offen offset:0
  buffer_load_dwordx4 a[100:103], v2, s[12:15], s57 offen offset:1024
  buffer_load_dwordx4 a[104:107], v2, s[12:15], s57 offen offset:2048
  buffer_load_dwordx4 a[108:111], v2, s[12:15], s57 offen offset:3072
  s_add_u32 s57, s53, 28672
  buffer_load_dwordx4 a[112:115], v2, s[12:15], s57 offen offset:0
  buffer_load_dwordx4 a[116:119], v2, s[12:15], s57 offen offset:1024
  buffer_load_dwordx4 a[120:123], v2, s[12:15], s57 offen offset:2048
  buffer_load_dwordx4 a[124:127], v2, s[12:15], s57 offen offset:3072
RB_WS1:
  s_bitcmp1_b32 s55, 2
  s_cbranch_scc0 RB_WS2
  s_lshl_b32 s53, s3, 1
  s_add_u32 s54, s53, 2
  s_cmp_ge_u32 s54, 7
  s_cselect_b32 s54, 7, 0
  s_sub_u32 s53, s53, s54
  s_mul_i32 s53, s53, 16384
  s_add_u32 s53, s53, s20
  s_add_u32 s57, s53, 32768
  buffer_load_dwordx4 a[128:131], v2, s[12:15], s57 offen offset:0
  buffer_load_dwordx4 a[132:135], v2, s[12:15], s57 offen offset:1024
  buffer_load_dwordx4 a[136:139], v2, s[12:15], s57 offen offset:2048
  buffer_load_dwordx4 a[140:143], v2, s[12:15], s57 offen offset:3072
  s_add_u32 s57, s53, 36864
  buffer_load_dwordx4 a[144:147], v2, s[12:15], s57 offen offset:0
  buffer_load_dwordx4 a[148:151], v2, s[12:15], s57 offen offset:1024
  buffer_load_dwordx4 a[152:155], v2, s[12:15], s57 offen offset:2048
  buffer_load_dwordx4 a[156:159], v2, s[12:15], s57 offen offset:3072
  s_add_u32 s57, s53, 40960
  buffer_load_dwordx4 a[160:163], v2, s[12:15], s57 offen offset:0
  buffer_load_dwordx4 a[164:167], v2, s[12:15], s57 offen offset:1024
  buffer_load_dwordx4 a[168:171], v2, s[12:15], s57 offen offset:2048
  buffer_load_dwordx4 a[172:175], v2, s[12:15], s57 offen offset:3072
  s_add_u32 s57, s53, 45056
  buffer_load_dwordx4 a[176:179], v2, s[12:15], s57 offen offset:0
  buffer_load_dwordx4 a[180:183], v2, s[12:15], s57 offen offset:1024
  buffer_load_dwordx4 a[184:187], v2, s[12:15], s57 offen offset:2048
  buffer_load_dwordx4 a[188:191], v2, s[12:15], s57 offen offset:3072
RB_WS2:
  s_bitcmp1_b32 s55, 3
  s_cbranch_scc0 RB_WS3
  s_lshl_b32 s53, s3, 1
  s_add_u32 s54, s53, 3
  s_cmp_ge_u32 s54, 7
  s_cselect_b32 s54, 7, 0
  s_sub_u32 s53, s53, s54
  s_mul_i32 s53, s53, 16384
  s_add_u32 s53, s53, s20
  s_add_u32 s57, s53, 49152
  buffer_load_dwordx4 a[192:195], v2, s[12:15], s57 offen offset:0
  buffer_load_dwordx4 a[196:199], v2, s[12:15], s57 offen offset:1024
  buffer_load_dwordx4 a[200:203], v2, s[12:15], s57 offen offset:2048
  buffer_load_dwordx4 a[204:207], v2, s[12:15], s57 offen offset:3072
  s_add_u32 s57, s53, 53248
  buffer_load_dwordx4 a[208:211], v2, s[12:15], s57 offen offset:0
  buffer_load_dwordx4 a[212:215], v2, s[12:15], s57 offen offset:1024
  buffer_load_dwordx4 a[216:219], v2, s[12:15], s57 offen offset:2048
  buffer_load_dwordx4 a[220:223], v2, s[12:15], s57 offen offset:3072
  s_add_u32 s57, s53, 57344
  buffer_load_dwordx4 a[224:227], v2, s[12:15], s57 offen offset:0
  buffer_load_dwordx4 a[228:231], v2, s[12:15], s57 offen offset:1024
  buffer_load_dwordx4 a[232:235], v2, s[12:15], s57 offen offset:2048
  buffer_load_dwordx4 a[236:239], v2, s[12:15], s57 offen offset:3072
  s_add_u32 s57, s53, 61440
  buffer_load_dwordx4 a[240:243], v2, s[12:15], s57 offen offset:0
  buffer_load_dwordx4 a[244:247], v2, s[12:15], s57 offen offset:1024
  buffer_load_dwordx4 a[248:251], v2, s[12:15], s57 offen offset:2048
  buffer_load_dwordx4 a[252:255], v2, s[12:15], s57 offen offset:3072
RB_WS3:
  s_bitcmp1_b32 s55, 4
  s_cbranch_scc0 RB_WS4
  s_lshl_b32 s53, s3, 1
  s_add_u32 s54, s53, 4
  s_cmp_ge_u32 s54, 7
  s_cselect_b32 s54, 7, 0
  s_sub_u32 s53, s53, s54
  s_mul_i32 s53, s53, 16384
  s_add_u32 s53, s53, s20
  s_add_u32 s57, s53, 65536
  buffer_load_dwordx4 v[120:123], v2, s[12:15], s57 offen offset:0
  buffer_load_dwordx4 v[124:127], v2, s[12:15], s57 offen offset:1024
  buffer_load_dwordx4 v[128:131], v2, s[12:15], s57 offen offset:2048
  buffer_load_dwordx4 v[132:135], v2, s[12:15], s57 offen offset:3072
  s_add_u32 s57, s53, 69632
  buffer_load_dwordx4 v[136:139], v2, s[12:15], s57 offen offset:0
  buffer_load_dwordx4 v[140:143], v2, s[12:15], s57 offen offset:1024
  buffer_load_dwordx4 v[144:147], v2, s[12:15], s57 offen offset:2048
  buffer_load_dwordx4 v[148:151], v2, s[12:15], s57 offen offset:3072
  s_add_u32 s57, s53, 73728
  buffer_load_dwordx4 v[152:155], v2, s[12:15], s57 offen offset:0
  buffer_load_dwordx4 v[156:159], v2, s[12:15], s57 offen offset:1024
  buffer_load_dwordx4 v[160:163], v2, s[12:15], s57 offen offset:2048
  buffer_load_dwordx4 v[164:167], v2, s[12:15], s57 offen offset:3072
  s_add_u32 s57, s53, 77824
  buffer_load_dwordx4 v[168:171], v2, s[12:15], s57 offen offset:0
  buffer_load_dwordx4 v[172:175], v2, s[12:15], s57 offen offset:1024
  buffer_load_dwordx4 v[176:179], v2, s[12:15], s57 offen offset:2048
  buffer_load_dwordx4 v[180:183], v2, s[12:15], s57 offen offset:3072
RB_WS4:
  s_bitcmp1_b32 s55, 5
  s_cbranch_scc0 RB_WS5
  s_lshl_b32 s53, s3, 1
  s_add_u32 s54, s53, 5
  s_cmp_ge_u32 s54, 7
  s_cselect_b32 s54, 7, 0
  s_sub_u32 s53, s53, s54
  s_mul_i32 s53, s53, 16384
  s_add_u32 s53, s53, s20
  s_add_u32 s57, s53, 81920
  buffer_load_dwordx4 v[184:187], v2, s[12:15], s57 offen offset:0
  buffer_load_dwordx4 v[188:191], v2, s[12:15], s57 offen offset:1024
  buffer_load_dwordx4 v[192:195], v2, s[12:15], s57 offen offset:2048
  buffer_load_dwordx4 v[196:199], v2, s[12:15], s57 offen offset:3072
  s_add_u32 s57, s53, 86016
  buffer_load_dwordx4 v[200:203], v2, s[12:15], s57 offen offset:0
  buffer_load_dwordx4 v[204:207], v2, s[12:15], s57 offen offset:1024
  buffer_load_dwordx4 v[208:211], v2, s[12:15], s57 offen offset:2048
  buffer_load_dwordx4 v[212:215], v2, s[12:15], s57 offen offset:3072
  s_add_u32 s57, s53, 90112
  buffer_load_dwordx4 v[216:219], v2, s[12:15], s57 offen offset:0
  buffer_load_dwordx4 v[220:223], v2, s[12:15], s57 offen offset:1024
  buffer_load_dwordx4 v[224:227], v2, s[12:15], s57 offen offset:2048
  buffer_load_dwordx4 v[228:231], v2, s[12:15], s57 offen offset:3072
  s_add_u32 s57, s53, 94208
  buffer_load_dwordx4 v[232:235], v2, s[12:15], s57 offen offset:0
  buffer_load_dwordx4 v[236:239], v2, s[12:15], s57 offen offset:1024
  buffer_load_dwordx4 v[240:243], v2, s[12:15], s57 offen offset:2048
  buffer_load_dwordx4 v[244:247], v2, s[12:15], s57 offen offset:3072
RB_WS5:
  s_bitcmp1_b32 s55, 6
  s_cbranch_scc0 RB_WS6
  s_lshl_b32 s53, s3, 1
  s_add_u32 s54, s53, 6
  s_cmp_ge_u32 s54, 7
  s_cselect_b32 s54, 7, 0
  s_sub_u32 s53, s53, s54
  s_mul_i32 s53, s53, 16384
  s_add_u32 s53, s53, s20
  s_add_u32 s57, s53, 98304
  buffer_load_dwordx4 v[248:251], v2, s[12:15], s57 offen offset:0
  buffer_load_dwordx4 v[252:255], v2, s[12:15], s57 offen offset:1024
  s_add_u32 m0, s31, -2048
  s_nop 0
  buffer_load_dwordx4 v2, s[12:15], s57 offen offset:2048 lds
  s_add_u32 m0, s31, -2048
  s_nop 0
  buffer_load_dwordx4 v2, s[12:15], s57 offen offset:3072 lds
  s_add_u32 s57, s53, 102400
  s_add_u32 m0, s31, 2048
  s_nop 0
  buffer_load_dwordx4 v2, s[12:15], s57 offen offset:0 lds
  s_add_u32 m0, s31, 2048
  s_nop 0
  buffer_load_dwordx4 v2, s[12:15], s57 offen offset:1024 lds
  s_add_u32 m0, s31, 2048
  s_nop 0
  buffer_load_dwordx4 v2, s[12:15], s57 offen offset:2048 lds
  s_add_u32 m0, s31, 2048
  s_nop 0
  buffer_load_dwordx4 v2, s[12:15], s57 offen offset:3072 lds
  s_add_u32 s57, s53, 106496
  s_add_u32 m0, s31, 6144
  s_nop 0
  buffer_load_dwordx4 v2, s[12:15], s57 offen offset:0 lds
  s_add_u32 m0, s31, 6144
  s_nop 0
  buffer_load_dwordx4 v2, s[12:15], s57 offen offset:1024 lds
  s_add_u32 m0, s31, 6144
  s_nop 0
  buffer_load_dwordx4 v2, s[12:15], s57 offen offset:2048 lds
  s_add_u32 m0, s31, 6144
  s_nop 0
  buffer_load_dwordx4 v2, s[12:15], s57 offen offset:3072 lds
  s_add_u32 s57, s53, 110592
  s_add_u32 m0, s31, 10240
  s_nop 0
  buffer_load_dwordx4 v2, s[12:15], s57 offen offset:0 lds
  s_add_u32 m0, s31, 10240
  s_nop 0
  buffer_load_dwordx4 v2, s[12:15], s57 offen offset:1024 lds
  s_add_u32 m0, s31, 10240
  s_nop 0
  buffer_load_dwordx4 v2, s[12:15], s57 offen offset:2048 lds
  s_add_u32 m0, s31, 10240
  s_nop 0
  buffer_load_dwordx4 v2, s[12:15], s57 offen offset:3072 lds
RB_WS6:
  s_cmp_eq_u32 s56, 0
  s_cbranch_scc1 RB_WE
  s_sleep 3
  s_branch RB_WL
RB_WE:
  s_waitcnt vmcnt(0)
  s_cmp_lg_u32 s3, 0
  s_cbranch_scc1 RB_TA_B
  v_lshrrev_b32 v16, 1, v1
  v_lshlrev_b32 v16, 7, v16
  v_and_b32 v17, 1, v1
  v_lshl_add_u32 v16, v17, 4, v16
  s_mov_b32 s58, 17895424
  s_mov_b32 s59, 0
RB_TA_L:
  buffer_load_dwordx4 v[12:15], v16, s[12:15], s58 offen sc1
  s_add_u32 s59, s59, 1
  s_cmp_gt_u32 s59, 131072
  s_mov_b32 s99, 18
  s_cbranch_scc1 FAIL
  s_waitcnt vmcnt(0)
  v_xor_b32 v12, s90, v12
  v_xor_b32 v13, s90, v13
  v_xor_b32 v14, s90, v14
  v_xor_b32 v15, s90, v15
  v_or3_b32 v12, v12, v13, v14
  v_or_b32 v12, v12, v15
  v_cmp_ne_u32 vcc, 0, v12
  s_cbranch_vccz RB_TA_B
  s_sleep 4
  s_branch RB_TA_L
RB_TA_B:
  s_barrier
  v_lshlrev_b32 v2, 4, v1
  s_lshl_b32 s20, s3, 1
  s_add_u32 s20, s20, 0
  s_cmp_ge_u32 s20, 7
  s_cselect_b32 s21, 7, 0
  s_sub_u32 s20, s20, s21
  s_lshl_b32 s20, s20, 10
  v_add_u32 v3, s20, v2
  s_lshl_b32 s20, s3, 1
  s_add_u32 s20, s20, 1
  s_cmp_ge_u32 s20, 7
  s_cselect_b32 s21, 7, 0
  s_sub_u32 s20, s20, s21
  s_lshl_b32 s20, s20, 10
  v_add_u32 v4, s20, v2
  s_lshl_b32 s20, s3, 1
  s_add_u32 s20, s20, 2
  s_cmp_ge_u32 s20, 7
  s_cselect_b32 s21, 7, 0
  s_sub_u32 s20, s20, s21
  s_lshl_b32 s20, s20, 10
  v_add_u32 v32, s20, v2
  s_lshl_b32 s20, s3, 1
  s_add_u32 s20, s20, 3
  s_cmp_ge_u32 s20, 7
  s_cselect_b32 s21, 7, 0
  s_sub_u32 s20, s20, s21
  s_lshl_b32 s20, s20, 10
  v_add_u32 v33, s20, v2
  s_lshl_b32 s20, s3, 1
  s_add_u32 s20, s20, 4
  s_cmp_ge_u32 s20, 7
  s_cselect_b32 s21, 7, 0
  s_sub_u32 s20, s20, s21
  s_lshl_b32 s20, s20, 10
  v_add_u32 v34, s20, v2
  s_lshl_b32 s20, s3, 1
  s_add_u32 s20, s20, 5
  s_cmp_ge_u32 s20, 7
  s_cselect_b32 s21, 7, 0
  s_sub_u32 s20, s20, s21
  s_lshl_b32 s20, s20, 10
  v_add_u32 v35, s20, v2
  s_lshl_b32 s20, s3, 1
  s_add_u32 s20, s20, 6
  s_cmp_ge_u32 s20, 7
  s_cselect_b32 s21, 7, 0
  s_sub_u32 s20, s20, s21
  s_lshl_b32 s20, s20, 10
  v_add_u32 v36, s20, v2
  v_and_b32 v6, 1, v1
  v_cmp_eq_u32 vcc, 0, v6
  v_mov_b32 v5, 0xeeee
  v_mov_b32 v6, 0x4444
  v_cndmask_b32 v5, v5, v6, vcc
  s_mul_i32 s28, s16, 14336
  s_add_u32 s28, s28, 76627968
  s_mul_i32 s44, s16, 32768
  s_add_u32 s44, s44, 85803008
  s_mov_b32 s21, s44
  s_mul_i32 s22, s16, 29360128
  s_lshl_b32 s32, s30, 13
  s_add_u32 s22, s22, s32
  s_add_u32 s22, s22, 17907712
  s_mul_i32 s45, s16, 65536
  s_mul_i32 s32, s3, 3072
  s_add_u32 s45, s45, s32
  s_add_u32 s45, s45, 85868544
  s_mul_i32 s25, s16, 114688
  s_lshl_b32 s32, s17, 7
  s_add_u32 s25, s25, s32
  s_lshl_b32 s32, s3, 2
  s_add_u32 s25, s25, s32
  s_add_u32 s25, s25, 91242496
  v_and_b32 v6, 15, v1
  v_lshlrev_b32 v6, 2, v6
  v_lshrrev_b32 v40, 4, v1
  v_lshl_add_u32 v6, v40, 8, v6
  s_lshl_b32 s32, s3, 10
  s_add_u32 s32, s32, 8192
  v_add_u32 v7, s32, v6
  v_lshrrev_b32 v6, 5, v1
  v_lshlrev_b32 v11, 9, v6
  v_bfe_u32 v6, v1, 2, 2
  v_lshl_add_u32 v11, v6, 7, v11
  v_bfe_u32 v6, v1, 4, 1
  v_lshl_add_u32 v11, v6, 6, v11
  v_and_b32 v6, 3, v1
  v_lshl_add_u32 v11, v6, 4, v11
  v_and_b32 v6, 3, v1
  v_lshlrev_b32 v39, 9, v6
  v_and_b32 v38, 1, v1
  v_lshlrev_b32 v38, 2, v38
  v_bfe_u32 v6, v1, 1, 1
  v_lshl_add_u32 v38, v6, 9, v38
  v_add_u32 v38, 2048, v38
  v_and_b32 v6, 4, v1
  v_cmp_eq_u32 vcc, 0, v6
  s_nop 1
  v_cndmask_b32 v39, v38, v39, vcc
  v_add_u32 v39, 504, v39
  v_mov_b32 v38, -1
  v_and_b32 v40, 127, v0
  s_cmp_ge_u32 s3, 2
  s_cbranch_scc1 RB_INIT_F
  v_bfe_u32 v41, v40, 3, 3
  v_lshlrev_b32 v8, 7, v41
  v_and_b32 v41, 1, v40
  v_lshl_add_u32 v8, v41, 6, v8
  v_lshrrev_b32 v41, 6, v40
  v_lshl_add_u32 v8, v41, 5, v8
  v_bfe_u32 v41, v40, 1, 1
  v_lshl_add_u32 v8, v41, 4, v8
  v_bfe_u32 v41, v40, 2, 1
  v_lshl_add_u32 v8, v41, 3, v8
  s_lshl_b32 s32, s17, 9
  v_lshl_add_u32 v9, v40, 2, s32
  s_branch RB_INIT_D
RB_INIT_F:
  v_bfe_u32 v41, v40, 2, 3
  v_lshlrev_b32 v8, 7, v41
  v_bfe_u32 v41, v40, 1, 1
  v_lshl_add_u32 v8, v41, 6, v8
  v_lshrrev_b32 v41, 5, v40
  v_lshl_add_u32 v8, v41, 4, v8
  v_and_b32 v41, 1, v40
  v_lshl_add_u32 v8, v41, 3, v8
  s_lshl_b32 s32, s17, 9
  s_add_u32 s32, s32, 7168
  v_lshl_add_u32 v9, v40, 2, s32
RB_INIT_D:
  buffer_load_dword v1, v9, s[12:15], s28 offen sc1
  v_add_u32 v8, 8192, v8
  s_mov_b32 s26, 0
  v_mov_b32 v0, -1
  s_waitcnt vmcnt(0)
RB_STEP:
  v_cmp_eq_u32 vcc, -1, v0
  s_mov_b32 s35, 2147418112
  s_mov_b32 s32, 2147418112
  s_cbranch_vccnz RB_VE
  s_mov_b32 s35, s22
  s_add_u32 s32, s22, 4096
  buffer_load_dwordx4 v[88:91], v2, s[12:15], s35 offen offset:0 sc1
  buffer_load_dwordx4 v[92:95], v2, s[12:15], s35 offen offset:1024 sc1
  buffer_load_dwordx4 v[96:99], v2, s[12:15], s35 offen offset:2048 sc1
  buffer_load_dwordx4 v[100:103], v2, s[12:15], s35 offen offset:3072 sc1
RB_VE:
  s_cmp_eq_u32 s35, 2147418112
  s_cbranch_scc1 RB_V1
RB_V2:
  s_mov_b32 s27, 0
  buffer_load_dwordx4 v[40:43], v3, s[12:15], s21 offen sc1
  buffer_load_dwordx4 v[44:47], v4, s[12:15], s21 offen sc1
  s_add_u32 s25, s25, 1792
  s_add_u32 s33, s26, 2
  s_and_b32 s33, s33, 3
  s_lshl_b32 s33, s33, 13
  s_add_u32 s33, s33, s44
  s_cmp_lt_u32 s3, 2
  s_cselect_b32 s33, s33, 2147418112
  s_add_u32 s46, s26, 1
  s_and_b32 s46, s46, 3
  s_lshl_b32 s46, s46, 13
  s_add_u32 s46, s46, s44
  s_add_u32 s24, s26, 0
  s_and_b32 s24, s24, 3
  s_lshl_b32 s24, s24, 14
  s_add_u32 s24, s24, s45
  s_add_u32 s34, s28, 200704
  s_cmp_lt_u32 s26, 57
  s_cselect_b32 s34, s34, 2147418112
  s_waitcnt vmcnt(6)
  v_mov_b32 v56, 0
  v_mov_b32 v57, 0
  v_mov_b32 v58, 0
  v_mov_b32 v59, 0
  v_mov_b32 v60, 0
  v_mov_b32 v61, 0
  v_mov_b32 v62, 0
  v_mov_b32 v63, 0
  v_mov_b32 v64, 0
  v_mov_b32 v65, 0
  v_mov_b32 v66, 0
  v_mov_b32 v67, 0
  v_mov_b32 v68, 0
  v_mov_b32 v69, 0
  v_mov_b32 v70, 0
  v_mov_b32 v71, 0
  v_mov_b32 v72, 0
  v_mov_b32 v73, 0
  v_mov_b32 v74, 0
  v_mov_b32 v75, 0
  v_mov_b32 v76, 0
  v_mov_b32 v77, 0
  v_mov_b32 v78, 0
  v_mov_b32 v79, 0
  v_mov_b32 v80, 0
  v_mov_b32 v81, 0
  v_mov_b32 v82, 0
  v_mov_b32 v83, 0
  v_mov_b32 v84, 0
  v_mov_b32 v85, 0
  v_mov_b32 v86, 0
  v_mov_b32 v87, 0
RB_M_L:
  s_waitcnt vmcnt(0)
  ds_write_b128 v3, v[40:43]
  v_max3_u32 v6, v40, v41, v42
  ds_write_b128 v4, v[44:47]
  v_max3_u32 v6, v6, v43, v44
  v_max3_u32 v6, v6, v45, v46
  v_max_u32 v6, v6, v47
  v_cmp_eq_u32 vcc, -1, v6
  s_cbranch_vccz RB_M_OK0
  buffer_load_dwordx4 v[40:43], v3, s[12:15], s21 offen sc1
  buffer_load_dwordx4 v[44:47], v4, s[12:15], s21 offen sc1
  s_add_u32 s27, s27, 1
  s_cmp_gt_u32 s27, 131072
  s_mov_b32 s99, 4
  s_cbranch_scc1 FAIL
  s_branch RB_M_L
RB_M_OK0:
  v_smfmac_f32_16x16x64_bf16 v[56:59], v[40:43], a[0:7], v5
  buffer_load_dwordx4 v[104:107], v2, s[12:15], s32 offen offset:0 sc1
  v_smfmac_f32_16x16x64_bf16 v[60:63], v[40:43], a[8:15], v5
  buffer_load_dwordx4 v[108:111], v2, s[12:15], s32 offen offset:1024 sc1
  v_smfmac_f32_16x16x64_bf16 v[64:67], v[40:43], a[16:23], v5
  buffer_load_dwordx4 v[112:115], v2, s[12:15], s32 offen offset:2048 sc1
  v_smfmac_f32_16x16x64_bf16 v[68:71], v[40:43], a[24:31], v5
  buffer_load_dwordx4 v[116:119], v2, s[12:15], s32 offen offset:3072 sc1
  v_smfmac_f32_16x16x64_bf16 v[72:75], v[40:43], a[32:39], v5
  s_waitcnt lgkmcnt(0)
  s_barrier
  ds_read_b128 v[12:15], v32
  v_smfmac_f32_16x16x64_bf16 v[76:79], v[40:43], a[40:47], v5
  ds_read_b128 v[16:19], v33
  v_smfmac_f32_16x16x64_bf16 v[80:83], v[40:43], a[48:55], v5
  ds_read_b128 v[20:23], v34
  v_smfmac_f32_16x16x64_bf16 v[84:87], v[40:43], a[56:63], v5
  ds_read_b128 v[24:27], v35
  v_smfmac_f32_16x16x64_bf16 v[56:59], v[44:47], a[64:71], v5
  ds_read_b128 v[28:31], v36
  v_smfmac_f32_16x16x64_bf16 v[60:63], v[44:47], a[72:79], v5
  v_smfmac_f32_16x16x64_bf16 v[64:67], v[44:47], a[80:87], v5
  v_smfmac_f32_16x16x64_bf16 v[68:71], v[44:47], a[88:95], v5
  v_smfmac_f32_16x16x64_bf16 v[72:75], v[44:47], a[96:103], v5
  v_smfmac_f32_16x16x64_bf16 v[76:79], v[44:47], a[104:111], v5
  v_smfmac_f32_16x16x64_bf16 v[80:83], v[44:47], a[112:119], v5
  v_smfmac_f32_16x16x64_bf16 v[84:87], v[44:47], a[120:127], v5
RB_M_DONE:
  s_cmp_eq_u32 s35, 2147418112
  s_cbranch_scc1 RB_V3
RB_V4:
  s_waitcnt lgkmcnt(0)
  v_smfmac_f32_16x16x64_bf16 v[60:63], v[12:15], a[136:143], v5
  ds_read_b128 v[48:51], v10 offset:0
  v_smfmac_f32_16x16x64_bf16 v[64:67], v[12:15], a[144:151], v5
  ds_read_b128 v[52:55], v10 offset:1024
  v_smfmac_f32_16x16x64_bf16 v[68:71], v[12:15], a[152:159], v5
  ds_read_b128 v[40:43], v10 offset:2048
  v_smfmac_f32_16x16x64_bf16 v[56:59], v[12:15], a[128:135], v5
  ds_read_b128 v[44:47], v10 offset:3072
  v_smfmac_f32_16x16x64_bf16 v[56:59], v[16:19], a[192:199], v5
  buffer_store_dword v1, v9, s[12:15], s28 offen sc1
  v_smfmac_f32_16x16x64_bf16 v[56:59], v[20:23], v[120:127], v5
  v_smfmac_f32_16x16x64_bf16 v[72:75], v[12:15], a[160:167], v5
  buffer_store_dword v38, v9, s[12:15], s34 offen sc1
  s_waitcnt lgkmcnt(2)
  v_smfmac_f32_16x16x64_bf16 v[60:63], v[28:31], v[48:55], v5
  ds_read_b128 v[48:51], v10 offset:4096
  v_smfmac_f32_16x16x64_bf16 v[76:79], v[12:15], a[168:175], v5
  ds_read_b128 v[52:55], v10 offset:5120
  s_waitcnt lgkmcnt(2)
  v_smfmac_f32_16x16x64_bf16 v[64:67], v[28:31], v[40:47], v5
  ds_read_b128 v[40:43], v10 offset:6144
  v_smfmac_f32_16x16x64_bf16 v[56:59], v[24:27], v[184:191], v5
  ds_read_b128 v[44:47], v10 offset:7168
  v_smfmac_f32_16x16x64_bf16 v[64:67], v[16:19], a[208:215], v5
  buffer_load_dword v0, off, s[12:15], s25 sc1
  v_smfmac_f32_16x16x64_bf16 v[64:67], v[20:23], v[136:143], v5
  v_smfmac_f32_16x16x64_bf16 v[80:83], v[12:15], a[176:183], v5
  buffer_store_dword v38, v9, s[12:15], s33 offen
  s_waitcnt lgkmcnt(2)
  v_smfmac_f32_16x16x64_bf16 v[68:71], v[28:31], v[48:55], v5
  ds_read_b128 v[48:51], v10 offset:8192
  v_smfmac_f32_16x16x64_bf16 v[60:63], v[16:19], a[200:207], v5
  ds_read_b128 v[52:55], v10 offset:9216
  s_waitcnt lgkmcnt(2)
  v_smfmac_f32_16x16x64_bf16 v[72:75], v[28:31], v[40:47], v5
  ds_read_b128 v[40:43], v10 offset:10240
  v_smfmac_f32_16x16x64_bf16 v[60:63], v[20:23], v[128:135], v5
  ds_read_b128 v[44:47], v10 offset:11264
  v_smfmac_f32_16x16x64_bf16 v[84:87], v[12:15], a[184:191], v5
  v_mov_b32 v12, 0
  v_smfmac_f32_16x16x64_bf16 v[68:71], v[16:19], a[216:223], v5
  v_mov_b32 v13, 0
  v_smfmac_f32_16x16x64_bf16 v[68:71], v[20:23], v[144:151], v5
  v_mov_b32 v14, 0
  s_waitcnt lgkmcnt(2)
  v_smfmac_f32_16x16x64_bf16 v[76:79], v[28:31], v[48:55], v5
  ds_read_b128 v[48:51], v10 offset:12288
  v_smfmac_f32_16x16x64_bf16 v[72:75], v[16:19], a[224:231], v5
  ds_read_b128 v[52:55], v10 offset:13312
  s_waitcnt lgkmcnt(2)
  v_smfmac_f32_16x16x64_bf16 v[80:83], v[28:31], v[40:47], v5
  v_mov_b32 v15, 0
  v_smfmac_f32_16x16x64_bf16 v[56:59], v[28:31], v[248:255], v5
  v_smfmac_f32_16x16x64_bf16 v[72:75], v[20:23], v[152:159], v5
  v_smfmac_f32_16x16x64_bf16 v[76:79], v[16:19], a[232:239], v5
  v_cvt_pk_bf16_f32 v56, v56, v57
  v_smfmac_f32_16x16x64_bf16 v[64:67], v[24:27], v[200:207], v5
  v_cvt_pk_bf16_f32 v57, v58, v59
  s_waitcnt lgkmcnt(0)
  v_smfmac_f32_16x16x64_bf16 v[84:87], v[28:31], v[48:55], v5
  v_smfmac_f32_16x16x64_bf16 v[76:79], v[20:23], v[160:167], v5
  v_cvt_pk_bf16_f32 v58, v64, v65
  v_smfmac_f32_16x16x64_bf16 v[60:63], v[24:27], v[192:199], v5
  v_cvt_pk_bf16_f32 v59, v66, v67
  v_smfmac_f32_16x16x64_bf16 v[80:83], v[16:19], a[240:247], v5
  v_smfmac_f32_16x16x64_bf16 v[68:71], v[24:27], v[208:215], v5
  v_cvt_pk_bf16_f32 v64, v60, v61
  v_smfmac_f32_16x16x64_bf16 v[80:83], v[20:23], v[168:175], v5
  v_cvt_pk_bf16_f32 v65, v62, v63
  v_smfmac_f32_16x16x64_bf16 v[72:75], v[24:27], v[216:223], v5
  v_cvt_pk_bf16_f32 v66, v68, v69
  v_smfmac_f32_16x16x64_bf16 v[84:87], v[16:19], a[248:255], v5
  v_cvt_pk_bf16_f32 v67, v70, v71
  v_smfmac_f32_16x16x64_bf16 v[76:79], v[24:27], v[224:231], v5
  v_cvt_pk_bf16_f32 v60, v72, v73
  v_smfmac_f32_16x16x64_bf16 v[84:87], v[20:23], v[176:183], v5
  v_cvt_pk_bf16_f32 v61, v74, v75
  v_smfmac_f32_16x16x64_bf16 v[80:83], v[24:27], v[232:239], v5
  v_cvt_pk_bf16_f32 v68, v76, v77
  v_smfmac_f32_16x16x64_bf16 v[84:87], v[24:27], v[240:247], v5
  v_cvt_pk_bf16_f32 v69, v78, v79
  v_mov_b32 v16, 0
  s_nop 1
  v_cvt_pk_bf16_f32 v62, v80, v81
  v_cvt_pk_bf16_f32 v63, v82, v83
  v_mov_b32 v17, 0
  v_mov_b32 v18, 0
  v_cvt_pk_bf16_f32 v70, v84, v85
  v_cvt_pk_bf16_f32 v71, v86, v87
  v_mov_b32 v19, 0
  s_cmp_eq_u32 s35, 2147418112
  s_cbranch_scc1 RB_V5
RB_V6:
  s_sleep 3
  s_mov_b32 s27, 0
  buffer_load_dwordx4 v[40:43], v11, s[12:15], s24 offen offset:0 sc1
  buffer_load_dwordx4 v[44:47], v11, s[12:15], s24 offen offset:1024 sc1
  buffer_load_dwordx4 v[48:51], v11, s[12:15], s24 offen offset:2048 sc1
  s_nop 15
  s_nop 15
  s_nop 15
  buffer_load_dwordx4 v[72:75], v11, s[12:15], s24 offen offset:0 sc1
  buffer_load_dwordx4 v[76:79], v11, s[12:15], s24 offen offset:1024 sc1
  buffer_load_dwordx4 v[80:83], v11, s[12:15], s24 offen offset:2048 sc1
RB_P_L:
  s_waitcnt vmcnt(3)
  v_smfmac_f32_16x16x64_bf16 v[12:15], v[40:43], v[88:95], v5
  v_max3_u32 v6, v40, v41, v42
  v_smfmac_f32_16x16x64_bf16 v[16:19], v[40:43], v[96:103], v5
  v_max3_u32 v6, v6, v43, v44
  v_smfmac_f32_16x16x64_bf16 v[12:15], v[44:47], v[104:111], v5
  v_max3_u32 v6, v6, v45, v46
  v_smfmac_f32_16x16x64_bf16 v[16:19], v[44:47], v[112:119], v5
  v_max3_u32 v6, v6, v47, v48
  v_smfmac_f32_16x16x64_bf16 v[12:15], v[48:51], v[56:63], v5
  v_max3_u32 v6, v6, v49, v50
  v_smfmac_f32_16x16x64_bf16 v[16:19], v[48:51], v[64:71], v5
  v_max_u32 v6, v6, v51
  v_cmp_eq_u32 vcc, -1, v6
  s_cbranch_vccz RB_P_DONE
  buffer_load_dwordx4 v[40:43], v11, s[12:15], s24 offen offset:0 sc1
  buffer_load_dwordx4 v[44:47], v11, s[12:15], s24 offen offset:1024 sc1
  buffer_load_dwordx4 v[48:51], v11, s[12:15], s24 offen offset:2048 sc1
  v_mov_b32 v12, 0
  v_mov_b32 v13, 0
  v_mov_b32 v14, 0
  v_mov_b32 v15, 0
  v_mov_b32 v16, 0
  v_mov_b32 v17, 0
  v_mov_b32 v18, 0
  v_mov_b32 v19, 0
  s_waitcnt vmcnt(3)
  v_smfmac_f32_16x16x64_bf16 v[12:15], v[72:75], v[88:95], v5
  v_max3_u32 v6, v72, v73, v74
  v_smfmac_f32_16x16x64_bf16 v[16:19], v[72:75], v[96:103], v5
  v_max3_u32 v6, v6, v75, v76
  v_smfmac_f32_16x16x64_bf16 v[12:15], v[76:79], v[104:111], v5
  v_max3_u32 v6, v6, v77, v78
  v_smfmac_f32_16x16x64_bf16 v[16:19], v[76:79], v[112:119], v5
  v_max3_u32 v6, v6, v79, v80
  v_smfmac_f32_16x16x64_bf16 v[12:15], v[80:83], v[56:63], v5
  v_max3_u32 v6, v6, v81, v82
  v_smfmac_f32_16x16x64_bf16 v[16:19], v[80:83], v[64:71], v5
  v_max_u32 v6, v6, v83
  v_cmp_eq_u32 vcc, -1, v6
  s_cbranch_vccz RB_P_DONE
  buffer_load_dwordx4 v[72:75], v11, s[12:15], s24 offen offset:0 sc1
  buffer_load_dwordx4 v[76:79], v11, s[12:15], s24 offen offset:1024 sc1
  buffer_load_dwordx4 v[80:83], v11, s[12:15], s24 offen offset:2048 sc1
  v_mov_b32 v12, 0
  v_mov_b32 v13, 0
  v_mov_b32 v14, 0
  v_mov_b32 v15, 0
  v_mov_b32 v16, 0
  v_mov_b32 v17, 0
  v_mov_b32 v18, 0
  v_mov_b32 v19, 0
  s_add_u32 s27, s27, 1
  s_cmp_gt_u32 s27, 131072
  s_mov_b32 s99, 5
  s_cbranch_scc1 FAIL
  s_branch RB_P_L
RB_P_DONE:
  s_mov_b32 s21, s46
  s_add_u32 s28, s28, 28672
  s_add_u32 s22, s22, 458752
  v_add_f32 v12, v12, v13
  ds_write_b32 v7, v12 offset:0
  v_add_f32 v14, v14, v15
  ds_write_b32 v7, v14 offset:128
  v_add_f32 v16, v16, v17
  ds_write_b32 v7, v16 offset:64
  v_add_f32 v18, v18, v19
  ds_write_b32 v7, v18 offset:192
  s_cmp_ge_u32 s3, 2
  s_waitcnt lgkmcnt(0)
  s_barrier
  ds_read2st64_b64 v[20:23], v8 offset0:0 offset1:2
  ds_read2st64_b64 v[24:27], v8 offset0:4 offset1:6
  s_waitcnt lgkmcnt(1)
  v_pk_add_f32 v[20:21], v[20:21], v[22:23]
  s_waitcnt lgkmcnt(0)
  v_pk_add_f32 v[24:25], v[24:25], v[26:27]
  v_pk_add_f32 v[20:21], v[20:21], v[24:25]
  v_cvt_pk_bf16_f32 v1, v20, v21
  s_cbranch_scc1 RB_NOLOC
  buffer_store_dword v1, v9, s[12:15], s21 offen
RB_NOLOC:
  s_add_u32 s26, s26, 1
  s_cmp_lt_u32 s26, 63
  s_cbranch_scc1 RB_STEP
  buffer_store_dword v1, v9, s[12:15], s28 offen sc1
  s_endpgm
RB_V1:
  s_waitcnt vmcnt(0)
  buffer_load_dword v0, off, s[12:15], s25 sc1
  s_branch RB_V2
RB_V3:
  v_cmp_eq_u32 vcc, -1, v0
  s_cbranch_vccnz RB_V4
  s_mov_b32 s35, s22
  s_add_u32 s32, s22, 4096
  buffer_load_dwordx4 v[88:91], v2, s[12:15], s35 offen offset:0 sc1
  buffer_load_dwordx4 v[92:95], v2, s[12:15], s35 offen offset:1024 sc1
  buffer_load_dwordx4 v[96:99], v2, s[12:15], s35 offen offset:2048 sc1
  buffer_load_dwordx4 v[100:103], v2, s[12:15], s35 offen offset:3072 sc1
  buffer_load_dwordx4 v[104:107], v2, s[12:15], s32 offen offset:0 sc1
  buffer_load_dwordx4 v[108:111], v2, s[12:15], s32 offen offset:1024 sc1
  buffer_load_dwordx4 v[112:115], v2, s[12:15], s32 offen offset:2048 sc1
  buffer_load_dwordx4 v[116:119], v2, s[12:15], s32 offen offset:3072 sc1
  s_branch RB_V4
RB_V5:
  s_mov_b32 s27, 0
  s_sub_u32 s33, s25, 1792
RB_VF:
  buffer_load_dword v6, off, s[12:15], s33 sc1
  s_add_u32 s27, s27, 1
  s_cmp_gt_u32 s27, 131072
  s_mov_b32 s99, 3
  s_cbranch_scc1 FAIL
  s_waitcnt vmcnt(0)
  v_cmp_eq_u32 vcc, -1, v6
  s_cbranch_vccnz RB_VF
  s_mov_b32 s35, s22
  s_add_u32 s32, s22, 4096
  buffer_load_dwordx4 v[88:91], v2, s[12:15], s35 offen offset:0 sc1
  buffer_load_dwordx4 v[92:95], v2, s[12:15], s35 offen offset:1024 sc1
  buffer_load_dwordx4 v[96:99], v2, s[12:15], s35 offen offset:2048 sc1
  buffer_load_dwordx4 v[100:103], v2, s[12:15], s35 offen offset:3072 sc1
  buffer_load_dwordx4 v[104:107], v2, s[12:15], s32 offen offset:0 sc1
  buffer_load_dwordx4 v[108:111], v2, s[12:15], s32 offen offset:1024 sc1
  buffer_load_dwordx4 v[112:115], v2, s[12:15], s32 offen offset:2048 sc1
  buffer_load_dwordx4 v[116:119], v2, s[12:15], s32 offen offset:3072 sc1
  s_branch RB_V6
PF:
  s_cmp_lg_u32 s3, 0
  s_cbranch_scc1 PF_TA_B
  v_lshrrev_b32 v16, 1, v1
  v_lshlrev_b32 v16, 7, v16
  v_and_b32 v17, 1, v1
  v_lshl_add_u32 v16, v17, 4, v16
  s_mov_b32 s58, 17895424
  s_mov_b32 s59, 0
PF_TA_L:
  buffer_load_dwordx4 v[12:15], v16, s[12:15], s58 offen sc1
  s_add_u32 s59, s59, 1
  s_cmp_gt_u32 s59, 131072
  s_mov_b32 s99, 18
  s_cbranch_scc1 FAIL
  s_waitcnt vmcnt(0)
  v_xor_b32 v12, s90, v12
  v_xor_b32 v13, s90, v13
  v_xor_b32 v14, s90, v14
  v_xor_b32 v15, s90, v15
  v_or3_b32 v12, v12, v13, v14
  v_or_b32 v12, v12, v15
  v_cmp_ne_u32 vcc, 0, v12
  s_cbranch_vccz PF_TA_B
  s_sleep 4
  s_branch PF_TA_L
PF_TA_B:
  s_barrier
  s_waitcnt vmcnt(0)
  s_lshl_b32 s30, s17, 2
  s_add_u32 s30, s30, s3
  s_mov_b32 s23, 16056320
  s_cmp_eq_u32 s16, 1
  s_cselect_b32 s23, 78462976, s23
  s_mul_i32 s32, s30, 3584
  s_add_u32 s23, s23, s32
  v_min_u32 v3, 27, v1
  v_lshlrev_b32 v3, 7, v3
  s_mov_b32 s25, 0
  v_lshlrev_b32 v7, 7, v1
  s_mul_i32 s27, s16, 65536
  s_lshl_b32 s32, s30, 13
  s_add_u32 s27, s27, s32
  s_add_u32 s27, s27, 85868544
  s_mul_i32 s28, s16, 32768
  s_and_b32 s32, s30, 3
  s_lshl_b32 s32, s32, 13
  s_add_u32 s28, s28, s32
  s_add_u32 s28, s28, 85803008
  buffer_load_dword v9, v7, s[12:15], s27 offen sc1
  buffer_load_dword v9, v7, s[12:15], s28 offen sc1
  s_mul_i32 s31, s30, 7
  v_add_u32 v5, s31, v1
  v_lshrrev_b32 v10, 2, v5
  v_lshlrev_b32 v10, 7, v10
  v_and_b32 v5, 3, v5
  v_lshl_add_u32 v10, v5, 2, v10
  s_mul_i32 s33, s16, 114688
  s_add_u32 s33, s33, 91242496
  v_add_u32 v10, s33, v10
  s_mul_i32 s33, s16, 14336
  s_add_u32 s33, s33, 76627968
  v_mov_b32 v8, s33
  v_cmp_gt_u32 s[36:37], 7, v1
  s_nop 1
  v_cndmask_b32 v10, v8, v10, s[36:37]
  v_mov_b32 v8, 28672
  v_mov_b32 v6, 1792
  v_cndmask_b32 v8, v8, v6, s[36:37]
  v_cndmask_b32 v6, 0, v6, s[36:37]
  s_mul_i32 s34, s16, 29360128
  s_mul_i32 s31, s30, 57344
  s_add_u32 s34, s34, s31
  s_add_u32 s34, s34, 17907712
PF_STEP:
  s_mov_b32 s26, 0
PF_F:
  buffer_load_dword v5, v10, s[12:15], 0 offen sc1
  s_add_u32 s26, s26, 1
  s_cmp_gt_u32 s26, 131072
  s_mov_b32 s99, 7
  s_cbranch_scc1 FAIL
  s_waitcnt vmcnt(0)
  v_cmp_eq_u32 vcc, -1, v5
  s_cbranch_vccz PF_V
  s_sleep 1
  s_branch PF_F
PF_V:
  buffer_load_dword v9, v3, s[12:15], s23 offen sc1
  s_add_u32 s34, s34, 458752
  s_add_u32 s23, s23, 28672
  s_add_u32 s25, s25, 1
  s_cmp_gt_u32 s25, 3
  s_cselect_b64 vcc, -1, 0
  v_cndmask_b32 v4, v6, v8, vcc
  v_add_u32 v10, v10, v4
  s_cmp_lt_u32 s25, 63
  s_cbranch_scc1 PF_STEP
  s_endpgm
PA:
  v_lshlrev_b32 v2, 4, v1
  s_lshl_b32 s20, s17, 2
  s_add_u32 s20, s20, s3
  s_mul_i32 s20, s20, 100352
  s_lshl_b32 s56, s17, 1
  v_mov_b32 v12, s56
  v_and_b32 v13, 15, v1
  v_min_u32 v13, 4, v13
  v_lshlrev_b32 v13, 2, v13
  v_lshl_add_u32 v12, v12, 7, v13
  s_mov_b32 s58, 17903616
  s_mov_b32 s59, 0
  s_mov_b32 s56, 0x7f
PA_WL:
  buffer_load_dword v13, v12, s[12:15], s58 offen sc1
  s_add_u32 s59, s59, 1
  s_cmp_gt_u32 s59, 131072
  s_mov_b32 s99, 18
  s_cbranch_scc1 FAIL
  s_waitcnt vmcnt(0)
  v_subrev_u32 v13, s90, v13
  v_cmp_gt_u32 vcc, 8, v13
  s_nop 1
  v_cndmask_b32 v13, 0, v13, vcc
  s_mov_b32 s55, 0
  v_cmp_gt_u32 vcc, 1, v13
  s_cmp_eq_u64 vcc, 0
  s_cselect_b32 s55, 3, s55
  v_cmp_gt_u32 vcc, 2, v13
  s_cmp_eq_u64 vcc, 0
  s_cselect_b32 s55, 15, s55
  v_cmp_gt_u32 vcc, 3, v13
  s_cmp_eq_u64 vcc, 0
  s_cselect_b32 s55, 63, s55
  v_cmp_gt_u32 vcc, 4, v13
  s_cmp_eq_u64 vcc, 0
  s_cselect_b32 s55, 127, s55
  s_and_b32 s55, s55, s56
  s_andn2_b32 s56, s56, s55
  s_bitcmp1_b32 s55, 0
  s_cbranch_scc0 PA_WS0
  s_add_u32 s57, s20, 0
  buffer_load_dwordx4 a[0:3], v2, s[12:15], s57 offen offset:0
  buffer_load_dwordx4 a[4:7], v2, s[12:15], s57 offen offset:1024
  buffer_load_dwordx4 a[8:11], v2, s[12:15], s57 offen offset:2048
  buffer_load_dwordx4 a[12:15], v2, s[12:15], s57 offen offset:3072
  s_add_u32 s57, s20, 4096
  buffer_load_dwordx4 a[16:19], v2, s[12:15], s57 offen offset:0
  buffer_load_dwordx4 a[20:23], v2, s[12:15], s57 offen offset:1024
  buffer_load_dwordx4 a[24:27], v2, s[12:15], s57 offen offset:2048
  buffer_load_dwordx4 a[28:31], v2, s[12:15], s57 offen offset:3072
  s_add_u32 s57, s20, 8192
  buffer_load_dwordx4 a[32:35], v2, s[12:15], s57 offen offset:0
  buffer_load_dwordx4 a[36:39], v2, s[12:15], s57 offen offset:1024
  buffer_load_dwordx4 a[40:43], v2, s[12:15], s57 offen offset:2048
  buffer_load_dwordx4 a[44:47], v2, s[12:15], s57 offen offset:3072
  s_add_u32 s57, s20, 12288
  buffer_load_dwordx4 a[48:51], v2, s[12:15], s57 offen offset:0
  buffer_load_dwordx4 a[52:55], v2, s[12:15], s57 offen offset:1024
PA_WS0:
  s_bitcmp1_b32 s55, 1
  s_cbranch_scc0 PA_WS1
  s_add_u32 s57, s20, 12288
  buffer_load_dwordx4 a[56:59], v2, s[12:15], s57 offen offset:2048
  buffer_load_dwordx4 a[60:63], v2, s[12:15], s57 offen offset:3072
  s_add_u32 s57, s20, 16384
  buffer_load_dwordx4 a[64:67], v2, s[12:15], s57 offen offset:0
  buffer_load_dwordx4 a[68:71], v2, s[12:15], s57 offen offset:1024
  buffer_load_dwordx4 a[72:75], v2, s[12:15], s57 offen offset:2048
  buffer_load_dwordx4 a[76:79], v2, s[12:15], s57 offen offset:3072
  s_add_u32 s57, s20, 20480
  buffer_load_dwordx4 a[80:83], v2, s[12:15], s57 offen offset:0
  buffer_load_dwordx4 a[84:87], v2, s[12:15], s57 offen offset:1024
  buffer_load_dwordx4 a[88:91], v2, s[12:15], s57 offen offset:2048
  buffer_load_dwordx4 a[92:95], v2, s[12:15], s57 offen offset:3072
  s_add_u32 s57, s20, 24576
  buffer_load_dwordx4 a[96:99], v2, s[12:15], s57 offen offset:0
  buffer_load_dwordx4 a[100:103], v2, s[12:15], s57 offen offset:1024
  buffer_load_dwordx4 a[104:107], v2, s[12:15], s57 offen offset:2048
  buffer_load_dwordx4 a[108:111], v2, s[12:15], s57 offen offset:3072
PA_WS1:
  s_bitcmp1_b32 s55, 2
  s_cbranch_scc0 PA_WS2
  s_add_u32 s57, s20, 28672
  buffer_load_dwordx4 a[112:115], v2, s[12:15], s57 offen offset:0
  buffer_load_dwordx4 a[116:119], v2, s[12:15], s57 offen offset:1024
  buffer_load_dwordx4 a[120:123], v2, s[12:15], s57 offen offset:2048
  buffer_load_dwordx4 a[124:127], v2, s[12:15], s57 offen offset:3072
  s_add_u32 s57, s20, 32768
  buffer_load_dwordx4 a[128:131], v2, s[12:15], s57 offen offset:0
  buffer_load_dwordx4 a[132:135], v2, s[12:15], s57 offen offset:1024
  buffer_load_dwordx4 a[136:139], v2, s[12:15], s57 offen offset:2048
  buffer_load_dwordx4 a[140:143], v2, s[12:15], s57 offen offset:3072
  s_add_u32 s57, s20, 36864
  buffer_load_dwordx4 a[144:147], v2, s[12:15], s57 offen offset:0
  buffer_load_dwordx4 a[148:151], v2, s[12:15], s57 offen offset:1024
  buffer_load_dwordx4 a[152:155], v2, s[12:15], s57 offen offset:2048
  buffer_load_dwordx4 a[156:159], v2, s[12:15], s57 offen offset:3072
  s_add_u32 s57, s20, 40960
  buffer_load_dwordx4 a[160:163], v2, s[12:15], s57 offen offset:0
  buffer_load_dwordx4 a[164:167], v2, s[12:15], s57 offen offset:1024
PA_WS2:
  s_bitcmp1_b32 s55, 3
  s_cbranch_scc0 PA_WS3
  s_add_u32 s57, s20, 40960
  buffer_load_dwordx4 a[168:171], v2, s[12:15], s57 offen offset:2048
  buffer_load_dwordx4 a[172:175], v2, s[12:15], s57 offen offset:3072
  s_add_u32 s57, s20, 45056
  buffer_load_dwordx4 a[176:179], v2, s[12:15], s57 offen offset:0
  buffer_load_dwordx4 a[180:183], v2, s[12:15], s57 offen offset:1024
  buffer_load_dwordx4 a[184:187], v2, s[12:15], s57 offen offset:2048
  buffer_load_dwordx4 a[188:191], v2, s[12:15], s57 offen offset:3072
  s_add_u32 s57, s20, 49152
  buffer_load_dwordx4 a[192:195], v2, s[12:15], s57 offen offset:0
  buffer_load_dwordx4 a[196:199], v2, s[12:15], s57 offen offset:1024
  buffer_load_dwordx4 a[200:203], v2, s[12:15], s57 offen offset:2048
  buffer_load_dwordx4 a[204:207], v2, s[12:15], s57 offen offset:3072
  s_add_u32 s57, s20, 53248
  buffer_load_dwordx4 a[208:211], v2, s[12:15], s57 offen offset:0
  buffer_load_dwordx4 a[212:215], v2, s[12:15], s57 offen offset:1024
  buffer_load_dwordx4 a[216:219], v2, s[12:15], s57 offen offset:2048
  buffer_load_dwordx4 a[220:223], v2, s[12:15], s57 offen offset:3072
PA_WS3:
  s_bitcmp1_b32 s55, 4
  s_cbranch_scc0 PA_WS4
  s_add_u32 s57, s20, 57344
  buffer_load_dwordx4 a[224:227], v2, s[12:15], s57 offen offset:0
  buffer_load_dwordx4 a[228:231], v2, s[12:15], s57 offen offset:1024
  buffer_load_dwordx4 a[232:235], v2, s[12:15], s57 offen offset:2048
  buffer_load_dwordx4 a[236:239], v2, s[12:15], s57 offen offset:3072
  s_add_u32 s57, s20, 61440
  buffer_load_dwordx4 a[240:243], v2, s[12:15], s57 offen offset:0
  buffer_load_dwordx4 a[244:247], v2, s[12:15], s57 offen offset:1024
  buffer_load_dwordx4 a[248:251], v2, s[12:15], s57 offen offset:2048
  buffer_load_dwordx4 a[252:255], v2, s[12:15], s57 offen offset:3072
  s_add_u32 s57, s20, 65536
  buffer_load_dwordx4 v[120:123], v2, s[12:15], s57 offen offset:0
  buffer_load_dwordx4 v[124:127], v2, s[12:15], s57 offen offset:1024
  buffer_load_dwordx4 v[128:131], v2, s[12:15], s57 offen offset:2048
  buffer_load_dwordx4 v[132:135], v2, s[12:15], s57 offen offset:3072
  s_add_u32 s57, s20, 69632
  buffer_load_dwordx4 v[136:139], v2, s[12:15], s57 offen offset:0
  buffer_load_dwordx4 v[140:143], v2, s[12:15], s57 offen offset:1024
PA_WS4:
  s_bitcmp1_b32 s55, 5
  s_cbranch_scc0 PA_WS5
  s_add_u32 s57, s20, 69632
  buffer_load_dwordx4 v[144:147], v2, s[12:15], s57 offen offset:2048
  buffer_load_dwordx4 v[148:151], v2, s[12:15], s57 offen offset:3072
  s_add_u32 s57, s20, 73728
  buffer_load_dwordx4 v[152:155], v2, s[12:15], s57 offen offset:0
  buffer_load_dwordx4 v[156:159], v2, s[12:15], s57 offen offset:1024
  buffer_load_dwordx4 v[160:163], v2, s[12:15], s57 offen offset:2048
  buffer_load_dwordx4 v[164:167], v2, s[12:15], s57 offen offset:3072
  s_add_u32 s57, s20, 77824
  buffer_load_dwordx4 v[168:171], v2, s[12:15], s57 offen offset:0
  buffer_load_dwordx4 v[172:175], v2, s[12:15], s57 offen offset:1024
  buffer_load_dwordx4 v[176:179], v2, s[12:15], s57 offen offset:2048
  buffer_load_dwordx4 v[180:183], v2, s[12:15], s57 offen offset:3072
  s_add_u32 s57, s20, 81920
  buffer_load_dwordx4 v[184:187], v2, s[12:15], s57 offen offset:0
  buffer_load_dwordx4 v[188:191], v2, s[12:15], s57 offen offset:1024
  buffer_load_dwordx4 v[192:195], v2, s[12:15], s57 offen offset:2048
  buffer_load_dwordx4 v[196:199], v2, s[12:15], s57 offen offset:3072
PA_WS5:
  s_bitcmp1_b32 s55, 6
  s_cbranch_scc0 PA_WS6
  s_add_u32 s57, s20, 86016
  buffer_load_dwordx4 v[200:203], v2, s[12:15], s57 offen offset:0
  buffer_load_dwordx4 v[204:207], v2, s[12:15], s57 offen offset:1024
  buffer_load_dwordx4 v[208:211], v2, s[12:15], s57 offen offset:2048
  buffer_load_dwordx4 v[212:215], v2, s[12:15], s57 offen offset:3072
  s_add_u32 s57, s20, 90112
  buffer_load_dwordx4 v[216:219], v2, s[12:15], s57 offen offset:0
  buffer_load_dwordx4 v[220:223], v2, s[12:15], s57 offen offset:1024
  buffer_load_dwordx4 v[224:227], v2, s[12:15], s57 offen offset:2048
  buffer_load_dwordx4 v[228:231], v2, s[12:15], s57 offen offset:3072
  s_add_u32 s57, s20, 94208
  buffer_load_dwordx4 v[232:235], v2, s[12:15], s57 offen offset:0
  buffer_load_dwordx4 v[236:239], v2, s[12:15], s57 offen offset:1024
  buffer_load_dwordx4 v[240:243], v2, s[12:15], s57 offen offset:2048
  buffer_load_dwordx4 v[244:247], v2, s[12:15], s57 offen offset:3072
  s_add_u32 s57, s20, 98304
  buffer_load_dwordx4 v[248:251], v2, s[12:15], s57 offen offset:0
  buffer_load_dwordx4 v[252:255], v2, s[12:15], s57 offen offset:1024
PA_WS6:
  s_cmp_eq_u32 s56, 0
  s_cbranch_scc1 PA_WE
  s_sleep 3
  s_branch PA_WL
PA_WE:
  s_waitcnt vmcnt(0)
  s_cmp_lg_u32 s3, 0
  s_cbranch_scc1 PA_TA_B
  v_lshrrev_b32 v16, 1, v1
  v_lshlrev_b32 v16, 7, v16
  v_and_b32 v17, 1, v1
  v_lshl_add_u32 v16, v17, 4, v16
  s_mov_b32 s58, 17895424
  s_mov_b32 s59, 0
PA_TA_L:
  buffer_load_dwordx4 v[12:15], v16, s[12:15], s58 offen sc1
  s_add_u32 s59, s59, 1
  s_cmp_gt_u32 s59, 131072
  s_mov_b32 s99, 18
  s_cbranch_scc1 FAIL
  s_waitcnt vmcnt(0)
  v_xor_b32 v12, s90, v12
  v_xor_b32 v13, s90, v13
  v_xor_b32 v14, s90, v14
  v_xor_b32 v15, s90, v15
  v_or3_b32 v12, v12, v13, v14
  v_or_b32 v12, v12, v15
  v_cmp_ne_u32 vcc, 0, v12
  s_cbranch_vccz PA_TA_B
  s_sleep 4
  s_branch PA_TA_L
PA_TA_B:
  s_barrier
  s_mul_i32 s29, s3, 7168
  v_add_u32 v3, s29, v2
  v_bfe_u32 v4, v1, 1, 3
  v_lshlrev_b32 v7, 4, v4
  v_lshrrev_b32 v4, 4, v1
  v_lshl_add_u32 v7, v4, 7, v7
  s_lshr_b32 s27, s3, 1
  s_mul_i32 s27, s27, 7
  s_add_u32 s27, s27, 3
  s_and_b32 s28, s3, 1
  s_lshl_b32 s28, s28, 3
  s_lshl_b32 s38, s27, 10
  s_add_u32 s38, s38, s28
  v_add_u32 v6, s38, v2
  s_lshl_b32 s38, s27, 9
  s_add_u32 s38, s38, s28
  v_add_u32 v8, s38, v7
  s_mul_i32 s27, s3, 7
  s_add_u32 s27, s27, 1
  s_lshr_b32 s27, s27, 1
  s_lshl_b32 s28, s27, 10
  s_lshl_b32 s27, s27, 9
  v_add_u32 v5, s28, v2
  v_add_u32 v7, s27, v7
  s_mul_i32 s27, s3, 5120
  s_add_u32 s27, s27, 57344
  v_add_u32 v9, s27, v2
  s_and_b32 s27, s3, 1
  s_lshl_b32 s27, s27, 3
  v_and_b32 v12, 7, v1
  v_add_u32 v12, s27, v12
  v_lshrrev_b32 v13, 4, v1
  v_lshl_add_u32 v11, v13, 4, v12
  v_lshlrev_b32 v0, 3, v11
  v_lshlrev_b32 v11, 4, v11
  v_bfe_u32 v14, v1, 3, 1
  v_lshl_add_u32 v10, v14, 3, v11
  s_lshr_b32 s28, s3, 1
  s_lshl_b32 s27, s28, 10
  s_add_u32 s27, s27, 57344
  v_add_u32 v10, s27, v10
  v_lshlrev_b32 v13, 2, v13
  v_lshl_add_u32 v13, v14, 1, v13
  s_lshl_b32 s27, s28, 4
  v_add_u32 v12, s27, v12
  v_add_u32 v14, 0, v13
  v_cmp_gt_u32 s[30:31], v14, v12
  v_add_u32 v14, 1, v13
  v_cmp_gt_u32 s[32:33], v14, v12
  v_add_u32 v14, 16, v13
  v_cmp_gt_u32 s[34:35], v14, v12
  v_add_u32 v14, 17, v13
  v_cmp_gt_u32 s[36:37], v14, v12
  v_add_u32 v0, 2048, v0
  s_cmp_eq_u32 s28, 0
  s_cselect_b32 s27, 1024, 0
  v_add_u32 v11, s27, v11
  s_mov_b32 s21, 16056320
  s_cmp_eq_u32 s16, 1
  s_cselect_b32 s21, 78462976, s21
  s_mul_i32 s27, s18, 28672
  s_add_u32 s21, s21, s27
  s_add_u32 s21, s21, s29
  s_mul_i32 s22, s16, 14336
  s_mul_i32 s27, s18, 28672
  s_add_u32 s22, s22, s27
  s_add_u32 s22, s22, 76635136
  s_lshl_b32 s27, s16, 6
  s_add_u32 s27, s27, s18
  s_mul_i32 s23, s27, 40960
  s_mul_i32 s27, s17, 2560
  s_add_u32 s23, s23, s27
  s_add_u32 s23, s23, 85999616
  s_mov_b32 s24, s18
  s_mov_b32 s39, 0xf149f2ca
  s_lshl_b32 s27, s3, 10
  v_add_u32 v118, s27, v2
  v_cmp_gt_u32 vcc, 2560, v118
  v_mov_b32 v119, 2147418112
  s_nop 0
  v_cndmask_b32 v118, v119, v118, vcc
  s_mov_b32 s41, 0
  s_mov_b32 s50, 0
  s_add_u32 s27, s21, 4096
  v_mov_b32 v119, v2
PA_TASK:
  s_cmp_eq_u32 s50, 1
  s_cbranch_scc1 PA_XOK
  s_mov_b32 s25, 0
PA_X_L:
  buffer_load_dwordx4 v[20:23], v2, s[12:15], s21 offen offset:0 sc1
  buffer_load_dwordx4 v[24:27], v2, s[12:15], s21 offen offset:1024 sc1
  buffer_load_dwordx4 v[36:39], v2, s[12:15], s21 offen offset:2048 sc1
  buffer_load_dwordx4 v[40:43], v2, s[12:15], s21 offen offset:3072 sc1
  buffer_load_dwordx4 v[52:55], v2, s[12:15], s27 offen offset:0 sc1
  buffer_load_dwordx4 v[56:59], v2, s[12:15], s27 offen offset:1024 sc1
  buffer_load_dwordx4 v[104:107], v2, s[12:15], s27 offen offset:2048 sc1
  s_add_u32 s25, s25, 1
  s_cmp_gt_u32 s25, 131072
  s_mov_b32 s99, 8
  s_cbranch_scc1 FAIL
  s_waitcnt vmcnt(0)
  v_max3_u32 v4, v20, v21, v22
  v_max3_u32 v4, v4, v23, v24
  v_max3_u32 v4, v4, v25, v26
  v_max3_u32 v4, v4, v27, v36
  v_max3_u32 v4, v4, v37, v38
  v_max3_u32 v4, v4, v39, v40
  v_max3_u32 v4, v4, v41, v42
  v_max3_u32 v4, v4, v43, v52
  v_max3_u32 v4, v4, v53, v54
  v_max3_u32 v4, v4, v55, v56
  v_max3_u32 v4, v4, v57, v58
  v_max3_u32 v4, v4, v59, v104
  v_max3_u32 v4, v4, v105, v106
  v_max_u32 v4, v4, v107
  v_cmp_eq_u32 vcc, -1, v4
  s_cbranch_vccz PA_X_OK
  s_sleep 1
  s_branch PA_X_L
PA_X_OK:
  ds_write_b128 v3, v[20:23] offset:0
  ds_write_b128 v3, v[24:27] offset:1024
  ds_write_b128 v3, v[36:39] offset:2048
  ds_write_b128 v3, v[40:43] offset:3072
  ds_write_b128 v3, v[52:55] offset:4096
  ds_write_b128 v3, v[56:59] offset:5120
  ds_write_b128 v3, v[104:107] offset:6144
PA_XOK:
  s_add_u32 s38, s23, 245760
  s_cmp_lt_u32 s24, 58
  s_cselect_b32 s38, s38, 2147418112
  v_mov_b32 v84, -1
  v_mov_b32 v85, -1
  v_mov_b32 v86, -1
  v_mov_b32 v87, -1
  buffer_store_dwordx4 v[84:87], v118, s[12:15], s38 offen sc1
  s_add_u32 s24, s24, 2
  s_cmp_lt_u32 s24, 64
  s_cselect_b32 s38, 57344, 0
  s_add_u32 s21, s21, s38
  s_add_u32 s27, s21, 4096
  s_sub_u32 s42, 28672, s41
  s_add_u32 s40, s42, s29
  s_sub_u32 s43, s42, s41
  s_waitcnt lgkmcnt(0)
  s_barrier
  ds_read_b128 v[68:71], v119 offset:0
  ds_read_b128 v[72:75], v119 offset:14336
  ds_read_b128 v[76:79], v119 offset:1024
  ds_read_b128 v[80:83], v119 offset:15360
  v_add_u32 v3, s43, v3
  s_mov_b32 s41, s42
  s_waitcnt lgkmcnt(3)
  v_mfma_f32_16x16x32_bf16 v[12:15], a[0:3], v[68:71], 0
  v_mfma_f32_16x16x32_bf16 v[20:23], a[8:11], v[68:71], 0
  v_mfma_f32_16x16x32_bf16 v[28:31], a[16:19], v[68:71], 0
  v_mfma_f32_16x16x32_bf16 v[36:39], a[24:27], v[68:71], 0
  v_mfma_f32_16x16x32_bf16 v[44:47], a[32:35], v[68:71], 0
  v_mfma_f32_16x16x32_bf16 v[52:55], a[40:43], v[68:71], 0
  v_mfma_f32_16x16x32_bf16 v[60:63], a[48:51], v[68:71], 0
  ds_read_b128 v[68:71], v119 offset:2048
  s_waitcnt lgkmcnt(1)
  v_mfma_f32_16x16x32_bf16 v[16:19], a[0:3], v[72:75], 0
  v_mfma_f32_16x16x32_bf16 v[24:27], a[8:11], v[72:75], 0
  v_mfma_f32_16x16x32_bf16 v[32:35], a[16:19], v[72:75], 0
  v_mfma_f32_16x16x32_bf16 v[40:43], a[24:27], v[72:75], 0
  v_mfma_f32_16x16x32_bf16 v[48:51], a[32:35], v[72:75], 0
  v_mfma_f32_16x16x32_bf16 v[56:59], a[40:43], v[72:75], 0
  v_mfma_f32_16x16x32_bf16 v[64:67], a[48:51], v[72:75], 0
  ds_read_b128 v[72:75], v119 offset:16384
  v_mfma_f32_16x16x32_bf16 v[12:15], a[4:7], v[76:79], v[12:15]
  v_mfma_f32_16x16x32_bf16 v[20:23], a[12:15], v[76:79], v[20:23]
  v_mfma_f32_16x16x32_bf16 v[28:31], a[20:23], v[76:79], v[28:31]
  v_mfma_f32_16x16x32_bf16 v[36:39], a[28:31], v[76:79], v[36:39]
  v_mfma_f32_16x16x32_bf16 v[44:47], a[36:39], v[76:79], v[44:47]
  v_mfma_f32_16x16x32_bf16 v[52:55], a[44:47], v[76:79], v[52:55]
  v_mfma_f32_16x16x32_bf16 v[60:63], a[52:55], v[76:79], v[60:63]
  ds_read_b128 v[76:79], v119 offset:3072
  v_mfma_f32_16x16x32_bf16 v[16:19], a[4:7], v[80:83], v[16:19]
  v_mfma_f32_16x16x32_bf16 v[24:27], a[12:15], v[80:83], v[24:27]
  v_mfma_f32_16x16x32_bf16 v[32:35], a[20:23], v[80:83], v[32:35]
  v_mfma_f32_16x16x32_bf16 v[40:43], a[28:31], v[80:83], v[40:43]
  v_mfma_f32_16x16x32_bf16 v[48:51], a[36:39], v[80:83], v[48:51]
  v_mfma_f32_16x16x32_bf16 v[56:59], a[44:47], v[80:83], v[56:59]
  v_mfma_f32_16x16x32_bf16 v[64:67], a[52:55], v[80:83], v[64:67]
  ds_read_b128 v[80:83], v119 offset:17408
  s_waitcnt lgkmcnt(2)
  v_mfma_f32_16x16x32_bf16 v[12:15], a[56:59], v[68:71], v[12:15]
  v_mfma_f32_16x16x32_bf16 v[20:23], a[64:67], v[68:71], v[20:23]
  v_mfma_f32_16x16x32_bf16 v[28:31], a[72:75], v[68:71], v[28:31]
  v_mfma_f32_16x16x32_bf16 v[36:39], a[80:83], v[68:71], v[36:39]
  v_mfma_f32_16x16x32_bf16 v[44:47], a[88:91], v[68:71], v[44:47]
  v_mfma_f32_16x16x32_bf16 v[52:55], a[96:99], v[68:71], v[52:55]
  v_mfma_f32_16x16x32_bf16 v[60:63], a[104:107], v[68:71], v[60:63]
  ds_read_b128 v[68:71], v119 offset:4096
  v_mfma_f32_16x16x32_bf16 v[16:19], a[56:59], v[72:75], v[16:19]
  v_mfma_f32_16x16x32_bf16 v[24:27], a[64:67], v[72:75], v[24:27]
  v_mfma_f32_16x16x32_bf16 v[32:35], a[72:75], v[72:75], v[32:35]
  v_mfma_f32_16x16x32_bf16 v[40:43], a[80:83], v[72:75], v[40:43]
  v_mfma_f32_16x16x32_bf16 v[48:51], a[88:91], v[72:75], v[48:51]
  v_mfma_f32_16x16x32_bf16 v[56:59], a[96:99], v[72:75], v[56:59]
  v_mfma_f32_16x16x32_bf16 v[64:67], a[104:107], v[72:75], v[64:67]
  ds_read_b128 v[72:75], v119 offset:18432
  s_waitcnt lgkmcnt(2)
  v_mfma_f32_16x16x32_bf16 v[12:15], a[60:63], v[76:79], v[12:15]
  v_mfma_f32_16x16x32_bf16 v[20:23], a[68:71], v[76:79], v[20:23]
  v_mfma_f32_16x16x32_bf16 v[28:31], a[76:79], v[76:79], v[28:31]
  v_mfma_f32_16x16x32_bf16 v[36:39], a[84:87], v[76:79], v[36:39]
  v_mfma_f32_16x16x32_bf16 v[44:47], a[92:95], v[76:79], v[44:47]
  v_mfma_f32_16x16x32_bf16 v[52:55], a[100:103], v[76:79], v[52:55]
  v_mfma_f32_16x16x32_bf16 v[60:63], a[108:111], v[76:79], v[60:63]
  ds_read_b128 v[76:79], v119 offset:5120
  v_mfma_f32_16x16x32_bf16 v[16:19], a[60:63], v[80:83], v[16:19]
  v_mfma_f32_16x16x32_bf16 v[24:27], a[68:71], v[80:83], v[24:27]
  v_mfma_f32_16x16x32_bf16 v[32:35], a[76:79], v[80:83], v[32:35]
  v_mfma_f32_16x16x32_bf16 v[40:43], a[84:87], v[80:83], v[40:43]
  v_mfma_f32_16x16x32_bf16 v[48:51], a[92:95], v[80:83], v[48:51]
  v_mfma_f32_16x16x32_bf16 v[56:59], a[100:103], v[80:83], v[56:59]
  v_mfma_f32_16x16x32_bf16 v[64:67], a[108:111], v[80:83], v[64:67]
  ds_read_b128 v[80:83], v119 offset:19456
  s_waitcnt lgkmcnt(2)
  v_mfma_f32_16x16x32_bf16 v[12:15], a[112:115], v[68:71], v[12:15]
  v_mfma_f32_16x16x32_bf16 v[20:23], a[120:123], v[68:71], v[20:23]
  v_mfma_f32_16x16x32_bf16 v[28:31], a[128:131], v[68:71], v[28:31]
  v_mfma_f32_16x16x32_bf16 v[36:39], a[136:139], v[68:71], v[36:39]
  v_mfma_f32_16x16x32_bf16 v[44:47], a[144:147], v[68:71], v[44:47]
  v_mfma_f32_16x16x32_bf16 v[52:55], a[152:155], v[68:71], v[52:55]
  v_mfma_f32_16x16x32_bf16 v[60:63], a[160:163], v[68:71], v[60:63]
  ds_read_b128 v[68:71], v119 offset:6144
  v_mfma_f32_16x16x32_bf16 v[16:19], a[112:115], v[72:75], v[16:19]
  v_mfma_f32_16x16x32_bf16 v[24:27], a[120:123], v[72:75], v[24:27]
  v_mfma_f32_16x16x32_bf16 v[32:35], a[128:131], v[72:75], v[32:35]
  v_mfma_f32_16x16x32_bf16 v[40:43], a[136:139], v[72:75], v[40:43]
  v_mfma_f32_16x16x32_bf16 v[48:51], a[144:147], v[72:75], v[48:51]
  v_mfma_f32_16x16x32_bf16 v[56:59], a[152:155], v[72:75], v[56:59]
  v_mfma_f32_16x16x32_bf16 v[64:67], a[160:163], v[72:75], v[64:67]
  ds_read_b128 v[72:75], v119 offset:20480
  s_waitcnt lgkmcnt(2)
  v_mfma_f32_16x16x32_bf16 v[12:15], a[116:119], v[76:79], v[12:15]
  v_mfma_f32_16x16x32_bf16 v[20:23], a[124:127], v[76:79], v[20:23]
  v_mfma_f32_16x16x32_bf16 v[28:31], a[132:135], v[76:79], v[28:31]
  v_mfma_f32_16x16x32_bf16 v[36:39], a[140:143], v[76:79], v[36:39]
  v_mfma_f32_16x16x32_bf16 v[44:47], a[148:151], v[76:79], v[44:47]
  v_mfma_f32_16x16x32_bf16 v[52:55], a[156:159], v[76:79], v[52:55]
  v_mfma_f32_16x16x32_bf16 v[60:63], a[164:167], v[76:79], v[60:63]
  ds_read_b128 v[76:79], v119 offset:7168
  v_mfma_f32_16x16x32_bf16 v[16:19], a[116:119], v[80:83], v[16:19]
  v_mfma_f32_16x16x32_bf16 v[24:27], a[124:127], v[80:83], v[24:27]
  v_mfma_f32_16x16x32_bf16 v[32:35], a[132:135], v[80:83], v[32:35]
  v_mfma_f32_16x16x32_bf16 v[40:43], a[140:143], v[80:83], v[40:43]
  v_mfma_f32_16x16x32_bf16 v[48:51], a[148:151], v[80:83], v[48:51]
  v_mfma_f32_16x16x32_bf16 v[56:59], a[156:159], v[80:83], v[56:59]
  v_mfma_f32_16x16x32_bf16 v[64:67], a[164:167], v[80:83], v[64:67]
  ds_read_b128 v[80:83], v119 offset:21504
  s_waitcnt lgkmcnt(2)
  v_mfma_f32_16x16x32_bf16 v[12:15], a[168:171], v[68:71], v[12:15]
  v_mfma_f32_16x16x32_bf16 v[20:23], a[176:179], v[68:71], v[20:23]
  v_mfma_f32_16x16x32_bf16 v[28:31], a[184:187], v[68:71], v[28:31]
  v_mfma_f32_16x16x32_bf16 v[36:39], a[192:195], v[68:71], v[36:39]
  v_mfma_f32_16x16x32_bf16 v[44:47], a[200:203], v[68:71], v[44:47]
  v_mfma_f32_16x16x32_bf16 v[52:55], a[208:211], v[68:71], v[52:55]
  v_mfma_f32_16x16x32_bf16 v[60:63], a[216:219], v[68:71], v[60:63]
  ds_read_b128 v[68:71], v119 offset:8192
  v_mfma_f32_16x16x32_bf16 v[16:19], a[168:171], v[72:75], v[16:19]
  v_mfma_f32_16x16x32_bf16 v[24:27], a[176:179], v[72:75], v[24:27]
  v_mfma_f32_16x16x32_bf16 v[32:35], a[184:187], v[72:75], v[32:35]
  v_mfma_f32_16x16x32_bf16 v[40:43], a[192:195], v[72:75], v[40:43]
  v_mfma_f32_16x16x32_bf16 v[48:51], a[200:203], v[72:75], v[48:51]
  v_mfma_f32_16x16x32_bf16 v[56:59], a[208:211], v[72:75], v[56:59]
  v_mfma_f32_16x16x32_bf16 v[64:67], a[216:219], v[72:75], v[64:67]
  ds_read_b128 v[72:75], v119 offset:22528
  s_waitcnt lgkmcnt(2)
  v_mfma_f32_16x16x32_bf16 v[12:15], a[172:175], v[76:79], v[12:15]
  v_mfma_f32_16x16x32_bf16 v[20:23], a[180:183], v[76:79], v[20:23]
  v_mfma_f32_16x16x32_bf16 v[28:31], a[188:191], v[76:79], v[28:31]
  v_mfma_f32_16x16x32_bf16 v[36:39], a[196:199], v[76:79], v[36:39]
  v_mfma_f32_16x16x32_bf16 v[44:47], a[204:207], v[76:79], v[44:47]
  v_mfma_f32_16x16x32_bf16 v[52:55], a[212:215], v[76:79], v[52:55]
  v_mfma_f32_16x16x32_bf16 v[60:63], a[220:223], v[76:79], v[60:63]
  ds_read_b128 v[76:79], v119 offset:9216
  v_mfma_f32_16x16x32_bf16 v[16:19], a[172:175], v[80:83], v[16:19]
  v_mfma_f32_16x16x32_bf16 v[24:27], a[180:183], v[80:83], v[24:27]
  s_mov_b32 m0, s40
  s_nop 0
  buffer_load_dwordx4 v2, s[12:15], s21 offen offset:0 sc1 lds
  v_mfma_f32_16x16x32_bf16 v[32:35], a[188:191], v[80:83], v[32:35]
  v_mfma_f32_16x16x32_bf16 v[40:43], a[196:199], v[80:83], v[40:43]
  v_mfma_f32_16x16x32_bf16 v[48:51], a[204:207], v[80:83], v[48:51]
  v_mfma_f32_16x16x32_bf16 v[56:59], a[212:215], v[80:83], v[56:59]
  v_mfma_f32_16x16x32_bf16 v[64:67], a[220:223], v[80:83], v[64:67]
  ds_read_b128 v[80:83], v119 offset:23552
  buffer_load_dwordx4 v2, s[12:15], s21 offen offset:1024 sc1 lds
  s_waitcnt lgkmcnt(2)
  v_mfma_f32_16x16x32_bf16 v[12:15], a[224:227], v[68:71], v[12:15]
  v_mfma_f32_16x16x32_bf16 v[20:23], a[232:235], v[68:71], v[20:23]
  v_mfma_f32_16x16x32_bf16 v[28:31], a[240:243], v[68:71], v[28:31]
  v_mfma_f32_16x16x32_bf16 v[36:39], a[248:251], v[68:71], v[36:39]
  v_mfma_f32_16x16x32_bf16 v[44:47], v[120:123], v[68:71], v[44:47]
  buffer_load_dwordx4 v2, s[12:15], s21 offen offset:2048 sc1 lds
  v_mfma_f32_16x16x32_bf16 v[52:55], v[128:131], v[68:71], v[52:55]
  v_mfma_f32_16x16x32_bf16 v[60:63], v[136:139], v[68:71], v[60:63]
  ds_read_b128 v[68:71], v119 offset:10240
  v_mfma_f32_16x16x32_bf16 v[16:19], a[224:227], v[72:75], v[16:19]
  v_mfma_f32_16x16x32_bf16 v[24:27], a[232:235], v[72:75], v[24:27]
  buffer_load_dwordx4 v2, s[12:15], s21 offen offset:3072 sc1 lds
  s_add_u32 m0, s40, 4096
  v_mfma_f32_16x16x32_bf16 v[32:35], a[240:243], v[72:75], v[32:35]
  v_mfma_f32_16x16x32_bf16 v[40:43], a[248:251], v[72:75], v[40:43]
  v_mfma_f32_16x16x32_bf16 v[48:51], v[120:123], v[72:75], v[48:51]
  v_mfma_f32_16x16x32_bf16 v[56:59], v[128:131], v[72:75], v[56:59]
  buffer_load_dwordx4 v2, s[12:15], s27 offen offset:0 sc1 lds
  v_mfma_f32_16x16x32_bf16 v[64:67], v[136:139], v[72:75], v[64:67]
  ds_read_b128 v[72:75], v119 offset:24576
  s_waitcnt lgkmcnt(2)
  v_mfma_f32_16x16x32_bf16 v[12:15], a[228:231], v[76:79], v[12:15]
  v_mfma_f32_16x16x32_bf16 v[20:23], a[236:239], v[76:79], v[20:23]
  v_mfma_f32_16x16x32_bf16 v[28:31], a[244:247], v[76:79], v[28:31]
  buffer_load_dwordx4 v2, s[12:15], s27 offen offset:1024 sc1 lds
  v_mfma_f32_16x16x32_bf16 v[36:39], a[252:255], v[76:79], v[36:39]
  v_mfma_f32_16x16x32_bf16 v[44:47], v[124:127], v[76:79], v[44:47]
  v_mfma_f32_16x16x32_bf16 v[52:55], v[132:135], v[76:79], v[52:55]
  v_mfma_f32_16x16x32_bf16 v[60:63], v[140:143], v[76:79], v[60:63]
  ds_read_b128 v[76:79], v119 offset:11264
  buffer_load_dwordx4 v2, s[12:15], s27 offen offset:2048 sc1 lds
  v_mfma_f32_16x16x32_bf16 v[16:19], a[228:231], v[80:83], v[16:19]
  v_mfma_f32_16x16x32_bf16 v[24:27], a[236:239], v[80:83], v[24:27]
  v_mfma_f32_16x16x32_bf16 v[32:35], a[244:247], v[80:83], v[32:35]
  v_mfma_f32_16x16x32_bf16 v[40:43], a[252:255], v[80:83], v[40:43]
  v_mfma_f32_16x16x32_bf16 v[48:51], v[124:127], v[80:83], v[48:51]
  v_mfma_f32_16x16x32_bf16 v[56:59], v[132:135], v[80:83], v[56:59]
  v_mfma_f32_16x16x32_bf16 v[64:67], v[140:143], v[80:83], v[64:67]
  ds_read_b128 v[80:83], v119 offset:25600
  s_waitcnt lgkmcnt(2)
  v_mfma_f32_16x16x32_bf16 v[12:15], v[144:147], v[68:71], v[12:15]
  v_mfma_f32_16x16x32_bf16 v[20:23], v[152:155], v[68:71], v[20:23]
  v_mfma_f32_16x16x32_bf16 v[28:31], v[160:163], v[68:71], v[28:31]
  v_mfma_f32_16x16x32_bf16 v[36:39], v[168:171], v[68:71], v[36:39]
  v_mfma_f32_16x16x32_bf16 v[44:47], v[176:179], v[68:71], v[44:47]
  v_mfma_f32_16x16x32_bf16 v[52:55], v[184:187], v[68:71], v[52:55]
  v_mfma_f32_16x16x32_bf16 v[60:63], v[192:195], v[68:71], v[60:63]
  ds_read_b128 v[68:71], v119 offset:12288
  v_mfma_f32_16x16x32_bf16 v[16:19], v[144:147], v[72:75], v[16:19]
  v_mfma_f32_16x16x32_bf16 v[24:27], v[152:155], v[72:75], v[24:27]
  v_mfma_f32_16x16x32_bf16 v[32:35], v[160:163], v[72:75], v[32:35]
  v_mfma_f32_16x16x32_bf16 v[40:43], v[168:171], v[72:75], v[40:43]
  v_mfma_f32_16x16x32_bf16 v[48:51], v[176:179], v[72:75], v[48:51]
  v_mfma_f32_16x16x32_bf16 v[56:59], v[184:187], v[72:75], v[56:59]
  v_mfma_f32_16x16x32_bf16 v[64:67], v[192:195], v[72:75], v[64:67]
  ds_read_b128 v[72:75], v119 offset:26624
  s_waitcnt lgkmcnt(2)
  v_mfma_f32_16x16x32_bf16 v[12:15], v[148:151], v[76:79], v[12:15]
  v_mfma_f32_16x16x32_bf16 v[20:23], v[156:159], v[76:79], v[20:23]
  v_mfma_f32_16x16x32_bf16 v[28:31], v[164:167], v[76:79], v[28:31]
  v_mfma_f32_16x16x32_bf16 v[36:39], v[172:175], v[76:79], v[36:39]
  v_mfma_f32_16x16x32_bf16 v[44:47], v[180:183], v[76:79], v[44:47]
  v_mfma_f32_16x16x32_bf16 v[52:55], v[188:191], v[76:79], v[52:55]
  v_mfma_f32_16x16x32_bf16 v[60:63], v[196:199], v[76:79], v[60:63]
  ds_read_b128 v[76:79], v119 offset:13312
  v_mfma_f32_16x16x32_bf16 v[16:19], v[148:151], v[80:83], v[16:19]
  v_mfma_f32_16x16x32_bf16 v[24:27], v[156:159], v[80:83], v[24:27]
  v_mfma_f32_16x16x32_bf16 v[32:35], v[164:167], v[80:83], v[32:35]
  v_mfma_f32_16x16x32_bf16 v[40:43], v[172:175], v[80:83], v[40:43]
  v_mfma_f32_16x16x32_bf16 v[48:51], v[180:183], v[80:83], v[48:51]
  v_mfma_f32_16x16x32_bf16 v[56:59], v[188:191], v[80:83], v[56:59]
  v_mfma_f32_16x16x32_bf16 v[64:67], v[196:199], v[80:83], v[64:67]
  ds_read_b128 v[80:83], v119 offset:27648
  ds_read_b128 v[104:107], v5 offset:0
  s_waitcnt lgkmcnt(3)
  v_mfma_f32_16x16x32_bf16 v[12:15], v[200:203], v[68:71], v[12:15]
  ds_read_b128 v[108:111], v5 offset:14336
  ds_read_b128 v[112:115], v5 offset:1024
  v_mfma_f32_16x16x32_bf16 v[16:19], v[200:203], v[72:75], v[16:19]
  v_add_u32 v119, s43, v119
  v_mfma_f32_16x16x32_bf16 v[20:23], v[208:211], v[68:71], v[20:23]
  v_mfma_f32_16x16x32_bf16 v[24:27], v[208:211], v[72:75], v[24:27]
  s_waitcnt lgkmcnt(4)
  v_mfma_f32_16x16x32_bf16 v[12:15], v[204:207], v[76:79], v[12:15]
  v_mfma_f32_16x16x32_bf16 v[20:23], v[212:215], v[76:79], v[20:23]
  s_waitcnt lgkmcnt(3)
  v_mfma_f32_16x16x32_bf16 v[16:19], v[204:207], v[80:83], v[16:19]
  v_cvt_pk_bf16_f32 v12, v12, v13
  v_cvt_pk_bf16_f32 v13, v14, v15
  v_mfma_f32_16x16x32_bf16 v[24:27], v[212:215], v[80:83], v[24:27]
  v_cvt_pk_bf16_f32 v14, v20, v21
  v_cvt_pk_bf16_f32 v15, v22, v23
  v_mfma_f32_16x16x32_bf16 v[28:31], v[216:219], v[68:71], v[28:31]
  v_cvt_pk_bf16_f32 v16, v16, v17
  v_cvt_pk_bf16_f32 v17, v18, v19
  v_mfma_f32_16x16x32_bf16 v[32:35], v[216:219], v[72:75], v[32:35]
  v_cvt_pk_bf16_f32 v18, v24, v25
  v_cvt_pk_bf16_f32 v19, v26, v27
  s_waitcnt lgkmcnt(0)
  v_mfma_f32_16x16x32_bf16 v[84:87], v[104:107], v[12:15], 0
  v_mfma_f32_16x16x32_bf16 v[88:91], v[104:107], v[16:19], 0
  ds_read_b128 v[104:107], v5 offset:15360
  v_mfma_f32_16x16x32_bf16 v[36:39], v[224:227], v[68:71], v[36:39]
  v_mfma_f32_16x16x32_bf16 v[40:43], v[224:227], v[72:75], v[40:43]
  v_mfma_f32_16x16x32_bf16 v[28:31], v[220:223], v[76:79], v[28:31]
  v_mfma_f32_16x16x32_bf16 v[32:35], v[220:223], v[80:83], v[32:35]
  v_mfma_f32_16x16x32_bf16 v[92:95], v[108:111], v[16:19], 0
  ds_read_b128 v[108:111], v5 offset:2048
  v_cvt_pk_bf16_f32 v28, v28, v29
  v_mfma_f32_16x16x32_bf16 v[44:47], v[232:235], v[68:71], v[44:47]
  v_cvt_pk_bf16_f32 v32, v32, v33
  v_cvt_pk_bf16_f32 v29, v30, v31
  v_mfma_f32_16x16x32_bf16 v[48:51], v[232:235], v[72:75], v[48:51]
  v_cvt_pk_bf16_f32 v33, v34, v35
  v_mfma_f32_16x16x32_bf16 v[36:39], v[228:231], v[76:79], v[36:39]
  v_mfma_f32_16x16x32_bf16 v[40:43], v[228:231], v[80:83], v[40:43]
  v_mfma_f32_16x16x32_bf16 v[52:55], v[240:243], v[68:71], v[52:55]
  v_cvt_pk_bf16_f32 v30, v36, v37
  v_cvt_pk_bf16_f32 v31, v38, v39
  v_mfma_f32_16x16x32_bf16 v[56:59], v[240:243], v[72:75], v[56:59]
  v_cvt_pk_bf16_f32 v34, v40, v41
  v_cvt_pk_bf16_f32 v35, v42, v43
  v_mfma_f32_16x16x32_bf16 v[44:47], v[236:239], v[76:79], v[44:47]
  v_mfma_f32_16x16x32_bf16 v[48:51], v[236:239], v[80:83], v[48:51]
  v_mfma_f32_16x16x32_bf16 v[52:55], v[244:247], v[76:79], v[52:55]
  v_cvt_pk_bf16_f32 v44, v44, v45
  v_cvt_pk_bf16_f32 v45, v46, v47
  v_mfma_f32_16x16x32_bf16 v[56:59], v[244:247], v[80:83], v[56:59]
  v_cvt_pk_bf16_f32 v48, v48, v49
  v_cvt_pk_bf16_f32 v49, v50, v51
  v_mfma_f32_16x16x32_bf16 v[60:63], v[248:251], v[68:71], v[60:63]
  buffer_load_dwordx4 v[68:71], v7, s[12:15], s22 offen offset:0 sc1
  v_cvt_pk_bf16_f32 v46, v52, v53
  v_mfma_f32_16x16x32_bf16 v[84:87], v[112:115], v[28:31], v[84:87]
  v_cvt_pk_bf16_f32 v47, v54, v55
  v_cvt_pk_bf16_f32 v50, v56, v57
  v_mfma_f32_16x16x32_bf16 v[88:91], v[112:115], v[32:35], v[88:91]
  ds_read_b128 v[112:115], v5 offset:16384
  v_cvt_pk_bf16_f32 v51, v58, v59
  s_waitcnt lgkmcnt(1)
  v_mfma_f32_16x16x32_bf16 v[92:95], v[104:107], v[32:35], v[92:95]
  ds_read_b64 v[104:105], v6 offset:0
  v_add_u32 v5, s43, v5
  v_mfma_f32_16x16x32_bf16 v[84:87], v[108:111], v[44:47], v[84:87]
  v_mfma_f32_16x16x32_bf16 v[88:91], v[108:111], v[48:51], v[88:91]
  ds_read_b64 v[108:109], v6 offset:14336
  v_add_u32 v6, s43, v6
  v_mfma_f32_16x16x32_bf16 v[64:67], v[248:251], v[72:75], v[64:67]
  buffer_load_dwordx4 v[72:75], v7, s[12:15], s22 offen offset:512 sc1
  v_mfma_f32_16x16x32_bf16 v[60:63], v[252:255], v[76:79], v[60:63]
  v_mfma_f32_16x16x32_bf16 v[64:67], v[252:255], v[80:83], v[64:67]
  s_waitcnt lgkmcnt(2)
  v_mfma_f32_16x16x32_bf16 v[92:95], v[112:115], v[48:51], v[92:95]
  v_cvt_pk_bf16_f32 v60, v60, v61
  v_cvt_pk_bf16_f32 v61, v62, v63
  s_nop 1
  v_cvt_pk_bf16_f32 v64, v64, v65
  s_waitcnt lgkmcnt(1)
  v_mfma_f32_16x16x16_bf16 v[84:87], v[104:105], v[60:61], v[84:87]
  buffer_load_dwordx4 v[76:79], v7, s[12:15], s22 offen offset:1024 sc1
  v_cvt_pk_bf16_f32 v65, v66, v67
  s_nop 1
  v_mfma_f32_16x16x16_bf16 v[88:91], v[104:105], v[64:65], v[88:91]
  s_waitcnt lgkmcnt(0)
  v_mfma_f32_16x16x16_bf16 v[92:95], v[108:109], v[64:65], v[92:95]
  ds_write_b128 v9, v[84:87] offset:0
  s_nop 2
  ds_write_b128 v9, v[88:91] offset:1024
  buffer_load_dwordx2 v[80:81], v8, s[12:15], s22 offen sc1
  s_nop 1
  ds_write_b128 v9, v[92:95] offset:2048
  s_waitcnt vmcnt(4)
  ds_read_b128 v[20:23], v3 offset:0
  ds_read_b128 v[24:27], v3 offset:1024
  ds_read_b128 v[36:39], v3 offset:2048
  ds_read_b128 v[40:43], v3 offset:3072
  ds_read_b128 v[52:55], v3 offset:4096
  ds_read_b128 v[56:59], v3 offset:5120
  ds_read_b128 v[104:107], v3 offset:6144
  s_waitcnt lgkmcnt(0)
  v_max3_u32 v4, v20, v21, v22
  v_max3_u32 v4, v4, v23, v24
  v_max3_u32 v4, v4, v25, v26
  v_max3_u32 v4, v4, v27, v36
  v_max3_u32 v4, v4, v37, v38
  v_max3_u32 v4, v4, v39, v40
  v_max3_u32 v4, v4, v41, v42
  v_max3_u32 v4, v4, v43, v52
  v_max3_u32 v4, v4, v53, v54
  v_max3_u32 v4, v4, v55, v56
  v_max3_u32 v4, v4, v57, v58
  v_max3_u32 v4, v4, v59, v104
  v_max3_u32 v4, v4, v105, v106
  v_max_u32 v4, v4, v107
  v_cmp_eq_u32 vcc, -1, v4
  s_cmp_eq_u64 vcc, 0
  s_cselect_b32 s50, 1, 0
  s_mov_b32 s25, 0
  s_waitcnt vmcnt(0)
  v_max3_u32 v4, v68, v69, v70
  v_max3_u32 v4, v4, v71, v72
  v_max3_u32 v4, v4, v73, v74
  v_max3_u32 v4, v4, v75, v76
  v_max3_u32 v4, v4, v77, v78
  v_max3_u32 v4, v4, v79, v80
  v_max_u32 v4, v4, v81
  v_cmp_eq_u32 vcc, -1, v4
  s_cbranch_vccz PA_M_OK
PA_M_L:
  buffer_load_dwordx4 v[68:71], v7, s[12:15], s22 offen offset:0 sc1
  buffer_load_dwordx4 v[72:75], v7, s[12:15], s22 offen offset:512 sc1
  buffer_load_dwordx4 v[76:79], v7, s[12:15], s22 offen offset:1024 sc1
  buffer_load_dwordx2 v[80:81], v8, s[12:15], s22 offen sc1
  s_add_u32 s25, s25, 1
  s_cmp_gt_u32 s25, 131072
  s_mov_b32 s99, 9
  s_cbranch_scc1 FAIL
  s_waitcnt vmcnt(0)
  v_max3_u32 v4, v68, v69, v70
  v_max3_u32 v4, v4, v71, v72
  v_max3_u32 v4, v4, v73, v74
  v_max3_u32 v4, v4, v75, v76
  v_max3_u32 v4, v4, v77, v78
  v_max3_u32 v4, v4, v79, v80
  v_max_u32 v4, v4, v81
  v_cmp_eq_u32 vcc, -1, v4
  s_cbranch_vccz PA_M_OK
  s_sleep 1
  s_branch PA_M_L
PA_M_OK:
  v_mfma_f32_16x16x32_bf16 v[96:99], v[68:71], v[12:15], 0
  v_mfma_f32_16x16x32_bf16 v[100:103], v[68:71], v[16:19], 0
  v_mfma_f32_16x16x32_bf16 v[96:99], v[72:75], v[28:31], v[96:99]
  v_mfma_f32_16x16x32_bf16 v[100:103], v[72:75], v[32:35], v[100:103]
  v_mfma_f32_16x16x32_bf16 v[96:99], v[76:79], v[44:47], v[96:99]
  v_mfma_f32_16x16x32_bf16 v[100:103], v[76:79], v[48:51], v[100:103]
  v_mfma_f32_16x16x16_bf16 v[96:99], v[80:81], v[60:61], v[96:99]
  v_mfma_f32_16x16x16_bf16 v[100:103], v[80:81], v[64:65], v[100:103]
  s_nop 3
  ds_write_b128 v9, v[96:99] offset:3072
  s_nop 2
  ds_write_b128 v9, v[100:103] offset:4096
  s_waitcnt lgkmcnt(0)
  s_barrier
  ds_read2st64_b64 v[84:87], v10 offset0:0 offset1:10
  ds_read2st64_b64 v[88:91], v10 offset0:20 offset1:30
  ds_read2st64_b64 v[92:95], v10 offset0:2 offset1:12
  ds_read2st64_b64 v[96:99], v10 offset0:22 offset1:32
  ds_read2st64_b64 v[100:103], v10 offset0:6 offset1:16
  ds_read2st64_b64 v[104:107], v10 offset0:26 offset1:36
  s_waitcnt lgkmcnt(4)
  v_pk_add_f32 v[84:85], v[84:85], v[86:87]
  v_pk_add_f32 v[88:89], v[88:89], v[90:91]
  v_pk_add_f32 v[84:85], v[84:85], v[88:89]
  s_waitcnt lgkmcnt(2)
  v_pk_add_f32 v[92:93], v[92:93], v[94:95]
  v_pk_add_f32 v[96:97], v[96:97], v[98:99]
  v_pk_add_f32 v[92:93], v[92:93], v[96:97]
  s_waitcnt lgkmcnt(0)
  v_pk_add_f32 v[100:101], v[100:101], v[102:103]
  v_pk_add_f32 v[104:105], v[104:105], v[106:107]
  v_pk_add_f32 v[100:101], v[100:101], v[104:105]
  v_mov_b32 v87, s39
  v_cndmask_b32 v84, v84, v87, s[30:31]
  v_cndmask_b32 v85, v85, v87, s[32:33]
  v_cndmask_b32 v92, v92, v87, s[34:35]
  v_cndmask_b32 v93, v93, v87, s[36:37]
  v_max3_f32 v86, v84, v85, v92
  v_max3_f32 v87, v93, v100, v101
  v_max_f32 v86, v86, v87
  s_nop 1
  v_max_f32_dpp v86, v86, v86 row_ror:8 row_mask:0xf bank_mask:0xf
  v_mov_b32 v87, v86
  s_nop 1
  v_permlane16_swap_b32 v86, v87
  v_max_f32 v86, v86, v87
  v_mov_b32 v87, v86
  s_nop 1
  v_permlane32_swap_b32 v86, v87
  v_max_f32 v86, v86, v87
  v_pk_add_f32 v[84:85], v[84:85], v[86:87] op_sel_hi:[1,0] neg_lo:[0,1] neg_hi:[0,1]
  v_pk_add_f32 v[92:93], v[92:93], v[86:87] op_sel_hi:[1,0] neg_lo:[0,1] neg_hi:[0,1]
  v_pk_add_f32 v[100:101], v[100:101], v[86:87] op_sel_hi:[1,0] neg_lo:[0,1] neg_hi:[0,1]
  v_exp_f32 v100, v100
  v_exp_f32 v101, v101
  v_exp_f32 v84, v84
  v_exp_f32 v85, v85
  v_exp_f32 v92, v92
  v_exp_f32 v93, v93
  v_add_f32 v86, v100, v101
  v_add_f32 v87, v84, v85
  v_fma_f32 v86, v86, 0.5, v92
  v_add_f32 v87, v87, v93
  v_add_f32 v86, v86, v87
  s_nop 1
  v_add_f32_dpp v86, v86, v86 row_ror:8 row_mask:0xf bank_mask:0xf
  v_mov_b32 v87, v86
  s_nop 1
  v_permlane16_swap_b32 v86, v87
  v_add_f32 v86, v86, v87
  v_mov_b32 v87, v86
  s_nop 1
  v_permlane32_swap_b32 v86, v87
  v_add_f32 v86, v86, v87
  v_rcp_f32 v86, v86
  s_nop 0
  v_pk_mul_f32 v[84:85], v[84:85], v[86:87] op_sel_hi:[1,0]
  v_pk_mul_f32 v[92:93], v[92:93], v[86:87] op_sel_hi:[1,0]
  v_pk_mul_f32 v[100:101], v[100:101], v[86:87] op_sel_hi:[1,0]
  v_cvt_pk_bf16_f32 v88, v84, v85
  v_cvt_pk_bf16_f32 v90, v92, v93
  v_cvt_pk_bf16_f32 v96, v100, v101
  v_mov_b32_dpp v89, v88 row_ror:8 row_mask:0xf bank_mask:0xf
  v_mov_b32_dpp v91, v90 row_ror:8 row_mask:0xf bank_mask:0xf
  v_mov_b32_dpp v97, v96 row_ror:8 row_mask:0xf bank_mask:0xf
  s_mov_b32 exec_lo, 0x00ff00ff
  s_mov_b32 exec_hi, 0x00ff00ff
  s_cmp_eq_u32 s28, 0
  s_cbranch_scc1 PA_Q0
  buffer_store_dwordx4 v[88:91], v11, s[12:15], s23 offen sc1
  buffer_store_dwordx2 v[96:97], v0, s[12:15], s23 offen sc1
  s_branch PA_STD
PA_Q0:
  s_bitcmp1_b32 s17, 0
  s_cbranch_scc1 PA_Q0ODD
  v_mov_b32 v90, v96
  v_mov_b32 v91, v97
  buffer_store_dwordx4 v[88:91], v11, s[12:15], s23 offen sc1
  s_branch PA_STD
PA_Q0ODD:
  v_mov_b32 v98, v88
  v_mov_b32 v99, v89
  buffer_store_dwordx4 v[96:99], v11, s[12:15], s23 offen sc1
PA_STD:
  s_mov_b64 exec, -1
  s_add_u32 s22, s22, 57344
  s_add_u32 s23, s23, 81920
  s_cmp_lt_u32 s24, 64
  s_cbranch_scc1 PA_TASK
  s_endpgm
PB:
  v_lshlrev_b32 v2, 4, v1
  v_lshlrev_b32 v9, 3, v1
  v_mov_b32 v10, 0
  v_and_b32 v4, 1, v1
  v_cmp_eq_u32 vcc, 0, v4
  v_mov_b32 v5, 0xeeee
  v_mov_b32 v4, 0x4444
  v_cndmask_b32 v5, v5, v4, vcc
  s_lshl_b32 s34, s17, 2
  s_add_u32 s34, s34, s3
  s_mul_i32 s20, s34, 114688
  s_add_u32 s20, s20, 6422528
  s_mul_i32 s35, s3, 14336
  s_add_u32 s35, s35, 28672
  v_add_u32 v6, s35, v2
  v_lshrrev_b32 v12, 4, v1
  s_lshl_b32 s56, s3, 2
  v_add_u32 v12, s56, v12
  v_lshl_add_u32 v12, v12, 1, 1
  v_and_b32 v13, 15, v1
  v_min_u32 v13, 4, v13
  v_lshlrev_b32 v13, 2, v13
  v_lshl_add_u32 v12, v12, 7, v13
  s_mov_b32 s58, 17903616
  s_mov_b32 s59, 0
  s_mov_b32 s56, 0x7f
PB_WL:
  buffer_load_dword v13, v12, s[12:15], s58 offen sc1
  s_add_u32 s59, s59, 1
  s_cmp_gt_u32 s59, 131072
  s_mov_b32 s99, 18
  s_cbranch_scc1 FAIL
  s_waitcnt vmcnt(0)
  v_subrev_u32 v13, s90, v13
  v_cmp_gt_u32 vcc, 8, v13
  s_nop 1
  v_cndmask_b32 v13, 0, v13, vcc
  s_mov_b32 s55, 0
  v_cmp_gt_u32 vcc, 1, v13
  s_cmp_eq_u64 vcc, 0
  s_cselect_b32 s55, 3, s55
  v_cmp_gt_u32 vcc, 2, v13
  s_cmp_eq_u64 vcc, 0
  s_cselect_b32 s55, 15, s55
  v_cmp_gt_u32 vcc, 3, v13
  s_cmp_eq_u64 vcc, 0
  s_cselect_b32 s55, 63, s55
  v_cmp_gt_u32 vcc, 4, v13
  s_cmp_eq_u64 vcc, 0
  s_cselect_b32 s55, 127, s55
  s_and_b32 s55, s55, s56
  s_andn2_b32 s56, s56, s55
  s_bitcmp1_b32 s55, 0
  s_cbranch_scc0 PB_WS0
  s_add_u32 s57, s20, 0
  buffer_load_dwordx4 a[0:3], v2, s[12:15], s57 offen offset:0
  buffer_load_dwordx4 a[4:7], v2, s[12:15], s57 offen offset:1024
  buffer_load_dwordx4 a[8:11], v2, s[12:15], s57 offen offset:2048
  buffer_load_dwordx4 a[12:15], v2, s[12:15], s57 offen offset:3072
  s_add_u32 s57, s20, 4096
  buffer_load_dwordx4 a[16:19], v2, s[12:15], s57 offen offset:0
  buffer_load_dwordx4 a[20:23], v2, s[12:15], s57 offen offset:1024
  buffer_load_dwordx4 a[24:27], v2, s[12:15], s57 offen offset:2048
  buffer_load_dwordx4 a[28:31], v2, s[12:15], s57 offen offset:3072
  s_add_u32 s57, s20, 8192
  buffer_load_dwordx4 a[32:35], v2, s[12:15], s57 offen offset:0
  buffer_load_dwordx4 a[36:39], v2, s[12:15], s57 offen offset:1024
  buffer_load_dwordx4 a[40:43], v2, s[12:15], s57 offen offset:2048
  buffer_load_dwordx4 a[44:47], v2, s[12:15], s57 offen offset:3072
  s_add_u32 s57, s20, 12288
  buffer_load_dwordx4 a[48:51], v2, s[12:15], s57 offen offset:0
  buffer_load_dwordx4 a[52:55], v2, s[12:15], s57 offen offset:1024
  buffer_load_dwordx4 a[56:59], v2, s[12:15], s57 offen offset:2048
  buffer_load_dwordx4 a[60:63], v2, s[12:15], s57 offen offset:3072
PB_WS0:
  s_bitcmp1_b32 s55, 1
  s_cbranch_scc0 PB_WS1
  s_add_u32 s57, s20, 16384
  buffer_load_dwordx4 a[64:67], v2, s[12:15], s57 offen offset:0
  buffer_load_dwordx4 a[68:71], v2, s[12:15], s57 offen offset:1024
  buffer_load_dwordx4 a[72:75], v2, s[12:15], s57 offen offset:2048
  buffer_load_dwordx4 a[76:79], v2, s[12:15], s57 offen offset:3072
  s_add_u32 s57, s20, 20480
  buffer_load_dwordx4 a[80:83], v2, s[12:15], s57 offen offset:0
  buffer_load_dwordx4 a[84:87], v2, s[12:15], s57 offen offset:1024
  buffer_load_dwordx4 a[88:91], v2, s[12:15], s57 offen offset:2048
  buffer_load_dwordx4 a[92:95], v2, s[12:15], s57 offen offset:3072
  s_add_u32 s57, s20, 24576
  buffer_load_dwordx4 a[96:99], v2, s[12:15], s57 offen offset:0
  buffer_load_dwordx4 a[100:103], v2, s[12:15], s57 offen offset:1024
  buffer_load_dwordx4 a[104:107], v2, s[12:15], s57 offen offset:2048
  buffer_load_dwordx4 a[108:111], v2, s[12:15], s57 offen offset:3072
  s_add_u32 s57, s20, 28672
  buffer_load_dwordx4 a[112:115], v2, s[12:15], s57 offen offset:0
  buffer_load_dwordx4 a[116:119], v2, s[12:15], s57 offen offset:1024
  buffer_load_dwordx4 a[120:123], v2, s[12:15], s57 offen offset:2048
  buffer_load_dwordx4 a[124:127], v2, s[12:15], s57 offen offset:3072
PB_WS1:
  s_bitcmp1_b32 s55, 2
  s_cbranch_scc0 PB_WS2
  s_add_u32 s57, s20, 32768
  buffer_load_dwordx4 a[128:131], v2, s[12:15], s57 offen offset:0
  buffer_load_dwordx4 a[132:135], v2, s[12:15], s57 offen offset:1024
  buffer_load_dwordx4 a[136:139], v2, s[12:15], s57 offen offset:2048
  buffer_load_dwordx4 a[140:143], v2, s[12:15], s57 offen offset:3072
  s_add_u32 s57, s20, 36864
  buffer_load_dwordx4 a[144:147], v2, s[12:15], s57 offen offset:0
  buffer_load_dwordx4 a[148:151], v2, s[12:15], s57 offen offset:1024
  buffer_load_dwordx4 a[152:155], v2, s[12:15], s57 offen offset:2048
  buffer_load_dwordx4 a[156:159], v2, s[12:15], s57 offen offset:3072
  s_add_u32 s57, s20, 40960
  buffer_load_dwordx4 a[160:163], v2, s[12:15], s57 offen offset:0
  buffer_load_dwordx4 a[164:167], v2, s[12:15], s57 offen offset:1024
  buffer_load_dwordx4 a[168:171], v2, s[12:15], s57 offen offset:2048
  buffer_load_dwordx4 a[172:175], v2, s[12:15], s57 offen offset:3072
  s_add_u32 s57, s20, 45056
  buffer_load_dwordx4 a[176:179], v2, s[12:15], s57 offen offset:0
  buffer_load_dwordx4 a[180:183], v2, s[12:15], s57 offen offset:1024
  buffer_load_dwordx4 a[184:187], v2, s[12:15], s57 offen offset:2048
  buffer_load_dwordx4 a[188:191], v2, s[12:15], s57 offen offset:3072
PB_WS2:
  s_bitcmp1_b32 s55, 3
  s_cbranch_scc0 PB_WS3
  s_add_u32 s57, s20, 49152
  buffer_load_dwordx4 a[192:195], v2, s[12:15], s57 offen offset:0
  buffer_load_dwordx4 a[196:199], v2, s[12:15], s57 offen offset:1024
  buffer_load_dwordx4 a[200:203], v2, s[12:15], s57 offen offset:2048
  buffer_load_dwordx4 a[204:207], v2, s[12:15], s57 offen offset:3072
  s_add_u32 s57, s20, 53248
  buffer_load_dwordx4 a[208:211], v2, s[12:15], s57 offen offset:0
  buffer_load_dwordx4 a[212:215], v2, s[12:15], s57 offen offset:1024
  buffer_load_dwordx4 a[216:219], v2, s[12:15], s57 offen offset:2048
  buffer_load_dwordx4 a[220:223], v2, s[12:15], s57 offen offset:3072
  s_add_u32 s57, s20, 57344
  buffer_load_dwordx4 a[224:227], v2, s[12:15], s57 offen offset:0
  buffer_load_dwordx4 a[228:231], v2, s[12:15], s57 offen offset:1024
  buffer_load_dwordx4 a[232:235], v2, s[12:15], s57 offen offset:2048
  buffer_load_dwordx4 a[236:239], v2, s[12:15], s57 offen offset:3072
  s_add_u32 s57, s20, 61440
  buffer_load_dwordx4 a[240:243], v2, s[12:15], s57 offen offset:0
  buffer_load_dwordx4 a[244:247], v2, s[12:15], s57 offen offset:1024
  buffer_load_dwordx4 a[248:251], v2, s[12:15], s57 offen offset:2048
  buffer_load_dwordx4 a[252:255], v2, s[12:15], s57 offen offset:3072
PB_WS3:
  s_bitcmp1_b32 s55, 4
  s_cbranch_scc0 PB_WS4
  s_add_u32 s57, s20, 65536
  buffer_load_dwordx4 v[120:123], v2, s[12:15], s57 offen offset:0
  buffer_load_dwordx4 v[124:127], v2, s[12:15], s57 offen offset:1024
  buffer_load_dwordx4 v[128:131], v2, s[12:15], s57 offen offset:2048
  buffer_load_dwordx4 v[132:135], v2, s[12:15], s57 offen offset:3072
  s_add_u32 s57, s20, 69632
  buffer_load_dwordx4 v[136:139], v2, s[12:15], s57 offen offset:0
  buffer_load_dwordx4 v[140:143], v2, s[12:15], s57 offen offset:1024
  buffer_load_dwordx4 v[144:147], v2, s[12:15], s57 offen offset:2048
  buffer_load_dwordx4 v[148:151], v2, s[12:15], s57 offen offset:3072
  s_add_u32 s57, s20, 73728
  buffer_load_dwordx4 v[152:155], v2, s[12:15], s57 offen offset:0
  buffer_load_dwordx4 v[156:159], v2, s[12:15], s57 offen offset:1024
  buffer_load_dwordx4 v[160:163], v2, s[12:15], s57 offen offset:2048
  buffer_load_dwordx4 v[164:167], v2, s[12:15], s57 offen offset:3072
  s_add_u32 s57, s20, 77824
  buffer_load_dwordx4 v[168:171], v2, s[12:15], s57 offen offset:0
  buffer_load_dwordx4 v[172:175], v2, s[12:15], s57 offen offset:1024
  buffer_load_dwordx4 v[176:179], v2, s[12:15], s57 offen offset:2048
  buffer_load_dwordx4 v[180:183], v2, s[12:15], s57 offen offset:3072
PB_WS4:
  s_bitcmp1_b32 s55, 5
  s_cbranch_scc0 PB_WS5
  s_add_u32 s57, s20, 81920
  buffer_load_dwordx4 v[184:187], v2, s[12:15], s57 offen offset:0
  buffer_load_dwordx4 v[188:191], v2, s[12:15], s57 offen offset:1024
  buffer_load_dwordx4 v[192:195], v2, s[12:15], s57 offen offset:2048
  buffer_load_dwordx4 v[196:199], v2, s[12:15], s57 offen offset:3072
  s_add_u32 s57, s20, 86016
  buffer_load_dwordx4 v[200:203], v2, s[12:15], s57 offen offset:0
  buffer_load_dwordx4 v[204:207], v2, s[12:15], s57 offen offset:1024
  buffer_load_dwordx4 v[208:211], v2, s[12:15], s57 offen offset:2048
  buffer_load_dwordx4 v[212:215], v2, s[12:15], s57 offen offset:3072
  s_add_u32 s57, s20, 90112
  buffer_load_dwordx4 v[216:219], v2, s[12:15], s57 offen offset:0
  buffer_load_dwordx4 v[220:223], v2, s[12:15], s57 offen offset:1024
  buffer_load_dwordx4 v[224:227], v2, s[12:15], s57 offen offset:2048
  buffer_load_dwordx4 v[228:231], v2, s[12:15], s57 offen offset:3072
  s_add_u32 s57, s20, 94208
  buffer_load_dwordx4 v[232:235], v2, s[12:15], s57 offen offset:0
  buffer_load_dwordx4 v[236:239], v2, s[12:15], s57 offen offset:1024
  buffer_load_dwordx4 v[240:243], v2, s[12:15], s57 offen offset:2048
  buffer_load_dwordx4 v[244:247], v2, s[12:15], s57 offen offset:3072
PB_WS5:
  s_bitcmp1_b32 s55, 6
  s_cbranch_scc0 PB_WS6
  s_add_u32 s57, s20, 98304
  buffer_load_dwordx4 v[248:251], v2, s[12:15], s57 offen offset:0
  buffer_load_dwordx4 v[252:255], v2, s[12:15], s57 offen offset:1024
  s_add_u32 m0, s35, -2048
  s_nop 0
  buffer_load_dwordx4 v2, s[12:15], s57 offen offset:2048 lds
  s_add_u32 m0, s35, -2048
  s_nop 0
  buffer_load_dwordx4 v2, s[12:15], s57 offen offset:3072 lds
  s_add_u32 s57, s20, 102400
  s_add_u32 m0, s35, 2048
  s_nop 0
  buffer_load_dwordx4 v2, s[12:15], s57 offen offset:0 lds
  s_add_u32 m0, s35, 2048
  s_nop 0
  buffer_load_dwordx4 v2, s[12:15], s57 offen offset:1024 lds
  s_add_u32 m0, s35, 2048
  s_nop 0
  buffer_load_dwordx4 v2, s[12:15], s57 offen offset:2048 lds
  s_add_u32 m0, s35, 2048
  s_nop 0
  buffer_load_dwordx4 v2, s[12:15], s57 offen offset:3072 lds
  s_add_u32 s57, s20, 106496
  s_add_u32 m0, s35, 6144
  s_nop 0
  buffer_load_dwordx4 v2, s[12:15], s57 offen offset:0 lds
  s_add_u32 m0, s35, 6144
  s_nop 0
  buffer_load_dwordx4 v2, s[12:15], s57 offen offset:1024 lds
  s_add_u32 m0, s35, 6144
  s_nop 0
  buffer_load_dwordx4 v2, s[12:15], s57 offen offset:2048 lds
  s_add_u32 m0, s35, 6144
  s_nop 0
  buffer_load_dwordx4 v2, s[12:15], s57 offen offset:3072 lds
  s_add_u32 s57, s20, 110592
  s_add_u32 m0, s35, 10240
  s_nop 0
  buffer_load_dwordx4 v2, s[12:15], s57 offen offset:0 lds
  s_add_u32 m0, s35, 10240
  s_nop 0
  buffer_load_dwordx4 v2, s[12:15], s57 offen offset:1024 lds
  s_add_u32 m0, s35, 10240
  s_nop 0
  buffer_load_dwordx4 v2, s[12:15], s57 offen offset:2048 lds
  s_add_u32 m0, s35, 10240
  s_nop 0
  buffer_load_dwordx4 v2, s[12:15], s57 offen offset:3072 lds
PB_WS6:
  s_cmp_eq_u32 s56, 0
  s_cbranch_scc1 PB_WE
  s_sleep 3
  s_branch PB_WL
PB_WE:
  s_waitcnt vmcnt(0)
  s_cmp_lg_u32 s3, 0
  s_cbranch_scc1 PB_TA_B
  v_lshrrev_b32 v16, 1, v1
  v_lshlrev_b32 v16, 7, v16
  v_and_b32 v17, 1, v1
  v_lshl_add_u32 v16, v17, 4, v16
  s_mov_b32 s58, 17895424
  s_mov_b32 s59, 0
PB_TA_L:
  buffer_load_dwordx4 v[12:15], v16, s[12:15], s58 offen sc1
  s_add_u32 s59, s59, 1
  s_cmp_gt_u32 s59, 131072
  s_mov_b32 s99, 18
  s_cbranch_scc1 FAIL
  s_waitcnt vmcnt(0)
  v_xor_b32 v12, s90, v12
  v_xor_b32 v13, s90, v13
  v_xor_b32 v14, s90, v14
  v_xor_b32 v15, s90, v15
  v_or3_b32 v12, v12, v13, v14
  v_or_b32 v12, v12, v15
  v_cmp_ne_u32 vcc, 0, v12
  s_cbranch_vccz PB_TA_B
  s_sleep 4
  s_branch PB_TA_L
PB_TA_B:
  s_barrier
  s_mul_i32 s36, s3, 7168
  s_add_u32 s37, s36, 0
  v_add_u32 v3, s37, v2
  s_lshl_b32 s37, s3, 13
  s_add_u32 s37, s37, 86016
  v_add_u32 v7, s37, v2
  s_lshl_b32 s37, s3, 10
  s_add_u32 s37, s37, 86016
  v_add_u32 v8, s37, v2
  s_lshl_b32 s38, s16, 6
  s_add_u32 s38, s38, s18
  s_mov_b32 s21, 16056320
  s_cmp_eq_u32 s16, 1
  s_cselect_b32 s21, 78462976, s21
  s_cselect_b32 s29, 83968000, 0
  s_cselect_b32 s44, s4, s6
  s_cselect_b32 s45, s5, s7
  s_mov_b32 s46, 1835008
  s_cselect_b32 s46, 268435456, s46
  s_mov_b32 s47, 0x20000
  s_cselect_b32 s48, 10, 6
  s_cselect_b32 s49, 8, 32
  s_cselect_b64 vcc, -1, 0
  v_and_b32 v4, 15, v1
  v_mul_u32_u24 v11, 896, v4
  v_lshrrev_b32 v4, 4, v1
  v_lshl_add_u32 v11, v4, 3, v11
  v_cndmask_b32 v11, v11, v2, vcc
  v_add_u32 v0, s49, v11
  s_mul_i32 s37, s18, 28672
  s_add_u32 s21, s21, s37
  s_add_u32 s21, s21, s36
  s_mul_i32 s39, s3, 14336
  s_lshl_b32 s40, s17, 10
  s_add_u32 s29, s29, s37
  s_add_u32 s29, s29, s39
  s_add_u32 s39, s39, s40
  s_lshl_b32 s40, s17, s48
  s_add_u32 s29, s29, s40
  s_mul_i32 s30, s38, 28672
  s_add_u32 s30, s30, s39
  s_add_u32 s30, s30, 80297984
  s_mul_i32 s23, s38, 458752
  s_lshl_b32 s37, s34, 13
  s_add_u32 s23, s23, s37
  s_add_u32 s23, s23, 17907712
  s_mul_i32 s24, s38, 1792
  s_lshl_b32 s37, s17, 7
  s_add_u32 s24, s24, s37
  s_lshl_b32 s37, s3, 2
  s_add_u32 s24, s24, s37
  s_add_u32 s24, s24, 91242496
  s_mul_i32 s27, s16, 14336
  s_mul_i32 s37, s18, 28672
  s_add_u32 s27, s27, s37
  s_add_u32 s27, s27, 76627968
  s_mul_i32 s28, s38, 40960
  s_mul_i32 s37, s3, 10240
  s_add_u32 s28, s28, s37
  s_add_u32 s28, s28, 85999616
  s_mov_b32 s25, s18
  s_mov_b32 s41, 32768
  s_waitcnt vmcnt(0)
  v_and_b32 v4, 3, v1
  v_mul_u32_u24 v12, 2560, v4
  v_bfe_u32 v4, v1, 2, 1
  v_lshl_add_u32 v12, v4, 7, v12
  v_bfe_u32 v4, v1, 3, 1
  v_lshl_add_u32 v1, v4, 10, v12
  s_add_u32 s22, s21, 4096
  s_mov_b32 m0, s36
  s_nop 0
  buffer_load_dwordx4 v2, s[12:15], s21 offen offset:0 sc1 lds
  buffer_load_dwordx4 v2, s[12:15], s21 offen offset:1024 sc1 lds
  buffer_load_dwordx4 v2, s[12:15], s21 offen offset:2048 sc1 lds
  buffer_load_dwordx4 v2, s[12:15], s21 offen offset:3072 sc1 lds
  s_add_u32 m0, s36, 4096
  s_nop 0
  buffer_load_dwordx4 v2, s[12:15], s22 offen offset:0 sc1 lds
  buffer_load_dwordx4 v2, s[12:15], s22 offen offset:1024 sc1 lds
  buffer_load_dwordx4 v2, s[12:15], s22 offen offset:2048 sc1 lds
  s_waitcnt vmcnt(0)
  ds_read_b128 v[12:15], v3 offset:0
  ds_read_b128 v[16:19], v3 offset:1024
  ds_read_b128 v[20:23], v3 offset:2048
  ds_read_b128 v[24:27], v3 offset:3072
  ds_read_b128 v[28:31], v3 offset:4096
  ds_read_b128 v[32:35], v3 offset:5120
  ds_read_b128 v[36:39], v3 offset:6144
  s_waitcnt lgkmcnt(0)
  v_max3_u32 v4, v12, v13, v14
  v_max3_u32 v4, v4, v15, v16
  v_max3_u32 v4, v4, v17, v18
  v_max3_u32 v4, v4, v19, v20
  v_max3_u32 v4, v4, v21, v22
  v_max3_u32 v4, v4, v23, v24
  v_max3_u32 v4, v4, v25, v26
  v_max3_u32 v4, v4, v27, v28
  v_max3_u32 v4, v4, v29, v30
  v_max3_u32 v4, v4, v31, v32
  v_max3_u32 v4, v4, v33, v34
  v_max3_u32 v4, v4, v35, v36
  v_max3_u32 v4, v4, v37, v38
  v_max_u32 v4, v4, v39
  v_cmp_eq_u32 vcc, -1, v4
  s_cmp_eq_u64 vcc, 0
  s_cselect_b32 s50, 1, 0
PB_PRE:
  s_add_u32 s32, s23, 4096
  s_add_u32 s51, s27, 4096
  s_cmp_eq_u32 s50, 1
  s_cbranch_scc1 PB_XOK
  s_mov_b32 s26, 0
PB_X_L:
  buffer_load_dwordx4 v[12:15], v2, s[12:15], s21 offen offset:0 sc1
  buffer_load_dwordx4 v[16:19], v2, s[12:15], s21 offen offset:1024 sc1
  buffer_load_dwordx4 v[20:23], v2, s[12:15], s21 offen offset:2048 sc1
  buffer_load_dwordx4 v[24:27], v2, s[12:15], s21 offen offset:3072 sc1
  buffer_load_dwordx4 v[28:31], v2, s[12:15], s22 offen offset:0 sc1
  buffer_load_dwordx4 v[32:35], v2, s[12:15], s22 offen offset:1024 sc1
  buffer_load_dwordx4 v[36:39], v2, s[12:15], s22 offen offset:2048 sc1
  s_add_u32 s26, s26, 1
  s_cmp_gt_u32 s26, 131072
  s_mov_b32 s99, 10
  s_cbranch_scc1 FAIL
  s_waitcnt vmcnt(0)
  v_max3_u32 v4, v12, v13, v14
  v_max3_u32 v4, v4, v15, v16
  v_max3_u32 v4, v4, v17, v18
  v_max3_u32 v4, v4, v19, v20
  v_max3_u32 v4, v4, v21, v22
  v_max3_u32 v4, v4, v23, v24
  v_max3_u32 v4, v4, v25, v26
  v_max3_u32 v4, v4, v27, v28
  v_max3_u32 v4, v4, v29, v30
  v_max3_u32 v4, v4, v31, v32
  v_max3_u32 v4, v4, v33, v34
  v_max3_u32 v4, v4, v35, v36
  v_max3_u32 v4, v4, v37, v38
  v_max_u32 v4, v4, v39
  v_cmp_eq_u32 vcc, -1, v4
  s_cbranch_vccz PB_X_OK
  s_sleep 1
  s_branch PB_X_L
PB_X_OK:
  ds_write_b128 v3, v[12:15] offset:0
  ds_write_b128 v3, v[16:19] offset:1024
  ds_write_b128 v3, v[20:23] offset:2048
  ds_write_b128 v3, v[24:27] offset:3072
  ds_write_b128 v3, v[28:31] offset:4096
  ds_write_b128 v3, v[32:35] offset:5120
  ds_write_b128 v3, v[36:39] offset:6144
  s_waitcnt lgkmcnt(0)
PB_XOK:
  s_barrier
  ds_read_b128 v[12:15], v2 offset:0
  ds_read_b128 v[16:19], v2 offset:14336
  ds_read_b128 v[20:23], v2 offset:1024
  ds_read_b128 v[24:27], v2 offset:15360
  s_waitcnt lgkmcnt(3)
  v_mfma_f32_16x16x32_bf16 v[40:43], v[12:15], a[0:3], 0
  v_mfma_f32_16x16x32_bf16 v[48:51], v[12:15], a[8:11], 0
  v_mfma_f32_16x16x32_bf16 v[56:59], v[12:15], a[16:19], 0
  v_mfma_f32_16x16x32_bf16 v[64:67], v[12:15], a[24:27], 0
  ds_read_b128 v[12:15], v2 offset:2048
  s_waitcnt lgkmcnt(1)
  v_mfma_f32_16x16x32_bf16 v[44:47], v[16:19], a[0:3], 0
  v_mfma_f32_16x16x32_bf16 v[52:55], v[16:19], a[8:11], 0
  v_mfma_f32_16x16x32_bf16 v[60:63], v[16:19], a[16:19], 0
  v_mfma_f32_16x16x32_bf16 v[68:71], v[16:19], a[24:27], 0
  ds_read_b128 v[16:19], v2 offset:16384
  v_mfma_f32_16x16x32_bf16 v[40:43], v[20:23], a[4:7], v[40:43]
  v_mfma_f32_16x16x32_bf16 v[48:51], v[20:23], a[12:15], v[48:51]
  v_mfma_f32_16x16x32_bf16 v[56:59], v[20:23], a[20:23], v[56:59]
  v_mfma_f32_16x16x32_bf16 v[64:67], v[20:23], a[28:31], v[64:67]
  ds_read_b128 v[20:23], v2 offset:3072
  v_mfma_f32_16x16x32_bf16 v[44:47], v[24:27], a[4:7], v[44:47]
  v_mfma_f32_16x16x32_bf16 v[52:55], v[24:27], a[12:15], v[52:55]
  v_mfma_f32_16x16x32_bf16 v[60:63], v[24:27], a[20:23], v[60:63]
  v_mfma_f32_16x16x32_bf16 v[68:71], v[24:27], a[28:31], v[68:71]
  ds_read_b128 v[24:27], v2 offset:17408
  s_waitcnt lgkmcnt(2)
  v_mfma_f32_16x16x32_bf16 v[40:43], v[12:15], a[64:67], v[40:43]
  v_mfma_f32_16x16x32_bf16 v[48:51], v[12:15], a[72:75], v[48:51]
  v_mfma_f32_16x16x32_bf16 v[56:59], v[12:15], a[80:83], v[56:59]
  v_mfma_f32_16x16x32_bf16 v[64:67], v[12:15], a[88:91], v[64:67]
  ds_read_b128 v[12:15], v2 offset:4096
  v_mfma_f32_16x16x32_bf16 v[44:47], v[16:19], a[64:67], v[44:47]
  v_mfma_f32_16x16x32_bf16 v[52:55], v[16:19], a[72:75], v[52:55]
  v_mfma_f32_16x16x32_bf16 v[60:63], v[16:19], a[80:83], v[60:63]
  v_mfma_f32_16x16x32_bf16 v[68:71], v[16:19], a[88:91], v[68:71]
  ds_read_b128 v[16:19], v2 offset:18432
  s_waitcnt lgkmcnt(2)
  v_mfma_f32_16x16x32_bf16 v[40:43], v[20:23], a[68:71], v[40:43]
  v_mfma_f32_16x16x32_bf16 v[48:51], v[20:23], a[76:79], v[48:51]
  v_mfma_f32_16x16x32_bf16 v[56:59], v[20:23], a[84:87], v[56:59]
  v_mfma_f32_16x16x32_bf16 v[64:67], v[20:23], a[92:95], v[64:67]
  ds_read_b128 v[20:23], v2 offset:5120
  v_mfma_f32_16x16x32_bf16 v[44:47], v[24:27], a[68:71], v[44:47]
  v_mfma_f32_16x16x32_bf16 v[52:55], v[24:27], a[76:79], v[52:55]
  v_mfma_f32_16x16x32_bf16 v[60:63], v[24:27], a[84:87], v[60:63]
  v_mfma_f32_16x16x32_bf16 v[68:71], v[24:27], a[92:95], v[68:71]
  ds_read_b128 v[24:27], v2 offset:19456
  s_waitcnt lgkmcnt(2)
  v_mfma_f32_16x16x32_bf16 v[40:43], v[12:15], a[128:131], v[40:43]
  v_mfma_f32_16x16x32_bf16 v[48:51], v[12:15], a[136:139], v[48:51]
  v_mfma_f32_16x16x32_bf16 v[56:59], v[12:15], a[144:147], v[56:59]
  v_mfma_f32_16x16x32_bf16 v[64:67], v[12:15], a[152:155], v[64:67]
  ds_read_b128 v[12:15], v2 offset:6144
  v_mfma_f32_16x16x32_bf16 v[44:47], v[16:19], a[128:131], v[44:47]
  v_mfma_f32_16x16x32_bf16 v[52:55], v[16:19], a[136:139], v[52:55]
  v_mfma_f32_16x16x32_bf16 v[60:63], v[16:19], a[144:147], v[60:63]
  v_mfma_f32_16x16x32_bf16 v[68:71], v[16:19], a[152:155], v[68:71]
  ds_read_b128 v[16:19], v2 offset:20480
  s_waitcnt lgkmcnt(2)
  v_mfma_f32_16x16x32_bf16 v[40:43], v[20:23], a[132:135], v[40:43]
  v_mfma_f32_16x16x32_bf16 v[48:51], v[20:23], a[140:143], v[48:51]
  v_mfma_f32_16x16x32_bf16 v[56:59], v[20:23], a[148:151], v[56:59]
  v_mfma_f32_16x16x32_bf16 v[64:67], v[20:23], a[156:159], v[64:67]
  ds_read_b128 v[20:23], v2 offset:7168
  v_mfma_f32_16x16x32_bf16 v[44:47], v[24:27], a[132:135], v[44:47]
  v_mfma_f32_16x16x32_bf16 v[52:55], v[24:27], a[140:143], v[52:55]
  v_mfma_f32_16x16x32_bf16 v[60:63], v[24:27], a[148:151], v[60:63]
  v_mfma_f32_16x16x32_bf16 v[68:71], v[24:27], a[156:159], v[68:71]
  ds_read_b128 v[24:27], v2 offset:21504
  s_waitcnt lgkmcnt(2)
  v_mfma_f32_16x16x32_bf16 v[40:43], v[12:15], a[192:195], v[40:43]
  v_mfma_f32_16x16x32_bf16 v[48:51], v[12:15], a[200:203], v[48:51]
  v_mfma_f32_16x16x32_bf16 v[56:59], v[12:15], a[208:211], v[56:59]
  v_mfma_f32_16x16x32_bf16 v[64:67], v[12:15], a[216:219], v[64:67]
  ds_read_b128 v[12:15], v2 offset:8192
  v_mfma_f32_16x16x32_bf16 v[44:47], v[16:19], a[192:195], v[44:47]
  v_mfma_f32_16x16x32_bf16 v[52:55], v[16:19], a[200:203], v[52:55]
  v_mfma_f32_16x16x32_bf16 v[60:63], v[16:19], a[208:211], v[60:63]
  v_mfma_f32_16x16x32_bf16 v[68:71], v[16:19], a[216:219], v[68:71]
  ds_read_b128 v[16:19], v2 offset:22528
  s_waitcnt lgkmcnt(2)
  v_mfma_f32_16x16x32_bf16 v[40:43], v[20:23], a[196:199], v[40:43]
  v_mfma_f32_16x16x32_bf16 v[48:51], v[20:23], a[204:207], v[48:51]
  v_mfma_f32_16x16x32_bf16 v[56:59], v[20:23], a[212:215], v[56:59]
  v_mfma_f32_16x16x32_bf16 v[64:67], v[20:23], a[220:223], v[64:67]
  ds_read_b128 v[20:23], v2 offset:9216
  v_mfma_f32_16x16x32_bf16 v[44:47], v[24:27], a[196:199], v[44:47]
  v_mfma_f32_16x16x32_bf16 v[52:55], v[24:27], a[204:207], v[52:55]
  v_mfma_f32_16x16x32_bf16 v[60:63], v[24:27], a[212:215], v[60:63]
  v_mfma_f32_16x16x32_bf16 v[68:71], v[24:27], a[220:223], v[68:71]
  ds_read_b128 v[24:27], v2 offset:23552
  s_waitcnt lgkmcnt(2)
  v_mfma_f32_16x16x32_bf16 v[40:43], v[12:15], v[120:123], v[40:43]
  v_mfma_f32_16x16x32_bf16 v[48:51], v[12:15], v[128:131], v[48:51]
  v_mfma_f32_16x16x32_bf16 v[56:59], v[12:15], v[136:139], v[56:59]
  v_mfma_f32_16x16x32_bf16 v[64:67], v[12:15], v[144:147], v[64:67]
  ds_read_b128 v[12:15], v2 offset:10240
  v_mfma_f32_16x16x32_bf16 v[44:47], v[16:19], v[120:123], v[44:47]
  v_mfma_f32_16x16x32_bf16 v[52:55], v[16:19], v[128:131], v[52:55]
  v_mfma_f32_16x16x32_bf16 v[60:63], v[16:19], v[136:139], v[60:63]
  v_mfma_f32_16x16x32_bf16 v[68:71], v[16:19], v[144:147], v[68:71]
  ds_read_b128 v[16:19], v2 offset:24576
  s_waitcnt lgkmcnt(2)
  v_mfma_f32_16x16x32_bf16 v[40:43], v[20:23], v[124:127], v[40:43]
  v_mfma_f32_16x16x32_bf16 v[48:51], v[20:23], v[132:135], v[48:51]
  v_mfma_f32_16x16x32_bf16 v[56:59], v[20:23], v[140:143], v[56:59]
  v_mfma_f32_16x16x32_bf16 v[64:67], v[20:23], v[148:151], v[64:67]
  ds_read_b128 v[20:23], v2 offset:11264
  v_mfma_f32_16x16x32_bf16 v[44:47], v[24:27], v[124:127], v[44:47]
  v_mfma_f32_16x16x32_bf16 v[52:55], v[24:27], v[132:135], v[52:55]
  v_mfma_f32_16x16x32_bf16 v[60:63], v[24:27], v[140:143], v[60:63]
  v_mfma_f32_16x16x32_bf16 v[68:71], v[24:27], v[148:151], v[68:71]
  ds_read_b128 v[24:27], v2 offset:25600
  s_waitcnt lgkmcnt(2)
  v_mfma_f32_16x16x32_bf16 v[40:43], v[12:15], v[184:187], v[40:43]
  v_mfma_f32_16x16x32_bf16 v[48:51], v[12:15], v[192:195], v[48:51]
  v_mfma_f32_16x16x32_bf16 v[56:59], v[12:15], v[200:203], v[56:59]
  v_mfma_f32_16x16x32_bf16 v[64:67], v[12:15], v[208:211], v[64:67]
  ds_read_b128 v[12:15], v2 offset:12288
  v_mfma_f32_16x16x32_bf16 v[44:47], v[16:19], v[184:187], v[44:47]
  v_mfma_f32_16x16x32_bf16 v[52:55], v[16:19], v[192:195], v[52:55]
  v_mfma_f32_16x16x32_bf16 v[60:63], v[16:19], v[200:203], v[60:63]
  v_mfma_f32_16x16x32_bf16 v[68:71], v[16:19], v[208:211], v[68:71]
  ds_read_b128 v[16:19], v2 offset:26624
  ds_read_b128 v[28:31], v6 offset:0
  s_waitcnt lgkmcnt(3)
  v_mfma_f32_16x16x32_bf16 v[48:51], v[20:23], v[196:199], v[48:51]
  ds_read_b128 v[32:35], v6 offset:2048
  ds_read_b128 v[36:39], v6 offset:4096
  v_mfma_f32_16x16x32_bf16 v[52:55], v[24:27], v[196:199], v[52:55]
  v_mfma_f32_16x16x32_bf16 v[40:43], v[20:23], v[188:191], v[40:43]
  v_mfma_f32_16x16x32_bf16 v[56:59], v[20:23], v[204:207], v[56:59]
  v_mfma_f32_16x16x32_bf16 v[60:63], v[24:27], v[204:207], v[60:63]
  v_mfma_f32_16x16x32_bf16 v[64:67], v[20:23], v[212:215], v[64:67]
  ds_read_b128 v[20:23], v2 offset:13312
  v_mfma_f32_16x16x32_bf16 v[44:47], v[24:27], v[188:191], v[44:47]
  v_mfma_f32_16x16x32_bf16 v[68:71], v[24:27], v[212:215], v[68:71]
  ds_read_b128 v[24:27], v2 offset:27648
  s_waitcnt lgkmcnt(4)
  v_mfma_f32_16x16x32_bf16 v[48:51], v[12:15], v[28:31], v[48:51]
  v_mfma_f32_16x16x32_bf16 v[52:55], v[16:19], v[28:31], v[52:55]
  ds_read_b128 v[28:31], v6 offset:1024
  s_waitcnt lgkmcnt(3)
  v_mfma_f32_16x16x32_bf16 v[56:59], v[12:15], v[32:35], v[56:59]
  v_mfma_f32_16x16x32_bf16 v[60:63], v[16:19], v[32:35], v[60:63]
  ds_read_b128 v[32:35], v6 offset:3072
  v_mfma_f32_16x16x32_bf16 v[64:67], v[12:15], v[36:39], v[64:67]
  v_mfma_f32_16x16x32_bf16 v[68:71], v[16:19], v[36:39], v[68:71]
  ds_read_b128 v[36:39], v6 offset:5120
  v_mfma_f32_16x16x32_bf16 v[40:43], v[12:15], v[248:251], v[40:43]
  v_mfma_f32_16x16x32_bf16 v[44:47], v[16:19], v[248:251], v[44:47]
  s_waitcnt lgkmcnt(3)
  v_mfma_f32_16x16x32_bf16 v[40:43], v[20:23], v[252:255], v[40:43]
  v_mfma_f32_16x16x32_bf16 v[44:47], v[24:27], v[252:255], v[44:47]
  s_waitcnt lgkmcnt(2)
  v_mfma_f32_16x16x32_bf16 v[48:51], v[20:23], v[28:31], v[48:51]
  v_cvt_pk_bf16_f32 v72, v40, v41
  v_cvt_pk_bf16_f32 v73, v42, v43
  v_mfma_f32_16x16x32_bf16 v[52:55], v[24:27], v[28:31], v[52:55]
  v_cvt_pk_bf16_f32 v74, v44, v45
  v_cvt_pk_bf16_f32 v75, v46, v47
  s_waitcnt lgkmcnt(1)
  v_mfma_f32_16x16x32_bf16 v[56:59], v[20:23], v[32:35], v[56:59]
  ds_write_b128 v7, v[72:75] offset:0
  v_cvt_pk_bf16_f32 v80, v48, v49
  v_mfma_f32_16x16x32_bf16 v[60:63], v[24:27], v[32:35], v[60:63]
  v_cvt_pk_bf16_f32 v81, v50, v51
  v_cvt_pk_bf16_f32 v82, v52, v53
  s_waitcnt lgkmcnt(1)
  v_mfma_f32_16x16x32_bf16 v[64:67], v[20:23], v[36:39], v[64:67]
  v_cvt_pk_bf16_f32 v83, v54, v55
  ds_write_b128 v7, v[80:83] offset:2048
  v_mfma_f32_16x16x32_bf16 v[68:71], v[24:27], v[36:39], v[68:71]
  v_cvt_pk_bf16_f32 v76, v56, v57
  v_cvt_pk_bf16_f32 v77, v58, v59
  v_cvt_pk_bf16_f32 v78, v60, v61
  v_cvt_pk_bf16_f32 v79, v62, v63
  ds_write_b128 v7, v[76:79] offset:1024
  v_cvt_pk_bf16_f32 v84, v64, v65
  v_cvt_pk_bf16_f32 v85, v66, v67
  s_nop 0
  v_cvt_pk_bf16_f32 v86, v68, v69
  v_cvt_pk_bf16_f32 v87, v70, v71
  ds_write_b128 v7, v[84:87] offset:3072
  ds_read_b128 v[12:15], v2 offset:0
  ds_read_b128 v[16:19], v2 offset:14336
  ds_read_b128 v[20:23], v2 offset:1024
  ds_read_b128 v[24:27], v2 offset:15360
  buffer_store_dwordx4 v[72:75], v2, s[12:15], s23 offen offset:0 sc1
  buffer_store_dwordx4 v[80:83], v2, s[12:15], s23 offen offset:2048 sc1
  s_waitcnt lgkmcnt(3)
  v_mfma_f32_16x16x32_bf16 v[40:43], v[12:15], a[32:35], 0
  v_mfma_f32_16x16x32_bf16 v[48:51], v[12:15], a[40:43], 0
  v_mfma_f32_16x16x32_bf16 v[56:59], v[12:15], a[48:51], 0
  v_mfma_f32_16x16x32_bf16 v[64:67], v[12:15], a[56:59], 0
  ds_read_b128 v[12:15], v2 offset:2048
  buffer_store_dwordx4 v[76:79], v2, s[12:15], s23 offen offset:1024 sc1
  s_waitcnt lgkmcnt(1)
  v_mfma_f32_16x16x32_bf16 v[44:47], v[16:19], a[32:35], 0
  v_mfma_f32_16x16x32_bf16 v[52:55], v[16:19], a[40:43], 0
  v_mfma_f32_16x16x32_bf16 v[60:63], v[16:19], a[48:51], 0
  v_mfma_f32_16x16x32_bf16 v[68:71], v[16:19], a[56:59], 0
  ds_read_b128 v[16:19], v2 offset:16384
  buffer_store_dwordx4 v[84:87], v2, s[12:15], s23 offen offset:3072 sc1
  v_mfma_f32_16x16x32_bf16 v[40:43], v[20:23], a[36:39], v[40:43]
  v_mfma_f32_16x16x32_bf16 v[48:51], v[20:23], a[44:47], v[48:51]
  v_mfma_f32_16x16x32_bf16 v[56:59], v[20:23], a[52:55], v[56:59]
  v_mfma_f32_16x16x32_bf16 v[64:67], v[20:23], a[60:63], v[64:67]
  ds_read_b128 v[20:23], v2 offset:3072
  v_mfma_f32_16x16x32_bf16 v[44:47], v[24:27], a[36:39], v[44:47]
  v_mfma_f32_16x16x32_bf16 v[52:55], v[24:27], a[44:47], v[52:55]
  v_mfma_f32_16x16x32_bf16 v[60:63], v[24:27], a[52:55], v[60:63]
  v_mfma_f32_16x16x32_bf16 v[68:71], v[24:27], a[60:63], v[68:71]
  ds_read_b128 v[24:27], v2 offset:17408
  s_waitcnt lgkmcnt(2)
  v_mfma_f32_16x16x32_bf16 v[40:43], v[12:15], a[96:99], v[40:43]
  v_mfma_f32_16x16x32_bf16 v[48:51], v[12:15], a[104:107], v[48:51]
  v_mfma_f32_16x16x32_bf16 v[56:59], v[12:15], a[112:115], v[56:59]
  v_mfma_f32_16x16x32_bf16 v[64:67], v[12:15], a[120:123], v[64:67]
  ds_read_b128 v[12:15], v2 offset:4096
  v_mfma_f32_16x16x32_bf16 v[44:47], v[16:19], a[96:99], v[44:47]
  v_mfma_f32_16x16x32_bf16 v[52:55], v[16:19], a[104:107], v[52:55]
  v_mfma_f32_16x16x32_bf16 v[60:63], v[16:19], a[112:115], v[60:63]
  v_mfma_f32_16x16x32_bf16 v[68:71], v[16:19], a[120:123], v[68:71]
  ds_read_b128 v[16:19], v2 offset:18432
  s_waitcnt lgkmcnt(2)
  v_mfma_f32_16x16x32_bf16 v[40:43], v[20:23], a[100:103], v[40:43]
  v_mfma_f32_16x16x32_bf16 v[48:51], v[20:23], a[108:111], v[48:51]
  v_mfma_f32_16x16x32_bf16 v[56:59], v[20:23], a[116:119], v[56:59]
  v_mfma_f32_16x16x32_bf16 v[64:67], v[20:23], a[124:127], v[64:67]
  ds_read_b128 v[20:23], v2 offset:5120
  v_mfma_f32_16x16x32_bf16 v[44:47], v[24:27], a[100:103], v[44:47]
  v_mfma_f32_16x16x32_bf16 v[52:55], v[24:27], a[108:111], v[52:55]
  v_mfma_f32_16x16x32_bf16 v[60:63], v[24:27], a[116:119], v[60:63]
  v_mfma_f32_16x16x32_bf16 v[68:71], v[24:27], a[124:127], v[68:71]
  ds_read_b128 v[24:27], v2 offset:19456
  s_waitcnt lgkmcnt(2)
  v_mfma_f32_16x16x32_bf16 v[40:43], v[12:15], a[160:163], v[40:43]
  v_mfma_f32_16x16x32_bf16 v[48:51], v[12:15], a[168:171], v[48:51]
  v_mfma_f32_16x16x32_bf16 v[56:59], v[12:15], a[176:179], v[56:59]
  v_mfma_f32_16x16x32_bf16 v[64:67], v[12:15], a[184:187], v[64:67]
  ds_read_b128 v[12:15], v2 offset:6144
  v_mfma_f32_16x16x32_bf16 v[44:47], v[16:19], a[160:163], v[44:47]
  v_mfma_f32_16x16x32_bf16 v[52:55], v[16:19], a[168:171], v[52:55]
  v_mfma_f32_16x16x32_bf16 v[60:63], v[16:19], a[176:179], v[60:63]
  v_mfma_f32_16x16x32_bf16 v[68:71], v[16:19], a[184:187], v[68:71]
  ds_read_b128 v[16:19], v2 offset:20480
  s_waitcnt lgkmcnt(2)
  v_mfma_f32_16x16x32_bf16 v[40:43], v[20:23], a[164:167], v[40:43]
  v_mfma_f32_16x16x32_bf16 v[48:51], v[20:23], a[172:175], v[48:51]
  v_mfma_f32_16x16x32_bf16 v[56:59], v[20:23], a[180:183], v[56:59]
  buffer_load_dwordx4 v[88:91], v2, s[12:15], s27 offen offset:0 sc1
  v_mfma_f32_16x16x32_bf16 v[64:67], v[20:23], a[188:191], v[64:67]
  ds_read_b128 v[20:23], v2 offset:7168
  v_mfma_f32_16x16x32_bf16 v[44:47], v[24:27], a[164:167], v[44:47]
  v_mfma_f32_16x16x32_bf16 v[52:55], v[24:27], a[172:175], v[52:55]
  v_mfma_f32_16x16x32_bf16 v[60:63], v[24:27], a[180:183], v[60:63]
  buffer_load_dwordx4 v[92:95], v2, s[12:15], s27 offen offset:1024 sc1
  v_mfma_f32_16x16x32_bf16 v[68:71], v[24:27], a[188:191], v[68:71]
  ds_read_b128 v[24:27], v2 offset:21504
  s_waitcnt lgkmcnt(2)
  v_mfma_f32_16x16x32_bf16 v[40:43], v[12:15], a[224:227], v[40:43]
  v_mfma_f32_16x16x32_bf16 v[48:51], v[12:15], a[232:235], v[48:51]
  v_mfma_f32_16x16x32_bf16 v[56:59], v[12:15], a[240:243], v[56:59]
  buffer_load_dwordx4 v[96:99], v2, s[12:15], s27 offen offset:2048 sc1
  v_mfma_f32_16x16x32_bf16 v[64:67], v[12:15], a[248:251], v[64:67]
  ds_read_b128 v[12:15], v2 offset:8192
  v_mfma_f32_16x16x32_bf16 v[44:47], v[16:19], a[224:227], v[44:47]
  v_mfma_f32_16x16x32_bf16 v[52:55], v[16:19], a[232:235], v[52:55]
  v_mfma_f32_16x16x32_bf16 v[60:63], v[16:19], a[240:243], v[60:63]
  buffer_load_dwordx4 v[100:103], v2, s[12:15], s27 offen offset:3072 sc1
  v_mfma_f32_16x16x32_bf16 v[68:71], v[16:19], a[248:251], v[68:71]
  ds_read_b128 v[16:19], v2 offset:22528
  s_waitcnt lgkmcnt(2)
  v_mfma_f32_16x16x32_bf16 v[40:43], v[20:23], a[228:231], v[40:43]
  v_mfma_f32_16x16x32_bf16 v[48:51], v[20:23], a[236:239], v[48:51]
  v_mfma_f32_16x16x32_bf16 v[56:59], v[20:23], a[244:247], v[56:59]
  buffer_load_dwordx4 v[104:107], v2, s[12:15], s51 offen offset:0 sc1
  v_mfma_f32_16x16x32_bf16 v[64:67], v[20:23], a[252:255], v[64:67]
  ds_read_b128 v[20:23], v2 offset:9216
  v_mfma_f32_16x16x32_bf16 v[44:47], v[24:27], a[228:231], v[44:47]
  v_mfma_f32_16x16x32_bf16 v[52:55], v[24:27], a[236:239], v[52:55]
  v_mfma_f32_16x16x32_bf16 v[60:63], v[24:27], a[244:247], v[60:63]
  buffer_load_dwordx4 v[108:111], v2, s[12:15], s51 offen offset:1024 sc1
  v_mfma_f32_16x16x32_bf16 v[68:71], v[24:27], a[252:255], v[68:71]
  ds_read_b128 v[24:27], v2 offset:23552
  s_waitcnt lgkmcnt(2)
  v_mfma_f32_16x16x32_bf16 v[40:43], v[12:15], v[152:155], v[40:43]
  v_mfma_f32_16x16x32_bf16 v[48:51], v[12:15], v[160:163], v[48:51]
  v_mfma_f32_16x16x32_bf16 v[56:59], v[12:15], v[168:171], v[56:59]
  buffer_load_dwordx4 v[112:115], v2, s[12:15], s51 offen offset:2048 sc1
  v_mfma_f32_16x16x32_bf16 v[64:67], v[12:15], v[176:179], v[64:67]
  ds_read_b128 v[12:15], v2 offset:10240
  v_mfma_f32_16x16x32_bf16 v[44:47], v[16:19], v[152:155], v[44:47]
  v_mfma_f32_16x16x32_bf16 v[52:55], v[16:19], v[160:163], v[52:55]
  v_mfma_f32_16x16x32_bf16 v[60:63], v[16:19], v[168:171], v[60:63]
  v_mfma_f32_16x16x32_bf16 v[68:71], v[16:19], v[176:179], v[68:71]
  ds_read_b128 v[16:19], v2 offset:24576
  s_waitcnt lgkmcnt(2)
  v_mfma_f32_16x16x32_bf16 v[40:43], v[20:23], v[156:159], v[40:43]
  v_mfma_f32_16x16x32_bf16 v[48:51], v[20:23], v[164:167], v[48:51]
  v_mfma_f32_16x16x32_bf16 v[56:59], v[20:23], v[172:175], v[56:59]
  v_mfma_f32_16x16x32_bf16 v[64:67], v[20:23], v[180:183], v[64:67]
  ds_read_b128 v[20:23], v2 offset:11264
  v_mfma_f32_16x16x32_bf16 v[44:47], v[24:27], v[156:159], v[44:47]
  v_mfma_f32_16x16x32_bf16 v[52:55], v[24:27], v[164:167], v[52:55]
  v_mfma_f32_16x16x32_bf16 v[60:63], v[24:27], v[172:175], v[60:63]
  v_mfma_f32_16x16x32_bf16 v[68:71], v[24:27], v[180:183], v[68:71]
  ds_read_b128 v[24:27], v2 offset:25600
  s_waitcnt lgkmcnt(2)
  v_mfma_f32_16x16x32_bf16 v[40:43], v[12:15], v[216:219], v[40:43]
  v_mfma_f32_16x16x32_bf16 v[48:51], v[12:15], v[224:227], v[48:51]
  v_mfma_f32_16x16x32_bf16 v[56:59], v[12:15], v[232:235], v[56:59]
  v_mfma_f32_16x16x32_bf16 v[64:67], v[12:15], v[240:243], v[64:67]
  ds_read_b128 v[12:15], v2 offset:12288
  v_mfma_f32_16x16x32_bf16 v[44:47], v[16:19], v[216:219], v[44:47]
  v_mfma_f32_16x16x32_bf16 v[52:55], v[16:19], v[224:227], v[52:55]
  v_mfma_f32_16x16x32_bf16 v[60:63], v[16:19], v[232:235], v[60:63]
  v_mfma_f32_16x16x32_bf16 v[68:71], v[16:19], v[240:243], v[68:71]
  ds_read_b128 v[16:19], v2 offset:26624
  ds_read_b128 v[28:31], v6 offset:6144
  s_waitcnt lgkmcnt(3)
  v_mfma_f32_16x16x32_bf16 v[40:43], v[20:23], v[220:223], v[40:43]
  ds_read_b128 v[32:35], v6 offset:8192
  ds_read_b128 v[36:39], v6 offset:10240
  v_mfma_f32_16x16x32_bf16 v[44:47], v[24:27], v[220:223], v[44:47]
  v_mfma_f32_16x16x32_bf16 v[48:51], v[20:23], v[228:231], v[48:51]
  v_mfma_f32_16x16x32_bf16 v[52:55], v[24:27], v[228:231], v[52:55]
  v_mfma_f32_16x16x32_bf16 v[56:59], v[20:23], v[236:239], v[56:59]
  v_mfma_f32_16x16x32_bf16 v[64:67], v[20:23], v[244:247], v[64:67]
  s_waitcnt lgkmcnt(2)
  v_mfma_f32_16x16x32_bf16 v[40:43], v[12:15], v[28:31], v[40:43]
  v_mfma_f32_16x16x32_bf16 v[44:47], v[16:19], v[28:31], v[44:47]
  ds_read_b128 v[28:31], v6 offset:12288
  ds_read_b128 v[20:23], v2 offset:13312
  v_mfma_f32_16x16x32_bf16 v[60:63], v[24:27], v[236:239], v[60:63]
  v_mfma_f32_16x16x32_bf16 v[68:71], v[24:27], v[244:247], v[68:71]
  ds_read_b128 v[24:27], v2 offset:27648
  s_waitcnt lgkmcnt(3)
  v_mfma_f32_16x16x32_bf16 v[48:51], v[12:15], v[32:35], v[48:51]
  v_mfma_f32_16x16x32_bf16 v[52:55], v[16:19], v[32:35], v[52:55]
  ds_read_b128 v[32:35], v6 offset:7168
  v_mfma_f32_16x16x32_bf16 v[56:59], v[12:15], v[36:39], v[56:59]
  v_mfma_f32_16x16x32_bf16 v[60:63], v[16:19], v[36:39], v[60:63]
  ds_read_b128 v[36:39], v6 offset:9216
  s_waitcnt lgkmcnt(4)
  v_mfma_f32_16x16x32_bf16 v[64:67], v[12:15], v[28:31], v[64:67]
  v_mfma_f32_16x16x32_bf16 v[68:71], v[16:19], v[28:31], v[68:71]
  ds_read_b128 v[28:31], v6 offset:11264
  s_waitcnt lgkmcnt(2)
  v_mfma_f32_16x16x32_bf16 v[40:43], v[20:23], v[32:35], v[40:43]
  v_mfma_f32_16x16x32_bf16 v[44:47], v[24:27], v[32:35], v[44:47]
  ds_read_b128 v[32:35], v6 offset:13312
  s_waitcnt lgkmcnt(2)
  v_mfma_f32_16x16x32_bf16 v[48:51], v[20:23], v[36:39], v[48:51]
  v_cvt_pk_bf16_f32 v72, v40, v41
  v_cvt_pk_bf16_f32 v73, v42, v43
  v_mfma_f32_16x16x32_bf16 v[52:55], v[24:27], v[36:39], v[52:55]
  v_cvt_pk_bf16_f32 v74, v44, v45
  v_cvt_pk_bf16_f32 v75, v46, v47
  s_waitcnt lgkmcnt(1)
  v_mfma_f32_16x16x32_bf16 v[56:59], v[20:23], v[28:31], v[56:59]
  buffer_store_dwordx4 v[72:75], v2, s[12:15], s32 offen offset:0 sc1
  v_cvt_pk_bf16_f32 v80, v48, v49
  v_mfma_f32_16x16x32_bf16 v[60:63], v[24:27], v[28:31], v[60:63]
  v_cvt_pk_bf16_f32 v81, v50, v51
  v_cvt_pk_bf16_f32 v82, v52, v53
  v_cvt_pk_bf16_f32 v83, v54, v55
  s_nop 0
  v_cvt_pk_bf16_f32 v76, v56, v57
  v_cvt_pk_bf16_f32 v77, v58, v59
  ds_write_b128 v7, v[72:75] offset:4096
  ds_write_b128 v7, v[80:83] offset:6144
  v_cvt_pk_bf16_f32 v78, v60, v61
  v_cvt_pk_bf16_f32 v79, v62, v63
  s_waitcnt lgkmcnt(2)
  v_mfma_f32_16x16x32_bf16 v[64:67], v[20:23], v[32:35], v[64:67]
  ds_write_b128 v7, v[76:79] offset:5120
  buffer_store_dwordx4 v[80:83], v2, s[12:15], s32 offen offset:2048 sc1
  v_mfma_f32_16x16x32_bf16 v[68:71], v[24:27], v[32:35], v[68:71]
  s_nop 3
  v_cvt_pk_bf16_f32 v84, v64, v65
  v_cvt_pk_bf16_f32 v85, v66, v67
  s_nop 1
  v_cvt_pk_bf16_f32 v86, v68, v69
  v_cvt_pk_bf16_f32 v87, v70, v71
  ds_write_b128 v7, v[84:87] offset:7168
  buffer_store_dwordx4 v[76:79], v2, s[12:15], s32 offen offset:1024 sc1
  buffer_store_dwordx4 v[84:87], v2, s[12:15], s32 offen offset:3072 sc1
  s_mov_b32 s31, 1
  v_add_u32 v7, s41, v7
  s_sub_u32 s41, 0, s41
  s_add_u32 s25, s25, 3
  s_add_u32 s21, s21, 86016
  s_add_u32 s23, s23, 1376256
  s_mov_b32 s52, s24
  s_add_u32 s24, s24, 5376
  s_cmp_lt_u32 s25, 64
  s_cselect_b32 s32, 0, 86016
  s_sub_u32 s21, s21, s32
  s_add_u32 s22, s21, 4096
  s_waitcnt lgkmcnt(0)
  s_barrier
  s_sub_u32 s32, s25, s18
  s_cmp_gt_u32 s32, 3
  s_cbranch_scc1 PB_POST
  s_mov_b32 m0, s36
  s_nop 0
  buffer_load_dwordx4 v2, s[12:15], s21 offen offset:0 sc1 lds
  buffer_load_dwordx4 v2, s[12:15], s21 offen offset:1024 sc1 lds
  buffer_load_dwordx4 v2, s[12:15], s21 offen offset:2048 sc1 lds
  buffer_load_dwordx4 v2, s[12:15], s21 offen offset:3072 sc1 lds
  s_add_u32 m0, s36, 4096
  s_nop 0
  buffer_load_dwordx4 v2, s[12:15], s22 offen offset:0 sc1 lds
  buffer_load_dwordx4 v2, s[12:15], s22 offen offset:1024 sc1 lds
  buffer_load_dwordx4 v2, s[12:15], s22 offen offset:2048 sc1 lds
  s_waitcnt vmcnt(7)
  buffer_store_dword v10, v10, s[12:15], s52 offen sc1
  s_waitcnt vmcnt(1)
  ds_read_b128 v[12:15], v3 offset:0
  ds_read_b128 v[16:19], v3 offset:1024
  ds_read_b128 v[20:23], v3 offset:2048
  ds_read_b128 v[24:27], v3 offset:3072
  ds_read_b128 v[28:31], v3 offset:4096
  ds_read_b128 v[32:35], v3 offset:5120
  ds_read_b128 v[36:39], v3 offset:6144
  s_waitcnt lgkmcnt(0)
  v_max3_u32 v4, v12, v13, v14
  v_max3_u32 v4, v4, v15, v16
  v_max3_u32 v4, v4, v17, v18
  v_max3_u32 v4, v4, v19, v20
  v_max3_u32 v4, v4, v21, v22
  v_max3_u32 v4, v4, v23, v24
  v_max3_u32 v4, v4, v25, v26
  v_max3_u32 v4, v4, v27, v28
  v_max3_u32 v4, v4, v29, v30
  v_max3_u32 v4, v4, v31, v32
  v_max3_u32 v4, v4, v33, v34
  v_max3_u32 v4, v4, v35, v36
  v_max3_u32 v4, v4, v37, v38
  v_max_u32 v4, v4, v39
  v_cmp_eq_u32 vcc, -1, v4
  s_cmp_eq_u64 vcc, 0
  s_cselect_b32 s50, 1, 0
  s_branch PB_PRE
PB_POST:
  s_waitcnt vmcnt(4)
  v_max3_u32 v4, v88, v89, v90
  v_max3_u32 v4, v4, v91, v92
  v_max3_u32 v4, v4, v93, v94
  v_max3_u32 v4, v4, v95, v96
  v_max3_u32 v4, v4, v97, v98
  v_max3_u32 v4, v4, v99, v100
  v_max3_u32 v4, v4, v101, v102
  v_max3_u32 v4, v4, v103, v104
  v_max3_u32 v4, v4, v105, v106
  v_max3_u32 v4, v4, v107, v108
  v_max3_u32 v4, v4, v109, v110
  v_max3_u32 v4, v4, v111, v112
  v_max3_u32 v4, v4, v113, v114
  v_max_u32 v4, v4, v115
  v_cmp_eq_u32 vcc, -1, v4
  s_cbranch_vccnz PB_MSLOW
PB_MOK:
  s_add_u32 s42, s30, 86016
  s_cmp_lt_u32 s25, 67
  s_cselect_b32 s42, s42, 2147418112
  s_cmp_lt_u32 s3, 2
  s_cselect_b32 s42, s42, 2147418112
  s_add_u32 s53, s28, 2560
  s_add_u32 s54, s28, 5120
  s_add_u32 s55, s28, 7680
  v_mov_b32 v12, -1
  v_mov_b32 v13, -1
  v_mov_b32 v14, -1
  v_mov_b32 v15, -1
  buffer_store_dwordx4 v[12:15], v2, s[12:15], s42 offen sc1
  v_mov_b32 v40, 0
  v_mov_b32 v41, 0
  v_mov_b32 v42, 0
  v_mov_b32 v43, 0
  v_mov_b32 v44, 0
  v_mov_b32 v45, 0
  v_mov_b32 v46, 0
  v_mov_b32 v47, 0
  v_mov_b32 v48, 0
  v_mov_b32 v49, 0
  v_mov_b32 v50, 0
  v_mov_b32 v51, 0
  v_mov_b32 v52, 0
  v_mov_b32 v53, 0
  v_mov_b32 v54, 0
  v_mov_b32 v55, 0
  v_mov_b32 v56, 0
  v_mov_b32 v57, 0
  v_mov_b32 v58, 0
  v_mov_b32 v59, 0
  v_mov_b32 v60, 0
  v_mov_b32 v61, 0
  v_mov_b32 v62, 0
  v_mov_b32 v63, 0
  v_mov_b32 v64, 0
  v_mov_b32 v65, 0
  v_mov_b32 v66, 0
  v_mov_b32 v67, 0
  v_mov_b32 v68, 0
  v_mov_b32 v69, 0
  v_mov_b32 v70, 0
  v_mov_b32 v71, 0
  v_smfmac_f32_16x16x64_bf16 v[48:51], v[88:91], a[16:23], v5
  ds_read_b128 v[80:83], v6 offset:0
  v_smfmac_f32_16x16x64_bf16 v[52:55], v[88:91], a[24:31], v5
  ds_read_b128 v[84:87], v6 offset:1024
  v_smfmac_f32_16x16x64_bf16 v[52:55], v[92:95], a[88:95], v5
  s_mov_b32 m0, s36
  v_smfmac_f32_16x16x64_bf16 v[40:43], v[88:91], a[0:7], v5
  buffer_load_dwordx4 v2, s[12:15], s21 offen offset:0 sc1 lds
  v_smfmac_f32_16x16x64_bf16 v[56:59], v[88:91], a[32:39], v5
  v_smfmac_f32_16x16x64_bf16 v[60:63], v[88:91], a[40:47], v5
  v_smfmac_f32_16x16x64_bf16 v[64:67], v[88:91], a[48:55], v5
  v_smfmac_f32_16x16x64_bf16 v[68:71], v[88:91], a[56:63], v5
  buffer_load_dwordx4 v2, s[12:15], s21 offen offset:1024 sc1 lds
  s_waitcnt lgkmcnt(0)
  v_smfmac_f32_16x16x64_bf16 v[44:47], v[112:115], v[80:87], v5
  ds_read_b128 v[80:83], v6 offset:2048
  v_smfmac_f32_16x16x64_bf16 v[44:47], v[88:91], a[8:15], v5
  ds_read_b128 v[84:87], v6 offset:3072
  v_smfmac_f32_16x16x64_bf16 v[40:43], v[92:95], a[64:71], v5
  v_smfmac_f32_16x16x64_bf16 v[44:47], v[92:95], a[72:79], v5
  buffer_load_dwordx4 v2, s[12:15], s21 offen offset:2048 sc1 lds
  v_smfmac_f32_16x16x64_bf16 v[56:59], v[92:95], a[96:103], v5
  v_smfmac_f32_16x16x64_bf16 v[60:63], v[92:95], a[104:111], v5
  v_smfmac_f32_16x16x64_bf16 v[64:67], v[92:95], a[112:119], v5
  v_smfmac_f32_16x16x64_bf16 v[68:71], v[92:95], a[120:127], v5
  buffer_load_dwordx4 v2, s[12:15], s21 offen offset:3072 sc1 lds
  s_waitcnt lgkmcnt(0)
  v_smfmac_f32_16x16x64_bf16 v[48:51], v[112:115], v[80:87], v5
  ds_read_b128 v[80:83], v6 offset:4096
  v_smfmac_f32_16x16x64_bf16 v[48:51], v[92:95], a[80:87], v5
  ds_read_b128 v[84:87], v6 offset:5120
  v_smfmac_f32_16x16x64_bf16 v[40:43], v[96:99], a[128:135], v5
  s_add_u32 m0, s36, 4096
  v_smfmac_f32_16x16x64_bf16 v[44:47], v[96:99], a[136:143], v5
  buffer_load_dwordx4 v2, s[12:15], s22 offen offset:0 sc1 lds
  v_smfmac_f32_16x16x64_bf16 v[48:51], v[96:99], a[144:151], v5
  v_smfmac_f32_16x16x64_bf16 v[56:59], v[96:99], a[160:167], v5
  v_smfmac_f32_16x16x64_bf16 v[60:63], v[96:99], a[168:175], v5
  v_smfmac_f32_16x16x64_bf16 v[64:67], v[96:99], a[176:183], v5
  buffer_load_dwordx4 v2, s[12:15], s22 offen offset:1024 sc1 lds
  s_waitcnt lgkmcnt(0)
  v_smfmac_f32_16x16x64_bf16 v[52:55], v[112:115], v[80:87], v5
  ds_read_b128 v[80:83], v6 offset:6144
  v_smfmac_f32_16x16x64_bf16 v[52:55], v[96:99], a[152:159], v5
  ds_read_b128 v[84:87], v6 offset:7168
  v_smfmac_f32_16x16x64_bf16 v[68:71], v[96:99], a[184:191], v5
  v_smfmac_f32_16x16x64_bf16 v[40:43], v[100:103], a[192:199], v5
  buffer_load_dwordx4 v2, s[12:15], s22 offen offset:2048 sc1 lds
  v_smfmac_f32_16x16x64_bf16 v[44:47], v[100:103], a[200:207], v5
  v_smfmac_f32_16x16x64_bf16 v[48:51], v[100:103], a[208:215], v5
  v_smfmac_f32_16x16x64_bf16 v[52:55], v[100:103], a[216:223], v5
  s_waitcnt lgkmcnt(0)
  v_smfmac_f32_16x16x64_bf16 v[56:59], v[112:115], v[80:87], v5
  s_waitcnt vmcnt(8)
  buffer_store_dword v10, v10, s[12:15], s52 offen sc1
  v_smfmac_f32_16x16x64_bf16 v[64:67], v[100:103], a[240:247], v5
  buffer_load_dwordx4 v[12:15], v2, s[12:15], s28 offen sc1
  v_smfmac_f32_16x16x64_bf16 v[40:43], v[104:107], v[120:127], v5
  ds_read_b128 v[80:83], v6 offset:8192
  v_smfmac_f32_16x16x64_bf16 v[68:71], v[100:103], a[248:255], v5
  ds_read_b128 v[84:87], v6 offset:9216
  v_smfmac_f32_16x16x64_bf16 v[40:43], v[108:111], v[184:191], v5
  buffer_load_dwordx4 v[28:31], v2, s[12:15], s28 offen offset:1024 sc1
  v_smfmac_f32_16x16x64_bf16 v[56:59], v[100:103], a[224:231], v5
  v_smfmac_f32_16x16x64_bf16 v[44:47], v[104:107], v[128:135], v5
  v_smfmac_f32_16x16x64_bf16 v[48:51], v[104:107], v[136:143], v5
  buffer_load_dwordx2 v[36:37], v9, s[12:15], s28 offen offset:2048 sc1
  v_smfmac_f32_16x16x64_bf16 v[52:55], v[104:107], v[144:151], v5
  v_smfmac_f32_16x16x64_bf16 v[68:71], v[104:107], v[176:183], v5
  s_waitcnt lgkmcnt(0)
  v_smfmac_f32_16x16x64_bf16 v[60:63], v[112:115], v[80:87], v5
  buffer_load_dwordx4 v[16:19], v2, s[12:15], s53 offen sc1
  v_smfmac_f32_16x16x64_bf16 v[60:63], v[100:103], a[232:239], v5
  ds_read_b128 v[80:83], v6 offset:10240
  v_smfmac_f32_16x16x64_bf16 v[40:43], v[112:115], v[248:255], v5
  ds_read_b128 v[84:87], v6 offset:11264
  v_smfmac_f32_16x16x64_bf16 v[56:59], v[104:107], v[152:159], v5
  buffer_load_dwordx4 v[32:35], v2, s[12:15], s53 offen offset:1024 sc1
  v_smfmac_f32_16x16x64_bf16 v[44:47], v[108:111], v[192:199], v5
  v_cvt_pk_bf16_f32 v88, v40, v41
  v_smfmac_f32_16x16x64_bf16 v[60:63], v[104:107], v[160:167], v5
  v_cvt_pk_bf16_f32 v89, v42, v43
  v_smfmac_f32_16x16x64_bf16 v[48:51], v[108:111], v[200:207], v5
  buffer_load_dwordx2 v[38:39], v9, s[12:15], s53 offen offset:2048 sc1
  v_smfmac_f32_16x16x64_bf16 v[52:55], v[108:111], v[208:215], v5
  v_cvt_pk_bf16_f32 v96, v44, v45
  v_smfmac_f32_16x16x64_bf16 v[56:59], v[108:111], v[216:223], v5
  v_cvt_pk_bf16_f32 v97, v46, v47
  s_waitcnt lgkmcnt(0)
  v_smfmac_f32_16x16x64_bf16 v[64:67], v[112:115], v[80:87], v5
  buffer_load_dwordx4 v[20:23], v2, s[12:15], s54 offen sc1
  v_smfmac_f32_16x16x64_bf16 v[64:67], v[104:107], v[168:175], v5
  ds_read_b128 v[80:83], v6 offset:12288
  v_smfmac_f32_16x16x64_bf16 v[60:63], v[108:111], v[224:231], v5
  ds_read_b128 v[84:87], v6 offset:13312
  v_smfmac_f32_16x16x64_bf16 v[64:67], v[108:111], v[232:239], v5
  buffer_load_dwordx4 v[72:75], v2, s[12:15], s54 offen offset:1024 sc1
  ds_read_b128 v[40:43], v7 offset:0
  v_cvt_pk_bf16_f32 v90, v48, v49
  v_cvt_pk_bf16_f32 v91, v50, v51
  ds_read_b128 v[44:47], v7 offset:1024
  v_cvt_pk_bf16_f32 v98, v52, v53
  v_cvt_pk_bf16_f32 v99, v54, v55
  ds_read_b128 v[48:51], v7 offset:2048
  v_cvt_pk_bf16_f32 v92, v56, v57
  buffer_load_dwordx2 v[116:117], v9, s[12:15], s54 offen offset:2048 sc1
  v_cvt_pk_bf16_f32 v93, v58, v59
  ds_read_b128 v[52:55], v7 offset:3072
  v_cvt_pk_bf16_f32 v100, v60, v61
  v_cvt_pk_bf16_f32 v101, v62, v63
  ds_read_b128 v[56:59], v7 offset:4096
  v_cvt_pk_bf16_f32 v94, v64, v65
  v_cvt_pk_bf16_f32 v95, v66, v67
  ds_read_b128 v[60:63], v7 offset:5120
  buffer_load_dwordx4 v[24:27], v2, s[12:15], s55 offen sc1
  ds_read_b128 v[64:67], v7 offset:6144
  s_waitcnt lgkmcnt(7)
  v_smfmac_f32_16x16x64_bf16 v[68:71], v[112:115], v[80:87], v5
  v_smfmac_f32_16x16x64_bf16 v[68:71], v[108:111], v[240:247], v5
  buffer_load_dwordx4 v[76:79], v2, s[12:15], s55 offen offset:1024 sc1
  s_nop 6
  v_cvt_pk_bf16_f32 v102, v68, v69
  v_cvt_pk_bf16_f32 v103, v70, v71
  ds_read_b128 v[68:71], v7 offset:7168
  buffer_load_dwordx2 v[118:119], v9, s[12:15], s55 offen offset:2048 sc1
  buffer_load_dwordx2 v[84:85], v11, s[44:47], s29 offen sc1
  buffer_load_dwordx2 v[86:87], v0, s[44:47], s29 offen sc1
  s_waitcnt vmcnt(2)
  v_max3_u32 v4, v12, v13, v14
  v_max3_u32 v4, v4, v15, v16
  v_max3_u32 v4, v4, v17, v18
  v_max3_u32 v4, v4, v19, v20
  v_max3_u32 v4, v4, v21, v22
  v_max3_u32 v4, v4, v23, v24
  v_max3_u32 v4, v4, v25, v26
  v_max3_u32 v4, v4, v27, v28
  v_max3_u32 v4, v4, v29, v30
  v_max3_u32 v4, v4, v31, v32
  v_max3_u32 v4, v4, v33, v34
  v_max3_u32 v4, v4, v35, v36
  v_max3_u32 v4, v4, v37, v38
  v_max3_u32 v4, v4, v39, v72
  v_max3_u32 v4, v4, v73, v74
  v_max3_u32 v4, v4, v75, v76
  v_max3_u32 v4, v4, v77, v78
  v_max3_u32 v4, v4, v79, v116
  v_max3_u32 v4, v4, v117, v118
  v_max_u32 v4, v4, v119
  v_cmp_eq_u32 vcc, -1, v4
  s_cbranch_vccnz PB_PSLOW
PB_POK:
  s_waitcnt lgkmcnt(0)
  v_mfma_f32_16x16x32_bf16 v[104:107], v[88:91], v[30:33], 0
  v_mfma_f32_16x16x32_bf16 v[112:115], v[96:99], v[30:33], 0
  v_mfma_f32_16x16x16_bf16 v[104:107], v[40:41], v[28:29], v[104:107]
  v_mfma_f32_16x16x32_bf16 v[108:111], v[88:91], v[36:39], 0
  v_mfma_f32_16x16x16_bf16 v[112:115], v[48:49], v[28:29], v[112:115]
  v_mfma_f32_16x16x16_bf16 v[104:107], v[44:45], v[34:35], v[104:107]
  v_mfma_f32_16x16x32_bf16 v[80:83], v[96:99], v[36:39], 0
  v_mfma_f32_16x16x32_bf16 v[108:111], v[40:43], v[12:15], v[108:111]
  v_mfma_f32_16x16x16_bf16 v[112:115], v[52:53], v[34:35], v[112:115]
  v_mfma_f32_16x16x32_bf16 v[80:83], v[48:51], v[12:15], v[80:83]
  v_mfma_f32_16x16x32_bf16 v[104:107], v[92:95], v[74:77], v[104:107]
  v_mfma_f32_16x16x32_bf16 v[108:111], v[44:47], v[16:19], v[108:111]
  v_mfma_f32_16x16x32_bf16 v[112:115], v[100:103], v[74:77], v[112:115]
  v_mfma_f32_16x16x32_bf16 v[80:83], v[52:55], v[16:19], v[80:83]
  v_mfma_f32_16x16x32_bf16 v[108:111], v[92:95], v[116:119], v[108:111]
  v_mfma_f32_16x16x16_bf16 v[104:107], v[56:57], v[72:73], v[104:107]
  v_mfma_f32_16x16x32_bf16 v[80:83], v[100:103], v[116:119], v[80:83]
  v_mfma_f32_16x16x32_bf16 v[108:111], v[56:59], v[20:23], v[108:111]
  v_mfma_f32_16x16x16_bf16 v[112:115], v[64:65], v[72:73], v[112:115]
  v_mfma_f32_16x16x16_bf16 v[104:107], v[60:61], v[78:79], v[104:107]
  v_mfma_f32_16x16x32_bf16 v[80:83], v[64:67], v[20:23], v[80:83]
  v_mfma_f32_16x16x32_bf16 v[108:111], v[60:63], v[24:27], v[108:111]
  ds_write_b128 v7, v[104:107] offset:0
  v_mfma_f32_16x16x16_bf16 v[112:115], v[68:69], v[78:79], v[112:115]
  v_mfma_f32_16x16x32_bf16 v[80:83], v[68:71], v[24:27], v[80:83]
  ds_write_b128 v7, v[108:111] offset:1024
  s_nop 2
  ds_write_b128 v7, v[112:115] offset:2048
  s_nop 2
  ds_write_b128 v7, v[80:83] offset:3072
  s_waitcnt lgkmcnt(0)
  s_barrier
  s_cmp_ge_u32 s3, 2
  s_waitcnt vmcnt(0)
  s_cbranch_scc1 PB_NEXT
  s_max_i32 s42, s41, 0
  s_sub_u32 s42, 32768, s42
  v_add_u32 v4, s42, v8
  ds_read_b128 v[40:43], v4 offset:0
  ds_read_b128 v[44:47], v4 offset:2048
  ds_read_b128 v[48:51], v4 offset:8192
  ds_read_b128 v[52:55], v4 offset:10240
  ds_read_b128 v[56:59], v4 offset:16384
  ds_read_b128 v[60:63], v4 offset:18432
  ds_read_b128 v[64:67], v4 offset:24576
  ds_read_b128 v[68:71], v4 offset:26624
  s_mov_b32 s26, 0
PB_R:
  s_waitcnt vmcnt(0)
  v_max3_u32 v4, v84, v85, v86
  v_max_u32 v4, v4, v87
  v_cmp_eq_u32 vcc, -1, v4
  s_cbranch_vccz PB_ROK
  buffer_load_dwordx2 v[84:85], v11, s[44:47], s29 offen sc1
  buffer_load_dwordx2 v[86:87], v0, s[44:47], s29 offen sc1
  s_add_u32 s26, s26, 1
  s_cmp_gt_u32 s26, 131072
  s_mov_b32 s99, 13
  s_cbranch_scc1 FAIL
  s_branch PB_R
PB_ROK:
  v_lshlrev_b32 v12, 16, v84
  v_and_b32 v13, 0xffff0000, v84
  v_lshlrev_b32 v14, 16, v85
  v_and_b32 v15, 0xffff0000, v85
  v_lshlrev_b32 v16, 16, v86
  v_and_b32 v17, 0xffff0000, v86
  v_lshlrev_b32 v18, 16, v87
  v_and_b32 v19, 0xffff0000, v87
  s_waitcnt lgkmcnt(6)
  v_pk_add_f32 v[12:13], v[12:13], v[40:41]
  v_pk_add_f32 v[14:15], v[14:15], v[42:43]
  v_pk_add_f32 v[16:17], v[16:17], v[44:45]
  v_pk_add_f32 v[18:19], v[18:19], v[46:47]
  s_waitcnt lgkmcnt(4)
  v_pk_add_f32 v[12:13], v[12:13], v[48:49]
  v_pk_add_f32 v[14:15], v[14:15], v[50:51]
  v_pk_add_f32 v[16:17], v[16:17], v[52:53]
  v_pk_add_f32 v[18:19], v[18:19], v[54:55]
  s_waitcnt lgkmcnt(2)
  v_pk_add_f32 v[12:13], v[12:13], v[56:57]
  v_pk_add_f32 v[14:15], v[14:15], v[58:59]
  v_pk_add_f32 v[16:17], v[16:17], v[60:61]
  v_pk_add_f32 v[18:19], v[18:19], v[62:63]
  s_waitcnt lgkmcnt(0)
  v_pk_add_f32 v[12:13], v[12:13], v[64:65]
  v_pk_add_f32 v[14:15], v[14:15], v[66:67]
  v_pk_add_f32 v[16:17], v[16:17], v[68:69]
  v_pk_add_f32 v[18:19], v[18:19], v[70:71]
  v_cvt_pk_bf16_f32 v20, v12, v13
  v_cvt_pk_bf16_f32 v21, v14, v15
  v_cvt_pk_bf16_f32 v22, v16, v17
  v_cvt_pk_bf16_f32 v23, v18, v19
  buffer_store_dwordx4 v[20:23], v2, s[12:15], s30 offen sc1
PB_NEXT:
  ds_read_b128 v[88:91], v3 offset:0
  ds_read_b128 v[92:95], v3 offset:1024
  ds_read_b128 v[96:99], v3 offset:2048
  ds_read_b128 v[100:103], v3 offset:3072
  ds_read_b128 v[104:107], v3 offset:4096
  ds_read_b128 v[108:111], v3 offset:5120
  ds_read_b128 v[112:115], v3 offset:6144
  s_waitcnt lgkmcnt(0)
  v_max3_u32 v4, v88, v89, v90
  v_max3_u32 v4, v4, v91, v92
  v_max3_u32 v4, v4, v93, v94
  v_max3_u32 v4, v4, v95, v96
  v_max3_u32 v4, v4, v97, v98
  v_max3_u32 v4, v4, v99, v100
  v_max3_u32 v4, v4, v101, v102
  v_max3_u32 v4, v4, v103, v104
  v_max3_u32 v4, v4, v105, v106
  v_max3_u32 v4, v4, v107, v108
  v_max3_u32 v4, v4, v109, v110
  v_max3_u32 v4, v4, v111, v112
  v_max3_u32 v4, v4, v113, v114
  v_max_u32 v4, v4, v115
  v_cmp_eq_u32 vcc, -1, v4
  s_cmp_eq_u64 vcc, 0
  s_cselect_b32 s50, 1, 0
  s_add_u32 s27, s27, 86016
  s_add_u32 s28, s28, 122880
  s_add_u32 s29, s29, 86016
  s_add_u32 s30, s30, 86016
  s_cmp_lt_u32 s25, 64
  s_cbranch_scc1 PB_PRE
  s_cmp_eq_u32 s31, 0
  s_cbranch_scc1 END
  s_mov_b32 s31, 0
  v_add_u32 v7, s41, v7
  s_sub_u32 s41, 0, s41
  s_add_u32 s25, s25, 3
  s_mov_b32 s52, 2147418112
  s_add_u32 s51, s27, 4096
  s_barrier
PB_MSLOW:
  s_waitcnt vmcnt(0)
  buffer_store_dword v10, v10, s[12:15], s52 offen sc1
  s_mov_b32 s52, 2147418112
  s_mov_b32 s26, 0
PB_M_L:
  buffer_load_dwordx4 v[88:91], v2, s[12:15], s27 offen offset:0 sc1
  buffer_load_dwordx4 v[92:95], v2, s[12:15], s27 offen offset:1024 sc1
  buffer_load_dwordx4 v[96:99], v2, s[12:15], s27 offen offset:2048 sc1
  buffer_load_dwordx4 v[100:103], v2, s[12:15], s27 offen offset:3072 sc1
  buffer_load_dwordx4 v[104:107], v2, s[12:15], s51 offen offset:0 sc1
  buffer_load_dwordx4 v[108:111], v2, s[12:15], s51 offen offset:1024 sc1
  buffer_load_dwordx4 v[112:115], v2, s[12:15], s51 offen offset:2048 sc1
  s_add_u32 s26, s26, 1
  s_cmp_gt_u32 s26, 131072
  s_mov_b32 s99, 11
  s_cbranch_scc1 FAIL
  s_waitcnt vmcnt(0)
  v_max3_u32 v4, v88, v89, v90
  v_max3_u32 v4, v4, v91, v92
  v_max3_u32 v4, v4, v93, v94
  v_max3_u32 v4, v4, v95, v96
  v_max3_u32 v4, v4, v97, v98
  v_max3_u32 v4, v4, v99, v100
  v_max3_u32 v4, v4, v101, v102
  v_max3_u32 v4, v4, v103, v104
  v_max3_u32 v4, v4, v105, v106
  v_max3_u32 v4, v4, v107, v108
  v_max3_u32 v4, v4, v109, v110
  v_max3_u32 v4, v4, v111, v112
  v_max3_u32 v4, v4, v113, v114
  v_max_u32 v4, v4, v115
  v_cmp_eq_u32 vcc, -1, v4
  s_cbranch_vccz PB_M_OK
  s_sleep 1
  s_branch PB_M_L
PB_M_OK:
  s_branch PB_MOK
PB_PSLOW:
  s_mov_b32 s26, 0
PB_PS:
  buffer_load_dword v12, v1, s[12:15], s28 offen sc1
  s_add_u32 s26, s26, 1
  s_cmp_gt_u32 s26, 131072
  s_mov_b32 s99, 12
  s_cbranch_scc1 FAIL
  s_waitcnt vmcnt(0)
  v_cmp_eq_u32 vcc, -1, v12
  s_cbranch_vccnz PB_PS
  buffer_load_dwordx4 v[12:15], v2, s[12:15], s28 offen sc1
  buffer_load_dwordx4 v[28:31], v2, s[12:15], s28 offen offset:1024 sc1
  buffer_load_dwordx2 v[36:37], v9, s[12:15], s28 offen offset:2048 sc1
  buffer_load_dwordx4 v[16:19], v2, s[12:15], s53 offen sc1
  buffer_load_dwordx4 v[32:35], v2, s[12:15], s53 offen offset:1024 sc1
  buffer_load_dwordx2 v[38:39], v9, s[12:15], s53 offen offset:2048 sc1
  buffer_load_dwordx4 v[20:23], v2, s[12:15], s54 offen sc1
  buffer_load_dwordx4 v[72:75], v2, s[12:15], s54 offen offset:1024 sc1
  buffer_load_dwordx2 v[116:117], v9, s[12:15], s54 offen offset:2048 sc1
  buffer_load_dwordx4 v[24:27], v2, s[12:15], s55 offen sc1
  buffer_load_dwordx4 v[76:79], v2, s[12:15], s55 offen offset:1024 sc1
  buffer_load_dwordx2 v[118:119], v9, s[12:15], s55 offen offset:2048 sc1
  s_waitcnt vmcnt(0)
  v_max3_u32 v4, v12, v13, v14
  v_max3_u32 v4, v4, v15, v16
  v_max3_u32 v4, v4, v17, v18
  v_max3_u32 v4, v4, v19, v20
  v_max3_u32 v4, v4, v21, v22
  v_max3_u32 v4, v4, v23, v24
  v_max3_u32 v4, v4, v25, v26
  v_max3_u32 v4, v4, v27, v28
  v_max3_u32 v4, v4, v29, v30
  v_max3_u32 v4, v4, v31, v32
  v_max3_u32 v4, v4, v33, v34
  v_max3_u32 v4, v4, v35, v36
  v_max3_u32 v4, v4, v37, v38
  v_max3_u32 v4, v4, v39, v72
  v_max3_u32 v4, v4, v73, v74
  v_max3_u32 v4, v4, v75, v76
  v_max3_u32 v4, v4, v77, v78
  v_max3_u32 v4, v4, v79, v116
  v_max3_u32 v4, v4, v117, v118
  v_max_u32 v4, v4, v119
  v_cmp_eq_u32 vcc, -1, v4
  s_cbranch_vccnz PB_PS
  s_branch PB_POK
FF:
  s_mov_b32 s44, s8
  s_mov_b32 s45, s9
  s_mov_b32 s46, 0x1c0000
  s_mov_b32 s47, 0x20000
  v_lshlrev_b32 v2, 4, v1
  s_lshl_b32 s34, s17, 2
  s_add_u32 s34, s34, s3
  s_mul_i32 s20, s34, 114688
  s_add_u32 s20, s20, 12845056
  s_mul_i32 s35, s3, 14336
  s_add_u32 s35, s35, 28672
  v_add_u32 v5, s35, v2
  s_cmp_eq_u32 s17, 7
  s_cbranch_scc1 FF_NOW
  v_min_u32 v12, 55, v1
  v_and_b32 v13, 6, v12
  v_cmp_eq_u32 s[56:57], 2, v13
  v_cmp_gt_u32 vcc, 40, v12
  s_and_b64 vcc, vcc, s[56:57]
  v_mov_b32 v13, 55
  v_cndmask_b32 v12, v12, v13, vcc
  v_add_u32 v12, 200, v12
  v_lshrrev_b32 v13, 3, v12
  v_and_b32 v12, 7, v12
  v_lshlrev_b32 v12, 2, v12
  v_lshl_add_u32 v12, v13, 7, v12
  s_mov_b32 s58, 17895424
  s_mov_b32 s59, 0
FF_WW:
  buffer_load_dword v13, v12, s[12:15], s58 offen sc1
  s_add_u32 s59, s59, 1
  s_cmp_gt_u32 s59, 131072
  s_mov_b32 s99, 18
  s_cbranch_scc1 FAIL
  s_waitcnt vmcnt(0)
  v_cmp_ne_u32 vcc, s90, v13
  s_cbranch_vccz FF_WG
  s_sleep 4
  s_branch FF_WW
FF_WG:
  s_mov_b32 s52, 0x3f803f80
  s_add_u32 s21, s20, 57344
  s_add_u32 s22, s20, 0
  buffer_load_dwordx4 v[12:15], v2, s[12:15], s22 offen
  s_add_u32 s22, s22, 4096
  buffer_load_dwordx4 v[16:19], v2, s[12:15], s22 offen
  s_add_u32 s22, s22, 4096
  buffer_load_dwordx4 v[20:23], v2, s[12:15], s22 offen
  s_add_u32 s22, s22, 4096
  buffer_load_dwordx4 v[24:27], v2, s[12:15], s22 offen
  s_add_u32 s22, s22, 4096
  buffer_load_dwordx4 v[28:31], v2, s[12:15], s22 offen
  s_add_u32 s22, s22, 4096
  buffer_load_dwordx4 v[32:35], v2, s[12:15], s22 offen
  s_add_u32 s22, s22, 4096
  buffer_load_dwordx4 v[36:39], v2, s[12:15], s22 offen
  s_add_u32 s22, s22, 4096
  buffer_load_dwordx4 v[40:43], v2, s[12:15], s22 offen
  s_add_u32 s22, s22, 4096
  buffer_load_dwordx4 v[44:47], v2, s[12:15], s22 offen
  s_add_u32 s22, s22, 4096
  buffer_load_dwordx4 v[48:51], v2, s[12:15], s22 offen
  s_add_u32 s22, s22, 4096
  buffer_load_dwordx4 v[52:55], v2, s[12:15], s22 offen
  s_add_u32 s22, s22, 4096
  buffer_load_dwordx4 v[56:59], v2, s[12:15], s22 offen
  s_add_u32 s22, s22, 4096
  buffer_load_dwordx4 v[60:63], v2, s[12:15], s22 offen
  s_add_u32 s22, s22, 4096
  buffer_load_dwordx4 v[64:67], v2, s[12:15], s22 offen
  s_add_u32 s22, s22, 4096
  s_add_u32 s22, s20, 1024
  buffer_load_dwordx4 v[68:71], v2, s[12:15], s22 offen
  s_add_u32 s22, s22, 4096
  buffer_load_dwordx4 v[72:75], v2, s[12:15], s22 offen
  s_add_u32 s22, s22, 4096
  buffer_load_dwordx4 v[76:79], v2, s[12:15], s22 offen
  s_add_u32 s22, s22, 4096
  buffer_load_dwordx4 v[80:83], v2, s[12:15], s22 offen
  s_add_u32 s22, s22, 4096
  buffer_load_dwordx4 v[84:87], v2, s[12:15], s22 offen
  s_add_u32 s22, s22, 4096
  buffer_load_dwordx4 v[88:91], v2, s[12:15], s22 offen
  s_add_u32 s22, s22, 4096
  buffer_load_dwordx4 v[92:95], v2, s[12:15], s22 offen
  s_add_u32 s22, s22, 4096
  buffer_load_dwordx4 v[96:99], v2, s[12:15], s22 offen
  s_add_u32 s22, s22, 4096
  buffer_load_dwordx4 v[100:103], v2, s[12:15], s22 offen
  s_add_u32 s22, s22, 4096
  buffer_load_dwordx4 v[104:107], v2, s[12:15], s22 offen
  s_add_u32 s22, s22, 4096
  buffer_load_dwordx4 v[108:111], v2, s[12:15], s22 offen
  s_add_u32 s22, s22, 4096
  buffer_load_dwordx4 v[112:115], v2, s[12:15], s22 offen
  s_add_u32 s22, s22, 4096
  buffer_load_dwordx4 v[116:119], v2, s[12:15], s22 offen
  s_add_u32 s22, s22, 4096
  buffer_load_dwordx4 v[248:251], v2, s[12:15], s22 offen
  s_add_u32 s22, s22, 4096
  s_waitcnt vmcnt(14)
  v_mov_b32 v8, 0
  v_mov_b32 v9, 0
  v_dot2_f32_bf16 v8, v12, s52, v8
  v_dot2_f32_bf16 v9, v13, s52, v9
  v_dot2_f32_bf16 v8, v14, s52, v8
  v_dot2_f32_bf16 v9, v15, s52, v9
  v_dot2_f32_bf16 v8, v16, s52, v8
  v_dot2_f32_bf16 v9, v17, s52, v9
  v_dot2_f32_bf16 v8, v18, s52, v8
  v_dot2_f32_bf16 v9, v19, s52, v9
  v_dot2_f32_bf16 v8, v20, s52, v8
  v_dot2_f32_bf16 v9, v21, s52, v9
  v_dot2_f32_bf16 v8, v22, s52, v8
  v_dot2_f32_bf16 v9, v23, s52, v9
  v_dot2_f32_bf16 v8, v24, s52, v8
  v_dot2_f32_bf16 v9, v25, s52, v9
  v_dot2_f32_bf16 v8, v26, s52, v8
  v_dot2_f32_bf16 v9, v27, s52, v9
  v_dot2_f32_bf16 v8, v28, s52, v8
  v_dot2_f32_bf16 v9, v29, s52, v9
  v_dot2_f32_bf16 v8, v30, s52, v8
  v_dot2_f32_bf16 v9, v31, s52, v9
  v_dot2_f32_bf16 v8, v32, s52, v8
  v_dot2_f32_bf16 v9, v33, s52, v9
  v_dot2_f32_bf16 v8, v34, s52, v8
  v_dot2_f32_bf16 v9, v35, s52, v9
  v_dot2_f32_bf16 v8, v36, s52, v8
  v_dot2_f32_bf16 v9, v37, s52, v9
  v_dot2_f32_bf16 v8, v38, s52, v8
  v_dot2_f32_bf16 v9, v39, s52, v9
  v_dot2_f32_bf16 v8, v40, s52, v8
  v_dot2_f32_bf16 v9, v41, s52, v9
  v_dot2_f32_bf16 v8, v42, s52, v8
  v_dot2_f32_bf16 v9, v43, s52, v9
  v_dot2_f32_bf16 v8, v44, s52, v8
  v_dot2_f32_bf16 v9, v45, s52, v9
  v_dot2_f32_bf16 v8, v46, s52, v8
  v_dot2_f32_bf16 v9, v47, s52, v9
  v_dot2_f32_bf16 v8, v48, s52, v8
  v_dot2_f32_bf16 v9, v49, s52, v9
  v_dot2_f32_bf16 v8, v50, s52, v8
  v_dot2_f32_bf16 v9, v51, s52, v9
  v_dot2_f32_bf16 v8, v52, s52, v8
  v_dot2_f32_bf16 v9, v53, s52, v9
  v_dot2_f32_bf16 v8, v54, s52, v8
  v_dot2_f32_bf16 v9, v55, s52, v9
  v_dot2_f32_bf16 v8, v56, s52, v8
  v_dot2_f32_bf16 v9, v57, s52, v9
  v_dot2_f32_bf16 v8, v58, s52, v8
  v_dot2_f32_bf16 v9, v59, s52, v9
  v_dot2_f32_bf16 v8, v60, s52, v8
  v_dot2_f32_bf16 v9, v61, s52, v9
  v_dot2_f32_bf16 v8, v62, s52, v8
  v_dot2_f32_bf16 v9, v63, s52, v9
  v_dot2_f32_bf16 v8, v64, s52, v8
  v_dot2_f32_bf16 v9, v65, s52, v9
  v_dot2_f32_bf16 v8, v66, s52, v8
  v_dot2_f32_bf16 v9, v67, s52, v9
  s_nop 2
  v_add_f32 v8, v8, v9
  v_mov_b32 v9, v8
  s_nop 1
  v_permlane16_swap_b32 v8, v9
  v_add_f32 v8, v8, v9
  v_mov_b32 v9, v8
  s_nop 1
  v_permlane32_swap_b32 v8, v9
  v_add_f32 v8, v8, v9
  v_mul_f32 v8, 0x3b124925, v8
  v_lshlrev_b32 v10, 16, v12
  v_and_b32 v11, 0xffff0000, v12
  v_pk_add_f32 v[10:11], v[10:11], v[8:9] op_sel_hi:[1,0] neg_lo:[0,1] neg_hi:[0,1]
  v_cvt_pk_bf16_f32 v10, v10, v11
  v_accvgpr_write_b32 a0, v10
  v_lshlrev_b32 v6, 16, v13
  v_and_b32 v7, 0xffff0000, v13
  v_pk_add_f32 v[6:7], v[6:7], v[8:9] op_sel_hi:[1,0] neg_lo:[0,1] neg_hi:[0,1]
  v_cvt_pk_bf16_f32 v6, v6, v7
  v_accvgpr_write_b32 a1, v6
  v_lshlrev_b32 v10, 16, v14
  v_and_b32 v11, 0xffff0000, v14
  v_pk_add_f32 v[10:11], v[10:11], v[8:9] op_sel_hi:[1,0] neg_lo:[0,1] neg_hi:[0,1]
  v_cvt_pk_bf16_f32 v10, v10, v11
  v_accvgpr_write_b32 a2, v10
  v_lshlrev_b32 v6, 16, v15
  v_and_b32 v7, 0xffff0000, v15
  v_pk_add_f32 v[6:7], v[6:7], v[8:9] op_sel_hi:[1,0] neg_lo:[0,1] neg_hi:[0,1]
  v_cvt_pk_bf16_f32 v6, v6, v7
  v_accvgpr_write_b32 a3, v6
  v_lshlrev_b32 v10, 16, v16
  v_and_b32 v11, 0xffff0000, v16
  v_pk_add_f32 v[10:11], v[10:11], v[8:9] op_sel_hi:[1,0] neg_lo:[0,1] neg_hi:[0,1]
  v_cvt_pk_bf16_f32 v10, v10, v11
  v_accvgpr_write_b32 a16, v10
  v_lshlrev_b32 v6, 16, v17
  v_and_b32 v7, 0xffff0000, v17
  v_pk_add_f32 v[6:7], v[6:7], v[8:9] op_sel_hi:[1,0] neg_lo:[0,1] neg_hi:[0,1]
  v_cvt_pk_bf16_f32 v6, v6, v7
  v_accvgpr_write_b32 a17, v6
  v_lshlrev_b32 v10, 16, v18
  v_and_b32 v11, 0xffff0000, v18
  v_pk_add_f32 v[10:11], v[10:11], v[8:9] op_sel_hi:[1,0] neg_lo:[0,1] neg_hi:[0,1]
  v_cvt_pk_bf16_f32 v10, v10, v11
  v_accvgpr_write_b32 a18, v10
  v_lshlrev_b32 v6, 16, v19
  v_and_b32 v7, 0xffff0000, v19
  v_pk_add_f32 v[6:7], v[6:7], v[8:9] op_sel_hi:[1,0] neg_lo:[0,1] neg_hi:[0,1]
  v_cvt_pk_bf16_f32 v6, v6, v7
  v_accvgpr_write_b32 a19, v6
  v_lshlrev_b32 v10, 16, v20
  v_and_b32 v11, 0xffff0000, v20
  v_pk_add_f32 v[10:11], v[10:11], v[8:9] op_sel_hi:[1,0] neg_lo:[0,1] neg_hi:[0,1]
  v_cvt_pk_bf16_f32 v10, v10, v11
  v_accvgpr_write_b32 a32, v10
  v_lshlrev_b32 v6, 16, v21
  v_and_b32 v7, 0xffff0000, v21
  v_pk_add_f32 v[6:7], v[6:7], v[8:9] op_sel_hi:[1,0] neg_lo:[0,1] neg_hi:[0,1]
  v_cvt_pk_bf16_f32 v6, v6, v7
  v_accvgpr_write_b32 a33, v6
  v_lshlrev_b32 v10, 16, v22
  v_and_b32 v11, 0xffff0000, v22
  v_pk_add_f32 v[10:11], v[10:11], v[8:9] op_sel_hi:[1,0] neg_lo:[0,1] neg_hi:[0,1]
  v_cvt_pk_bf16_f32 v10, v10, v11
  v_accvgpr_write_b32 a34, v10
  v_lshlrev_b32 v6, 16, v23
  v_and_b32 v7, 0xffff0000, v23
  v_pk_add_f32 v[6:7], v[6:7], v[8:9] op_sel_hi:[1,0] neg_lo:[0,1] neg_hi:[0,1]
  v_cvt_pk_bf16_f32 v6, v6, v7
  v_accvgpr_write_b32 a35, v6
  v_lshlrev_b32 v10, 16, v24
  v_and_b32 v11, 0xffff0000, v24
  v_pk_add_f32 v[10:11], v[10:11], v[8:9] op_sel_hi:[1,0] neg_lo:[0,1] neg_hi:[0,1]
  v_cvt_pk_bf16_f32 v10, v10, v11
  v_accvgpr_write_b32 a48, v10
  v_lshlrev_b32 v6, 16, v25
  v_and_b32 v7, 0xffff0000, v25
  v_pk_add_f32 v[6:7], v[6:7], v[8:9] op_sel_hi:[1,0] neg_lo:[0,1] neg_hi:[0,1]
  v_cvt_pk_bf16_f32 v6, v6, v7
  v_accvgpr_write_b32 a49, v6
  v_lshlrev_b32 v10, 16, v26
  v_and_b32 v11, 0xffff0000, v26
  v_pk_add_f32 v[10:11], v[10:11], v[8:9] op_sel_hi:[1,0] neg_lo:[0,1] neg_hi:[0,1]
  v_cvt_pk_bf16_f32 v10, v10, v11
  v_accvgpr_write_b32 a50, v10
  v_lshlrev_b32 v6, 16, v27
  v_and_b32 v7, 0xffff0000, v27
  v_pk_add_f32 v[6:7], v[6:7], v[8:9] op_sel_hi:[1,0] neg_lo:[0,1] neg_hi:[0,1]
  v_cvt_pk_bf16_f32 v6, v6, v7
  v_accvgpr_write_b32 a51, v6
  v_lshlrev_b32 v10, 16, v28
  v_and_b32 v11, 0xffff0000, v28
  v_pk_add_f32 v[10:11], v[10:11], v[8:9] op_sel_hi:[1,0] neg_lo:[0,1] neg_hi:[0,1]
  v_cvt_pk_bf16_f32 v10, v10, v11
  v_accvgpr_write_b32 a64, v10
  v_lshlrev_b32 v6, 16, v29
  v_and_b32 v7, 0xffff0000, v29
  v_pk_add_f32 v[6:7], v[6:7], v[8:9] op_sel_hi:[1,0] neg_lo:[0,1] neg_hi:[0,1]
  v_cvt_pk_bf16_f32 v6, v6, v7
  v_accvgpr_write_b32 a65, v6
  v_lshlrev_b32 v10, 16, v30
  v_and_b32 v11, 0xffff0000, v30
  v_pk_add_f32 v[10:11], v[10:11], v[8:9] op_sel_hi:[1,0] neg_lo:[0,1] neg_hi:[0,1]
  v_cvt_pk_bf16_f32 v10, v10, v11
  v_accvgpr_write_b32 a66, v10
  v_lshlrev_b32 v6, 16, v31
  v_and_b32 v7, 0xffff0000, v31
  v_pk_add_f32 v[6:7], v[6:7], v[8:9] op_sel_hi:[1,0] neg_lo:[0,1] neg_hi:[0,1]
  v_cvt_pk_bf16_f32 v6, v6, v7
  v_accvgpr_write_b32 a67, v6
  v_lshlrev_b32 v10, 16, v32
  v_and_b32 v11, 0xffff0000, v32
  v_pk_add_f32 v[10:11], v[10:11], v[8:9] op_sel_hi:[1,0] neg_lo:[0,1] neg_hi:[0,1]
  v_cvt_pk_bf16_f32 v10, v10, v11
  v_accvgpr_write_b32 a80, v10
  v_lshlrev_b32 v6, 16, v33
  v_and_b32 v7, 0xffff0000, v33
  v_pk_add_f32 v[6:7], v[6:7], v[8:9] op_sel_hi:[1,0] neg_lo:[0,1] neg_hi:[0,1]
  v_cvt_pk_bf16_f32 v6, v6, v7
  v_accvgpr_write_b32 a81, v6
  v_lshlrev_b32 v10, 16, v34
  v_and_b32 v11, 0xffff0000, v34
  v_pk_add_f32 v[10:11], v[10:11], v[8:9] op_sel_hi:[1,0] neg_lo:[0,1] neg_hi:[0,1]
  v_cvt_pk_bf16_f32 v10, v10, v11
  v_accvgpr_write_b32 a82, v10
  v_lshlrev_b32 v6, 16, v35
  v_and_b32 v7, 0xffff0000, v35
  v_pk_add_f32 v[6:7], v[6:7], v[8:9] op_sel_hi:[1,0] neg_lo:[0,1] neg_hi:[0,1]
  v_cvt_pk_bf16_f32 v6, v6, v7
  v_accvgpr_write_b32 a83, v6
  v_lshlrev_b32 v10, 16, v36
  v_and_b32 v11, 0xffff0000, v36
  v_pk_add_f32 v[10:11], v[10:11], v[8:9] op_sel_hi:[1,0] neg_lo:[0,1] neg_hi:[0,1]
  v_cvt_pk_bf16_f32 v10, v10, v11
  v_accvgpr_write_b32 a96, v10
  v_lshlrev_b32 v6, 16, v37
  v_and_b32 v7, 0xffff0000, v37
  v_pk_add_f32 v[6:7], v[6:7], v[8:9] op_sel_hi:[1,0] neg_lo:[0,1] neg_hi:[0,1]
  v_cvt_pk_bf16_f32 v6, v6, v7
  v_accvgpr_write_b32 a97, v6
  v_lshlrev_b32 v10, 16, v38
  v_and_b32 v11, 0xffff0000, v38
  v_pk_add_f32 v[10:11], v[10:11], v[8:9] op_sel_hi:[1,0] neg_lo:[0,1] neg_hi:[0,1]
  v_cvt_pk_bf16_f32 v10, v10, v11
  v_accvgpr_write_b32 a98, v10
  v_lshlrev_b32 v6, 16, v39
  v_and_b32 v7, 0xffff0000, v39
  v_pk_add_f32 v[6:7], v[6:7], v[8:9] op_sel_hi:[1,0] neg_lo:[0,1] neg_hi:[0,1]
  v_cvt_pk_bf16_f32 v6, v6, v7
  v_accvgpr_write_b32 a99, v6
  v_lshlrev_b32 v10, 16, v40
  v_and_b32 v11, 0xffff0000, v40
  v_pk_add_f32 v[10:11], v[10:11], v[8:9] op_sel_hi:[1,0] neg_lo:[0,1] neg_hi:[0,1]
  v_cvt_pk_bf16_f32 v10, v10, v11
  v_accvgpr_write_b32 a112, v10
  v_lshlrev_b32 v6, 16, v41
  v_and_b32 v7, 0xffff0000, v41
  v_pk_add_f32 v[6:7], v[6:7], v[8:9] op_sel_hi:[1,0] neg_lo:[0,1] neg_hi:[0,1]
  v_cvt_pk_bf16_f32 v6, v6, v7
  v_accvgpr_write_b32 a113, v6
  v_lshlrev_b32 v10, 16, v42
  v_and_b32 v11, 0xffff0000, v42
  v_pk_add_f32 v[10:11], v[10:11], v[8:9] op_sel_hi:[1,0] neg_lo:[0,1] neg_hi:[0,1]
  v_cvt_pk_bf16_f32 v10, v10, v11
  v_accvgpr_write_b32 a114, v10
  v_lshlrev_b32 v6, 16, v43
  v_and_b32 v7, 0xffff0000, v43
  v_pk_add_f32 v[6:7], v[6:7], v[8:9] op_sel_hi:[1,0] neg_lo:[0,1] neg_hi:[0,1]
  v_cvt_pk_bf16_f32 v6, v6, v7
  v_accvgpr_write_b32 a115, v6
  v_lshlrev_b32 v10, 16, v44
  v_and_b32 v11, 0xffff0000, v44
  v_pk_add_f32 v[10:11], v[10:11], v[8:9] op_sel_hi:[1,0] neg_lo:[0,1] neg_hi:[0,1]
  v_cvt_pk_bf16_f32 v10, v10, v11
  v_accvgpr_write_b32 a128, v10
  v_lshlrev_b32 v6, 16, v45
  v_and_b32 v7, 0xffff0000, v45
  v_pk_add_f32 v[6:7], v[6:7], v[8:9] op_sel_hi:[1,0] neg_lo:[0,1] neg_hi:[0,1]
  v_cvt_pk_bf16_f32 v6, v6, v7
  v_accvgpr_write_b32 a129, v6
  v_lshlrev_b32 v10, 16, v46
  v_and_b32 v11, 0xffff0000, v46
  v_pk_add_f32 v[10:11], v[10:11], v[8:9] op_sel_hi:[1,0] neg_lo:[0,1] neg_hi:[0,1]
  v_cvt_pk_bf16_f32 v10, v10, v11
  v_accvgpr_write_b32 a130, v10
  v_lshlrev_b32 v6, 16, v47
  v_and_b32 v7, 0xffff0000, v47
  v_pk_add_f32 v[6:7], v[6:7], v[8:9] op_sel_hi:[1,0] neg_lo:[0,1] neg_hi:[0,1]
  v_cvt_pk_bf16_f32 v6, v6, v7
  v_accvgpr_write_b32 a131, v6
  v_lshlrev_b32 v10, 16, v48
  v_and_b32 v11, 0xffff0000, v48
  v_pk_add_f32 v[10:11], v[10:11], v[8:9] op_sel_hi:[1,0] neg_lo:[0,1] neg_hi:[0,1]
  v_cvt_pk_bf16_f32 v10, v10, v11
  v_accvgpr_write_b32 a144, v10
  v_lshlrev_b32 v6, 16, v49
  v_and_b32 v7, 0xffff0000, v49
  v_pk_add_f32 v[6:7], v[6:7], v[8:9] op_sel_hi:[1,0] neg_lo:[0,1] neg_hi:[0,1]
  v_cvt_pk_bf16_f32 v6, v6, v7
  v_accvgpr_write_b32 a145, v6
  v_lshlrev_b32 v10, 16, v50
  v_and_b32 v11, 0xffff0000, v50
  v_pk_add_f32 v[10:11], v[10:11], v[8:9] op_sel_hi:[1,0] neg_lo:[0,1] neg_hi:[0,1]
  v_cvt_pk_bf16_f32 v10, v10, v11
  v_accvgpr_write_b32 a146, v10
  v_lshlrev_b32 v6, 16, v51
  v_and_b32 v7, 0xffff0000, v51
  v_pk_add_f32 v[6:7], v[6:7], v[8:9] op_sel_hi:[1,0] neg_lo:[0,1] neg_hi:[0,1]
  v_cvt_pk_bf16_f32 v6, v6, v7
  v_accvgpr_write_b32 a147, v6
  v_lshlrev_b32 v10, 16, v52
  v_and_b32 v11, 0xffff0000, v52
  v_pk_add_f32 v[10:11], v[10:11], v[8:9] op_sel_hi:[1,0] neg_lo:[0,1] neg_hi:[0,1]
  v_cvt_pk_bf16_f32 v10, v10, v11
  v_accvgpr_write_b32 a160, v10
  v_lshlrev_b32 v6, 16, v53
  v_and_b32 v7, 0xffff0000, v53
  v_pk_add_f32 v[6:7], v[6:7], v[8:9] op_sel_hi:[1,0] neg_lo:[0,1] neg_hi:[0,1]
  v_cvt_pk_bf16_f32 v6, v6, v7
  v_accvgpr_write_b32 a161, v6
  v_lshlrev_b32 v10, 16, v54
  v_and_b32 v11, 0xffff0000, v54
  v_pk_add_f32 v[10:11], v[10:11], v[8:9] op_sel_hi:[1,0] neg_lo:[0,1] neg_hi:[0,1]
  v_cvt_pk_bf16_f32 v10, v10, v11
  v_accvgpr_write_b32 a162, v10
  v_lshlrev_b32 v6, 16, v55
  v_and_b32 v7, 0xffff0000, v55
  v_pk_add_f32 v[6:7], v[6:7], v[8:9] op_sel_hi:[1,0] neg_lo:[0,1] neg_hi:[0,1]
  v_cvt_pk_bf16_f32 v6, v6, v7
  v_accvgpr_write_b32 a163, v6
  v_lshlrev_b32 v10, 16, v56
  v_and_b32 v11, 0xffff0000, v56
  v_pk_add_f32 v[10:11], v[10:11], v[8:9] op_sel_hi:[1,0] neg_lo:[0,1] neg_hi:[0,1]
  v_cvt_pk_bf16_f32 v10, v10, v11
  v_accvgpr_write_b32 a176, v10
  v_lshlrev_b32 v6, 16, v57
  v_and_b32 v7, 0xffff0000, v57
  v_pk_add_f32 v[6:7], v[6:7], v[8:9] op_sel_hi:[1,0] neg_lo:[0,1] neg_hi:[0,1]
  v_cvt_pk_bf16_f32 v6, v6, v7
  v_accvgpr_write_b32 a177, v6
  v_lshlrev_b32 v10, 16, v58
  v_and_b32 v11, 0xffff0000, v58
  v_pk_add_f32 v[10:11], v[10:11], v[8:9] op_sel_hi:[1,0] neg_lo:[0,1] neg_hi:[0,1]
  v_cvt_pk_bf16_f32 v10, v10, v11
  v_accvgpr_write_b32 a178, v10
  v_lshlrev_b32 v6, 16, v59
  v_and_b32 v7, 0xffff0000, v59
  v_pk_add_f32 v[6:7], v[6:7], v[8:9] op_sel_hi:[1,0] neg_lo:[0,1] neg_hi:[0,1]
  v_cvt_pk_bf16_f32 v6, v6, v7
  v_accvgpr_write_b32 a179, v6
  v_lshlrev_b32 v10, 16, v60
  v_and_b32 v11, 0xffff0000, v60
  v_pk_add_f32 v[10:11], v[10:11], v[8:9] op_sel_hi:[1,0] neg_lo:[0,1] neg_hi:[0,1]
  v_cvt_pk_bf16_f32 v10, v10, v11
  v_accvgpr_write_b32 a192, v10
  v_lshlrev_b32 v6, 16, v61
  v_and_b32 v7, 0xffff0000, v61
  v_pk_add_f32 v[6:7], v[6:7], v[8:9] op_sel_hi:[1,0] neg_lo:[0,1] neg_hi:[0,1]
  v_cvt_pk_bf16_f32 v6, v6, v7
  v_accvgpr_write_b32 a193, v6
  v_lshlrev_b32 v10, 16, v62
  v_and_b32 v11, 0xffff0000, v62
  v_pk_add_f32 v[10:11], v[10:11], v[8:9] op_sel_hi:[1,0] neg_lo:[0,1] neg_hi:[0,1]
  v_cvt_pk_bf16_f32 v10, v10, v11
  v_accvgpr_write_b32 a194, v10
  v_lshlrev_b32 v6, 16, v63
  v_and_b32 v7, 0xffff0000, v63
  v_pk_add_f32 v[6:7], v[6:7], v[8:9] op_sel_hi:[1,0] neg_lo:[0,1] neg_hi:[0,1]
  v_cvt_pk_bf16_f32 v6, v6, v7
  v_accvgpr_write_b32 a195, v6
  v_lshlrev_b32 v10, 16, v64
  v_and_b32 v11, 0xffff0000, v64
  v_pk_add_f32 v[10:11], v[10:11], v[8:9] op_sel_hi:[1,0] neg_lo:[0,1] neg_hi:[0,1]
  v_cvt_pk_bf16_f32 v10, v10, v11
  v_accvgpr_write_b32 a208, v10
  v_lshlrev_b32 v6, 16, v65
  v_and_b32 v7, 0xffff0000, v65
  v_pk_add_f32 v[6:7], v[6:7], v[8:9] op_sel_hi:[1,0] neg_lo:[0,1] neg_hi:[0,1]
  v_cvt_pk_bf16_f32 v6, v6, v7
  v_accvgpr_write_b32 a209, v6
  v_lshlrev_b32 v10, 16, v66
  v_and_b32 v11, 0xffff0000, v66
  v_pk_add_f32 v[10:11], v[10:11], v[8:9] op_sel_hi:[1,0] neg_lo:[0,1] neg_hi:[0,1]
  v_cvt_pk_bf16_f32 v10, v10, v11
  v_accvgpr_write_b32 a210, v10
  v_lshlrev_b32 v6, 16, v67
  v_and_b32 v7, 0xffff0000, v67
  v_pk_add_f32 v[6:7], v[6:7], v[8:9] op_sel_hi:[1,0] neg_lo:[0,1] neg_hi:[0,1]
  v_cvt_pk_bf16_f32 v6, v6, v7
  v_accvgpr_write_b32 a211, v6
  s_add_u32 s22, s20, 2048
  buffer_load_dwordx4 v[12:15], v2, s[12:15], s22 offen
  s_add_u32 s22, s22, 4096
  buffer_load_dwordx4 v[16:19], v2, s[12:15], s22 offen
  s_add_u32 s22, s22, 4096
  buffer_load_dwordx4 v[20:23], v2, s[12:15], s22 offen
  s_add_u32 s22, s22, 4096
  buffer_load_dwordx4 v[24:27], v2, s[12:15], s22 offen
  s_add_u32 s22, s22, 4096
  buffer_load_dwordx4 v[28:31], v2, s[12:15], s22 offen
  s_add_u32 s22, s22, 4096
  buffer_load_dwordx4 v[32:35], v2, s[12:15], s22 offen
  s_add_u32 s22, s22, 4096
  buffer_load_dwordx4 v[36:39], v2, s[12:15], s22 offen
  s_add_u32 s22, s22, 4096
  buffer_load_dwordx4 v[40:43], v2, s[12:15], s22 offen
  s_add_u32 s22, s22, 4096
  buffer_load_dwordx4 v[44:47], v2, s[12:15], s22 offen
  s_add_u32 s22, s22, 4096
  buffer_load_dwordx4 v[48:51], v2, s[12:15], s22 offen
  s_add_u32 s22, s22, 4096
  buffer_load_dwordx4 v[52:55], v2, s[12:15], s22 offen
  s_add_u32 s22, s22, 4096
  buffer_load_dwordx4 v[56:59], v2, s[12:15], s22 offen
  s_add_u32 s22, s22, 4096
  buffer_load_dwordx4 v[60:63], v2, s[12:15], s22 offen
  s_add_u32 s22, s22, 4096
  buffer_load_dwordx4 v[64:67], v2, s[12:15], s22 offen
  s_add_u32 s22, s22, 4096
  s_waitcnt vmcnt(14)
  v_mov_b32 v8, 0
  v_mov_b32 v9, 0
  v_dot2_f32_bf16 v8, v68, s52, v8
  v_dot2_f32_bf16 v9, v69, s52, v9
  v_dot2_f32_bf16 v8, v70, s52, v8
  v_dot2_f32_bf16 v9, v71, s52, v9
  v_dot2_f32_bf16 v8, v72, s52, v8
  v_dot2_f32_bf16 v9, v73, s52, v9
  v_dot2_f32_bf16 v8, v74, s52, v8
  v_dot2_f32_bf16 v9, v75, s52, v9
  v_dot2_f32_bf16 v8, v76, s52, v8
  v_dot2_f32_bf16 v9, v77, s52, v9
  v_dot2_f32_bf16 v8, v78, s52, v8
  v_dot2_f32_bf16 v9, v79, s52, v9
  v_dot2_f32_bf16 v8, v80, s52, v8
  v_dot2_f32_bf16 v9, v81, s52, v9
  v_dot2_f32_bf16 v8, v82, s52, v8
  v_dot2_f32_bf16 v9, v83, s52, v9
  v_dot2_f32_bf16 v8, v84, s52, v8
  v_dot2_f32_bf16 v9, v85, s52, v9
  v_dot2_f32_bf16 v8, v86, s52, v8
  v_dot2_f32_bf16 v9, v87, s52, v9
  v_dot2_f32_bf16 v8, v88, s52, v8
  v_dot2_f32_bf16 v9, v89, s52, v9
  v_dot2_f32_bf16 v8, v90, s52, v8
  v_dot2_f32_bf16 v9, v91, s52, v9
  v_dot2_f32_bf16 v8, v92, s52, v8
  v_dot2_f32_bf16 v9, v93, s52, v9
  v_dot2_f32_bf16 v8, v94, s52, v8
  v_dot2_f32_bf16 v9, v95, s52, v9
  v_dot2_f32_bf16 v8, v96, s52, v8
  v_dot2_f32_bf16 v9, v97, s52, v9
  v_dot2_f32_bf16 v8, v98, s52, v8
  v_dot2_f32_bf16 v9, v99, s52, v9
  v_dot2_f32_bf16 v8, v100, s52, v8
  v_dot2_f32_bf16 v9, v101, s52, v9
  v_dot2_f32_bf16 v8, v102, s52, v8
  v_dot2_f32_bf16 v9, v103, s52, v9
  v_dot2_f32_bf16 v8, v104, s52, v8
  v_dot2_f32_bf16 v9, v105, s52, v9
  v_dot2_f32_bf16 v8, v106, s52, v8
  v_dot2_f32_bf16 v9, v107, s52, v9
  v_dot2_f32_bf16 v8, v108, s52, v8
  v_dot2_f32_bf16 v9, v109, s52, v9
  v_dot2_f32_bf16 v8, v110, s52, v8
  v_dot2_f32_bf16 v9, v111, s52, v9
  v_dot2_f32_bf16 v8, v112, s52, v8
  v_dot2_f32_bf16 v9, v113, s52, v9
  v_dot2_f32_bf16 v8, v114, s52, v8
  v_dot2_f32_bf16 v9, v115, s52, v9
  v_dot2_f32_bf16 v8, v116, s52, v8
  v_dot2_f32_bf16 v9, v117, s52, v9
  v_dot2_f32_bf16 v8, v118, s52, v8
  v_dot2_f32_bf16 v9, v119, s52, v9
  v_dot2_f32_bf16 v8, v248, s52, v8
  v_dot2_f32_bf16 v9, v249, s52, v9
  v_dot2_f32_bf16 v8, v250, s52, v8
  v_dot2_f32_bf16 v9, v251, s52, v9
  s_nop 2
  v_add_f32 v8, v8, v9
  v_mov_b32 v9, v8
  s_nop 1
  v_permlane16_swap_b32 v8, v9
  v_add_f32 v8, v8, v9
  v_mov_b32 v9, v8
  s_nop 1
  v_permlane32_swap_b32 v8, v9
  v_add_f32 v8, v8, v9
  v_mul_f32 v8, 0x3b124925, v8
  v_lshlrev_b32 v10, 16, v68
  v_and_b32 v11, 0xffff0000, v68
  v_pk_add_f32 v[10:11], v[10:11], v[8:9] op_sel_hi:[1,0] neg_lo:[0,1] neg_hi:[0,1]
  v_cvt_pk_bf16_f32 v10, v10, v11
  v_accvgpr_write_b32 a4, v10
  v_lshlrev_b32 v6, 16, v69
  v_and_b32 v7, 0xffff0000, v69
  v_pk_add_f32 v[6:7], v[6:7], v[8:9] op_sel_hi:[1,0] neg_lo:[0,1] neg_hi:[0,1]
  v_cvt_pk_bf16_f32 v6, v6, v7
  v_accvgpr_write_b32 a5, v6
  v_lshlrev_b32 v10, 16, v70
  v_and_b32 v11, 0xffff0000, v70
  v_pk_add_f32 v[10:11], v[10:11], v[8:9] op_sel_hi:[1,0] neg_lo:[0,1] neg_hi:[0,1]
  v_cvt_pk_bf16_f32 v10, v10, v11
  v_accvgpr_write_b32 a6, v10
  v_lshlrev_b32 v6, 16, v71
  v_and_b32 v7, 0xffff0000, v71
  v_pk_add_f32 v[6:7], v[6:7], v[8:9] op_sel_hi:[1,0] neg_lo:[0,1] neg_hi:[0,1]
  v_cvt_pk_bf16_f32 v6, v6, v7
  v_accvgpr_write_b32 a7, v6
  v_lshlrev_b32 v10, 16, v72
  v_and_b32 v11, 0xffff0000, v72
  v_pk_add_f32 v[10:11], v[10:11], v[8:9] op_sel_hi:[1,0] neg_lo:[0,1] neg_hi:[0,1]
  v_cvt_pk_bf16_f32 v10, v10, v11
  v_accvgpr_write_b32 a20, v10
  v_lshlrev_b32 v6, 16, v73
  v_and_b32 v7, 0xffff0000, v73
  v_pk_add_f32 v[6:7], v[6:7], v[8:9] op_sel_hi:[1,0] neg_lo:[0,1] neg_hi:[0,1]
  v_cvt_pk_bf16_f32 v6, v6, v7
  v_accvgpr_write_b32 a21, v6
  v_lshlrev_b32 v10, 16, v74
  v_and_b32 v11, 0xffff0000, v74
  v_pk_add_f32 v[10:11], v[10:11], v[8:9] op_sel_hi:[1,0] neg_lo:[0,1] neg_hi:[0,1]
  v_cvt_pk_bf16_f32 v10, v10, v11
  v_accvgpr_write_b32 a22, v10
  v_lshlrev_b32 v6, 16, v75
  v_and_b32 v7, 0xffff0000, v75
  v_pk_add_f32 v[6:7], v[6:7], v[8:9] op_sel_hi:[1,0] neg_lo:[0,1] neg_hi:[0,1]
  v_cvt_pk_bf16_f32 v6, v6, v7
  v_accvgpr_write_b32 a23, v6
  v_lshlrev_b32 v10, 16, v76
  v_and_b32 v11, 0xffff0000, v76
  v_pk_add_f32 v[10:11], v[10:11], v[8:9] op_sel_hi:[1,0] neg_lo:[0,1] neg_hi:[0,1]
  v_cvt_pk_bf16_f32 v10, v10, v11
  v_accvgpr_write_b32 a36, v10
  v_lshlrev_b32 v6, 16, v77
  v_and_b32 v7, 0xffff0000, v77
  v_pk_add_f32 v[6:7], v[6:7], v[8:9] op_sel_hi:[1,0] neg_lo:[0,1] neg_hi:[0,1]
  v_cvt_pk_bf16_f32 v6, v6, v7
  v_accvgpr_write_b32 a37, v6
  v_lshlrev_b32 v10, 16, v78
  v_and_b32 v11, 0xffff0000, v78
  v_pk_add_f32 v[10:11], v[10:11], v[8:9] op_sel_hi:[1,0] neg_lo:[0,1] neg_hi:[0,1]
  v_cvt_pk_bf16_f32 v10, v10, v11
  v_accvgpr_write_b32 a38, v10
  v_lshlrev_b32 v6, 16, v79
  v_and_b32 v7, 0xffff0000, v79
  v_pk_add_f32 v[6:7], v[6:7], v[8:9] op_sel_hi:[1,0] neg_lo:[0,1] neg_hi:[0,1]
  v_cvt_pk_bf16_f32 v6, v6, v7
  v_accvgpr_write_b32 a39, v6
  v_lshlrev_b32 v10, 16, v80
  v_and_b32 v11, 0xffff0000, v80
  v_pk_add_f32 v[10:11], v[10:11], v[8:9] op_sel_hi:[1,0] neg_lo:[0,1] neg_hi:[0,1]
  v_cvt_pk_bf16_f32 v10, v10, v11
  v_accvgpr_write_b32 a52, v10
  v_lshlrev_b32 v6, 16, v81
  v_and_b32 v7, 0xffff0000, v81
  v_pk_add_f32 v[6:7], v[6:7], v[8:9] op_sel_hi:[1,0] neg_lo:[0,1] neg_hi:[0,1]
  v_cvt_pk_bf16_f32 v6, v6, v7
  v_accvgpr_write_b32 a53, v6
  v_lshlrev_b32 v10, 16, v82
  v_and_b32 v11, 0xffff0000, v82
  v_pk_add_f32 v[10:11], v[10:11], v[8:9] op_sel_hi:[1,0] neg_lo:[0,1] neg_hi:[0,1]
  v_cvt_pk_bf16_f32 v10, v10, v11
  v_accvgpr_write_b32 a54, v10
  v_lshlrev_b32 v6, 16, v83
  v_and_b32 v7, 0xffff0000, v83
  v_pk_add_f32 v[6:7], v[6:7], v[8:9] op_sel_hi:[1,0] neg_lo:[0,1] neg_hi:[0,1]
  v_cvt_pk_bf16_f32 v6, v6, v7
  v_accvgpr_write_b32 a55, v6
  v_lshlrev_b32 v10, 16, v84
  v_and_b32 v11, 0xffff0000, v84
  v_pk_add_f32 v[10:11], v[10:11], v[8:9] op_sel_hi:[1,0] neg_lo:[0,1] neg_hi:[0,1]
  v_cvt_pk_bf16_f32 v10, v10, v11
  v_accvgpr_write_b32 a68, v10
  v_lshlrev_b32 v6, 16, v85
  v_and_b32 v7, 0xffff0000, v85
  v_pk_add_f32 v[6:7], v[6:7], v[8:9] op_sel_hi:[1,0] neg_lo:[0,1] neg_hi:[0,1]
  v_cvt_pk_bf16_f32 v6, v6, v7
  v_accvgpr_write_b32 a69, v6
  v_lshlrev_b32 v10, 16, v86
  v_and_b32 v11, 0xffff0000, v86
  v_pk_add_f32 v[10:11], v[10:11], v[8:9] op_sel_hi:[1,0] neg_lo:[0,1] neg_hi:[0,1]
  v_cvt_pk_bf16_f32 v10, v10, v11
  v_accvgpr_write_b32 a70, v10
  v_lshlrev_b32 v6, 16, v87
  v_and_b32 v7, 0xffff0000, v87
  v_pk_add_f32 v[6:7], v[6:7], v[8:9] op_sel_hi:[1,0] neg_lo:[0,1] neg_hi:[0,1]
  v_cvt_pk_bf16_f32 v6, v6, v7
  v_accvgpr_write_b32 a71, v6
  v_lshlrev_b32 v10, 16, v88
  v_and_b32 v11, 0xffff0000, v88
  v_pk_add_f32 v[10:11], v[10:11], v[8:9] op_sel_hi:[1,0] neg_lo:[0,1] neg_hi:[0,1]
  v_cvt_pk_bf16_f32 v10, v10, v11
  v_accvgpr_write_b32 a84, v10
  v_lshlrev_b32 v6, 16, v89
  v_and_b32 v7, 0xffff0000, v89
  v_pk_add_f32 v[6:7], v[6:7], v[8:9] op_sel_hi:[1,0] neg_lo:[0,1] neg_hi:[0,1]
  v_cvt_pk_bf16_f32 v6, v6, v7
  v_accvgpr_write_b32 a85, v6
  v_lshlrev_b32 v10, 16, v90
  v_and_b32 v11, 0xffff0000, v90
  v_pk_add_f32 v[10:11], v[10:11], v[8:9] op_sel_hi:[1,0] neg_lo:[0,1] neg_hi:[0,1]
  v_cvt_pk_bf16_f32 v10, v10, v11
  v_accvgpr_write_b32 a86, v10
  v_lshlrev_b32 v6, 16, v91
  v_and_b32 v7, 0xffff0000, v91
  v_pk_add_f32 v[6:7], v[6:7], v[8:9] op_sel_hi:[1,0] neg_lo:[0,1] neg_hi:[0,1]
  v_cvt_pk_bf16_f32 v6, v6, v7
  v_accvgpr_write_b32 a87, v6
  v_lshlrev_b32 v10, 16, v92
  v_and_b32 v11, 0xffff0000, v92
  v_pk_add_f32 v[10:11], v[10:11], v[8:9] op_sel_hi:[1,0] neg_lo:[0,1] neg_hi:[0,1]
  v_cvt_pk_bf16_f32 v10, v10, v11
  v_accvgpr_write_b32 a100, v10
  v_lshlrev_b32 v6, 16, v93
  v_and_b32 v7, 0xffff0000, v93
  v_pk_add_f32 v[6:7], v[6:7], v[8:9] op_sel_hi:[1,0] neg_lo:[0,1] neg_hi:[0,1]
  v_cvt_pk_bf16_f32 v6, v6, v7
  v_accvgpr_write_b32 a101, v6
  v_lshlrev_b32 v10, 16, v94
  v_and_b32 v11, 0xffff0000, v94
  v_pk_add_f32 v[10:11], v[10:11], v[8:9] op_sel_hi:[1,0] neg_lo:[0,1] neg_hi:[0,1]
  v_cvt_pk_bf16_f32 v10, v10, v11
  v_accvgpr_write_b32 a102, v10
  v_lshlrev_b32 v6, 16, v95
  v_and_b32 v7, 0xffff0000, v95
  v_pk_add_f32 v[6:7], v[6:7], v[8:9] op_sel_hi:[1,0] neg_lo:[0,1] neg_hi:[0,1]
  v_cvt_pk_bf16_f32 v6, v6, v7
  v_accvgpr_write_b32 a103, v6
  v_lshlrev_b32 v10, 16, v96
  v_and_b32 v11, 0xffff0000, v96
  v_pk_add_f32 v[10:11], v[10:11], v[8:9] op_sel_hi:[1,0] neg_lo:[0,1] neg_hi:[0,1]
  v_cvt_pk_bf16_f32 v10, v10, v11
  v_accvgpr_write_b32 a116, v10
  v_lshlrev_b32 v6, 16, v97
  v_and_b32 v7, 0xffff0000, v97
  v_pk_add_f32 v[6:7], v[6:7], v[8:9] op_sel_hi:[1,0] neg_lo:[0,1] neg_hi:[0,1]
  v_cvt_pk_bf16_f32 v6, v6, v7
  v_accvgpr_write_b32 a117, v6
  v_lshlrev_b32 v10, 16, v98
  v_and_b32 v11, 0xffff0000, v98
  v_pk_add_f32 v[10:11], v[10:11], v[8:9] op_sel_hi:[1,0] neg_lo:[0,1] neg_hi:[0,1]
  v_cvt_pk_bf16_f32 v10, v10, v11
  v_accvgpr_write_b32 a118, v10
  v_lshlrev_b32 v6, 16, v99
  v_and_b32 v7, 0xffff0000, v99
  v_pk_add_f32 v[6:7], v[6:7], v[8:9] op_sel_hi:[1,0] neg_lo:[0,1] neg_hi:[0,1]
  v_cvt_pk_bf16_f32 v6, v6, v7
  v_accvgpr_write_b32 a119, v6
  v_lshlrev_b32 v10, 16, v100
  v_and_b32 v11, 0xffff0000, v100
  v_pk_add_f32 v[10:11], v[10:11], v[8:9] op_sel_hi:[1,0] neg_lo:[0,1] neg_hi:[0,1]
  v_cvt_pk_bf16_f32 v10, v10, v11
  v_accvgpr_write_b32 a132, v10
  v_lshlrev_b32 v6, 16, v101
  v_and_b32 v7, 0xffff0000, v101
  v_pk_add_f32 v[6:7], v[6:7], v[8:9] op_sel_hi:[1,0] neg_lo:[0,1] neg_hi:[0,1]
  v_cvt_pk_bf16_f32 v6, v6, v7
  v_accvgpr_write_b32 a133, v6
  v_lshlrev_b32 v10, 16, v102
  v_and_b32 v11, 0xffff0000, v102
  v_pk_add_f32 v[10:11], v[10:11], v[8:9] op_sel_hi:[1,0] neg_lo:[0,1] neg_hi:[0,1]
  v_cvt_pk_bf16_f32 v10, v10, v11
  v_accvgpr_write_b32 a134, v10
  v_lshlrev_b32 v6, 16, v103
  v_and_b32 v7, 0xffff0000, v103
  v_pk_add_f32 v[6:7], v[6:7], v[8:9] op_sel_hi:[1,0] neg_lo:[0,1] neg_hi:[0,1]
  v_cvt_pk_bf16_f32 v6, v6, v7
  v_accvgpr_write_b32 a135, v6
  v_lshlrev_b32 v10, 16, v104
  v_and_b32 v11, 0xffff0000, v104
  v_pk_add_f32 v[10:11], v[10:11], v[8:9] op_sel_hi:[1,0] neg_lo:[0,1] neg_hi:[0,1]
  v_cvt_pk_bf16_f32 v10, v10, v11
  v_accvgpr_write_b32 a148, v10
  v_lshlrev_b32 v6, 16, v105
  v_and_b32 v7, 0xffff0000, v105
  v_pk_add_f32 v[6:7], v[6:7], v[8:9] op_sel_hi:[1,0] neg_lo:[0,1] neg_hi:[0,1]
  v_cvt_pk_bf16_f32 v6, v6, v7
  v_accvgpr_write_b32 a149, v6
  v_lshlrev_b32 v10, 16, v106
  v_and_b32 v11, 0xffff0000, v106
  v_pk_add_f32 v[10:11], v[10:11], v[8:9] op_sel_hi:[1,0] neg_lo:[0,1] neg_hi:[0,1]
  v_cvt_pk_bf16_f32 v10, v10, v11
  v_accvgpr_write_b32 a150, v10
  v_lshlrev_b32 v6, 16, v107
  v_and_b32 v7, 0xffff0000, v107
  v_pk_add_f32 v[6:7], v[6:7], v[8:9] op_sel_hi:[1,0] neg_lo:[0,1] neg_hi:[0,1]
  v_cvt_pk_bf16_f32 v6, v6, v7
  v_accvgpr_write_b32 a151, v6
  v_lshlrev_b32 v10, 16, v108
  v_and_b32 v11, 0xffff0000, v108
  v_pk_add_f32 v[10:11], v[10:11], v[8:9] op_sel_hi:[1,0] neg_lo:[0,1] neg_hi:[0,1]
  v_cvt_pk_bf16_f32 v10, v10, v11
  v_accvgpr_write_b32 a164, v10
  v_lshlrev_b32 v6, 16, v109
  v_and_b32 v7, 0xffff0000, v109
  v_pk_add_f32 v[6:7], v[6:7], v[8:9] op_sel_hi:[1,0] neg_lo:[0,1] neg_hi:[0,1]
  v_cvt_pk_bf16_f32 v6, v6, v7
  v_accvgpr_write_b32 a165, v6
  v_lshlrev_b32 v10, 16, v110
  v_and_b32 v11, 0xffff0000, v110
  v_pk_add_f32 v[10:11], v[10:11], v[8:9] op_sel_hi:[1,0] neg_lo:[0,1] neg_hi:[0,1]
  v_cvt_pk_bf16_f32 v10, v10, v11
  v_accvgpr_write_b32 a166, v10
  v_lshlrev_b32 v6, 16, v111
  v_and_b32 v7, 0xffff0000, v111
  v_pk_add_f32 v[6:7], v[6:7], v[8:9] op_sel_hi:[1,0] neg_lo:[0,1] neg_hi:[0,1]
  v_cvt_pk_bf16_f32 v6, v6, v7
  v_accvgpr_write_b32 a167, v6
  v_lshlrev_b32 v10, 16, v112
  v_and_b32 v11, 0xffff0000, v112
  v_pk_add_f32 v[10:11], v[10:11], v[8:9] op_sel_hi:[1,0] neg_lo:[0,1] neg_hi:[0,1]
  v_cvt_pk_bf16_f32 v10, v10, v11
  v_accvgpr_write_b32 a180, v10
  v_lshlrev_b32 v6, 16, v113
  v_and_b32 v7, 0xffff0000, v113
  v_pk_add_f32 v[6:7], v[6:7], v[8:9] op_sel_hi:[1,0] neg_lo:[0,1] neg_hi:[0,1]
  v_cvt_pk_bf16_f32 v6, v6, v7
  v_accvgpr_write_b32 a181, v6
  v_lshlrev_b32 v10, 16, v114
  v_and_b32 v11, 0xffff0000, v114
  v_pk_add_f32 v[10:11], v[10:11], v[8:9] op_sel_hi:[1,0] neg_lo:[0,1] neg_hi:[0,1]
  v_cvt_pk_bf16_f32 v10, v10, v11
  v_accvgpr_write_b32 a182, v10
  v_lshlrev_b32 v6, 16, v115
  v_and_b32 v7, 0xffff0000, v115
  v_pk_add_f32 v[6:7], v[6:7], v[8:9] op_sel_hi:[1,0] neg_lo:[0,1] neg_hi:[0,1]
  v_cvt_pk_bf16_f32 v6, v6, v7
  v_accvgpr_write_b32 a183, v6
  v_lshlrev_b32 v10, 16, v116
  v_and_b32 v11, 0xffff0000, v116
  v_pk_add_f32 v[10:11], v[10:11], v[8:9] op_sel_hi:[1,0] neg_lo:[0,1] neg_hi:[0,1]
  v_cvt_pk_bf16_f32 v10, v10, v11
  v_accvgpr_write_b32 a196, v10
  v_lshlrev_b32 v6, 16, v117
  v_and_b32 v7, 0xffff0000, v117
  v_pk_add_f32 v[6:7], v[6:7], v[8:9] op_sel_hi:[1,0] neg_lo:[0,1] neg_hi:[0,1]
  v_cvt_pk_bf16_f32 v6, v6, v7
  v_accvgpr_write_b32 a197, v6
  v_lshlrev_b32 v10, 16, v118
  v_and_b32 v11, 0xffff0000, v118
  v_pk_add_f32 v[10:11], v[10:11], v[8:9] op_sel_hi:[1,0] neg_lo:[0,1] neg_hi:[0,1]
  v_cvt_pk_bf16_f32 v10, v10, v11
  v_accvgpr_write_b32 a198, v10
  v_lshlrev_b32 v6, 16, v119
  v_and_b32 v7, 0xffff0000, v119
  v_pk_add_f32 v[6:7], v[6:7], v[8:9] op_sel_hi:[1,0] neg_lo:[0,1] neg_hi:[0,1]
  v_cvt_pk_bf16_f32 v6, v6, v7
  v_accvgpr_write_b32 a199, v6
  v_lshlrev_b32 v10, 16, v248
  v_and_b32 v11, 0xffff0000, v248
  v_pk_add_f32 v[10:11], v[10:11], v[8:9] op_sel_hi:[1,0] neg_lo:[0,1] neg_hi:[0,1]
  v_cvt_pk_bf16_f32 v10, v10, v11
  v_accvgpr_write_b32 a212, v10
  v_lshlrev_b32 v6, 16, v249
  v_and_b32 v7, 0xffff0000, v249
  v_pk_add_f32 v[6:7], v[6:7], v[8:9] op_sel_hi:[1,0] neg_lo:[0,1] neg_hi:[0,1]
  v_cvt_pk_bf16_f32 v6, v6, v7
  v_accvgpr_write_b32 a213, v6
  v_lshlrev_b32 v10, 16, v250
  v_and_b32 v11, 0xffff0000, v250
  v_pk_add_f32 v[10:11], v[10:11], v[8:9] op_sel_hi:[1,0] neg_lo:[0,1] neg_hi:[0,1]
  v_cvt_pk_bf16_f32 v10, v10, v11
  v_accvgpr_write_b32 a214, v10
  v_lshlrev_b32 v6, 16, v251
  v_and_b32 v7, 0xffff0000, v251
  v_pk_add_f32 v[6:7], v[6:7], v[8:9] op_sel_hi:[1,0] neg_lo:[0,1] neg_hi:[0,1]
  v_cvt_pk_bf16_f32 v6, v6, v7
  v_accvgpr_write_b32 a215, v6
  s_add_u32 s22, s20, 3072
  buffer_load_dwordx4 v[68:71], v2, s[12:15], s22 offen
  s_add_u32 s22, s22, 4096
  buffer_load_dwordx4 v[72:75], v2, s[12:15], s22 offen
  s_add_u32 s22, s22, 4096
  buffer_load_dwordx4 v[76:79], v2, s[12:15], s22 offen
  s_add_u32 s22, s22, 4096
  buffer_load_dwordx4 v[80:83], v2, s[12:15], s22 offen
  s_add_u32 s22, s22, 4096
  buffer_load_dwordx4 v[84:87], v2, s[12:15], s22 offen
  s_add_u32 s22, s22, 4096
  buffer_load_dwordx4 v[88:91], v2, s[12:15], s22 offen
  s_add_u32 s22, s22, 4096
  buffer_load_dwordx4 v[92:95], v2, s[12:15], s22 offen
  s_add_u32 s22, s22, 4096
  buffer_load_dwordx4 v[96:99], v2, s[12:15], s22 offen
  s_add_u32 s22, s22, 4096
  buffer_load_dwordx4 v[100:103], v2, s[12:15], s22 offen
  s_add_u32 s22, s22, 4096
  buffer_load_dwordx4 v[104:107], v2, s[12:15], s22 offen
  s_add_u32 s22, s22, 4096
  buffer_load_dwordx4 v[108:111], v2, s[12:15], s22 offen
  s_add_u32 s22, s22, 4096
  buffer_load_dwordx4 v[112:115], v2, s[12:15], s22 offen
  s_add_u32 s22, s22, 4096
  buffer_load_dwordx4 v[116:119], v2, s[12:15], s22 offen
  s_add_u32 s22, s22, 4096
  buffer_load_dwordx4 v[248:251], v2, s[12:15], s22 offen
  s_add_u32 s22, s22, 4096
  s_add_u32 s22, s20, 57344
  buffer_load_dwordx4 a[224:227], v2, s[12:15], s22 offen
  s_add_u32 s22, s20, 58368
  buffer_load_dwordx4 a[228:231], v2, s[12:15], s22 offen
  s_add_u32 s22, s20, 59392
  buffer_load_dwordx4 a[232:235], v2, s[12:15], s22 offen
  s_add_u32 s22, s20, 60416
  buffer_load_dwordx4 a[236:239], v2, s[12:15], s22 offen
  s_add_u32 s22, s20, 61440
  buffer_load_dwordx4 a[240:243], v2, s[12:15], s22 offen
  s_add_u32 s22, s20, 62464
  buffer_load_dwordx4 a[244:247], v2, s[12:15], s22 offen
  s_add_u32 s22, s20, 63488
  buffer_load_dwordx4 a[248:251], v2, s[12:15], s22 offen
  s_add_u32 s22, s20, 64512
  buffer_load_dwordx4 a[252:255], v2, s[12:15], s22 offen
  s_add_u32 s22, s20, 65536
  buffer_load_dwordx4 v[120:123], v2, s[12:15], s22 offen
  s_add_u32 s22, s20, 66560
  buffer_load_dwordx4 v[124:127], v2, s[12:15], s22 offen
  s_add_u32 s22, s20, 67584
  buffer_load_dwordx4 v[128:131], v2, s[12:15], s22 offen
  s_add_u32 s22, s20, 68608
  buffer_load_dwordx4 v[132:135], v2, s[12:15], s22 offen
  s_add_u32 s22, s20, 69632
  buffer_load_dwordx4 v[136:139], v2, s[12:15], s22 offen
  s_add_u32 s22, s20, 70656
  buffer_load_dwordx4 v[140:143], v2, s[12:15], s22 offen
  s_add_u32 s22, s20, 71680
  buffer_load_dwordx4 v[144:147], v2, s[12:15], s22 offen
  s_add_u32 s22, s20, 72704
  buffer_load_dwordx4 v[148:151], v2, s[12:15], s22 offen
  s_add_u32 s22, s20, 73728
  buffer_load_dwordx4 v[152:155], v2, s[12:15], s22 offen
  s_add_u32 s22, s20, 74752
  buffer_load_dwordx4 v[156:159], v2, s[12:15], s22 offen
  s_add_u32 s22, s20, 75776
  buffer_load_dwordx4 v[160:163], v2, s[12:15], s22 offen
  s_add_u32 s22, s20, 76800
  buffer_load_dwordx4 v[164:167], v2, s[12:15], s22 offen
  s_add_u32 s22, s20, 77824
  buffer_load_dwordx4 v[168:171], v2, s[12:15], s22 offen
  s_add_u32 s22, s20, 78848
  buffer_load_dwordx4 v[172:175], v2, s[12:15], s22 offen
  s_add_u32 s22, s20, 79872
  buffer_load_dwordx4 v[176:179], v2, s[12:15], s22 offen
  s_add_u32 s22, s20, 80896
  buffer_load_dwordx4 v[180:183], v2, s[12:15], s22 offen
  s_add_u32 s22, s20, 81920
  buffer_load_dwordx4 v[184:187], v2, s[12:15], s22 offen
  s_add_u32 s22, s20, 82944
  buffer_load_dwordx4 v[188:191], v2, s[12:15], s22 offen
  s_add_u32 s22, s20, 83968
  buffer_load_dwordx4 v[192:195], v2, s[12:15], s22 offen
  s_add_u32 s22, s20, 84992
  buffer_load_dwordx4 v[196:199], v2, s[12:15], s22 offen
  s_add_u32 s22, s20, 86016
  buffer_load_dwordx4 v[200:203], v2, s[12:15], s22 offen
  s_add_u32 s22, s20, 87040
  buffer_load_dwordx4 v[204:207], v2, s[12:15], s22 offen
  s_add_u32 s22, s20, 88064
  buffer_load_dwordx4 v[208:211], v2, s[12:15], s22 offen
  s_add_u32 s22, s20, 89088
  buffer_load_dwordx4 v[212:215], v2, s[12:15], s22 offen
  s_add_u32 s22, s20, 90112
  buffer_load_dwordx4 v[216:219], v2, s[12:15], s22 offen
  s_add_u32 s22, s20, 91136
  buffer_load_dwordx4 v[220:223], v2, s[12:15], s22 offen
  s_add_u32 s22, s20, 92160
  buffer_load_dwordx4 v[224:227], v2, s[12:15], s22 offen
  s_add_u32 s22, s20, 93184
  buffer_load_dwordx4 v[228:231], v2, s[12:15], s22 offen
  s_add_u32 s22, s20, 94208
  buffer_load_dwordx4 v[232:235], v2, s[12:15], s22 offen
  s_add_u32 s22, s20, 95232
  buffer_load_dwordx4 v[236:239], v2, s[12:15], s22 offen
  s_add_u32 s22, s20, 96256
  buffer_load_dwordx4 v[240:243], v2, s[12:15], s22 offen
  s_add_u32 s22, s20, 97280
  buffer_load_dwordx4 v[244:247], v2, s[12:15], s22 offen
  s_add_u32 s22, s20, 99328
  buffer_load_dwordx4 v[252:255], v2, s[12:15], s22 offen
  s_add_u32 s22, s20, 100352
  s_add_u32 m0, s35, 0
  s_nop 0
  buffer_load_dwordx4 v2, s[12:15], s22 offen lds
  s_add_u32 s22, s20, 101376
  s_add_u32 m0, s35, 1024
  s_nop 0
  buffer_load_dwordx4 v2, s[12:15], s22 offen lds
  s_add_u32 s22, s20, 102400
  s_add_u32 m0, s35, 2048
  s_nop 0
  buffer_load_dwordx4 v2, s[12:15], s22 offen lds
  s_add_u32 s22, s20, 103424
  s_add_u32 m0, s35, 3072
  s_nop 0
  buffer_load_dwordx4 v2, s[12:15], s22 offen lds
  s_add_u32 s22, s20, 104448
  s_add_u32 m0, s35, 4096
  s_nop 0
  buffer_load_dwordx4 v2, s[12:15], s22 offen lds
  s_add_u32 s22, s20, 105472
  s_add_u32 m0, s35, 5120
  s_nop 0
  buffer_load_dwordx4 v2, s[12:15], s22 offen lds
  s_add_u32 s22, s20, 106496
  s_add_u32 m0, s35, 6144
  s_nop 0
  buffer_load_dwordx4 v2, s[12:15], s22 offen lds
  s_add_u32 s22, s20, 107520
  s_add_u32 m0, s35, 7168
  s_nop 0
  buffer_load_dwordx4 v2, s[12:15], s22 offen lds
  s_add_u32 s22, s20, 108544
  s_add_u32 m0, s35, 8192
  s_nop 0
  buffer_load_dwordx4 v2, s[12:15], s22 offen lds
  s_add_u32 s22, s20, 109568
  s_add_u32 m0, s35, 9216
  s_nop 0
  buffer_load_dwordx4 v2, s[12:15], s22 offen lds
  s_add_u32 s22, s20, 110592
  s_add_u32 m0, s35, 10240
  s_nop 0
  buffer_load_dwordx4 v2, s[12:15], s22 offen lds
  s_add_u32 s22, s20, 111616
  s_add_u32 m0, s35, 11264
  s_nop 0
  buffer_load_dwordx4 v2, s[12:15], s22 offen lds
  s_add_u32 s22, s20, 112640
  s_add_u32 m0, s35, 12288
  s_nop 0
  buffer_load_dwordx4 v2, s[12:15], s22 offen lds
  s_add_u32 s22, s20, 113664
  s_add_u32 m0, s35, 13312
  s_nop 0
  buffer_load_dwordx4 v2, s[12:15], s22 offen lds
  s_waitcnt vmcnt(63)
  v_mov_b32 v8, 0
  v_mov_b32 v9, 0
  v_dot2_f32_bf16 v8, v12, s52, v8
  v_dot2_f32_bf16 v9, v13, s52, v9
  v_dot2_f32_bf16 v8, v14, s52, v8
  v_dot2_f32_bf16 v9, v15, s52, v9
  v_dot2_f32_bf16 v8, v16, s52, v8
  v_dot2_f32_bf16 v9, v17, s52, v9
  v_dot2_f32_bf16 v8, v18, s52, v8
  v_dot2_f32_bf16 v9, v19, s52, v9
  v_dot2_f32_bf16 v8, v20, s52, v8
  v_dot2_f32_bf16 v9, v21, s52, v9
  v_dot2_f32_bf16 v8, v22, s52, v8
  v_dot2_f32_bf16 v9, v23, s52, v9
  v_dot2_f32_bf16 v8, v24, s52, v8
  v_dot2_f32_bf16 v9, v25, s52, v9
  v_dot2_f32_bf16 v8, v26, s52, v8
  v_dot2_f32_bf16 v9, v27, s52, v9
  v_dot2_f32_bf16 v8, v28, s52, v8
  v_dot2_f32_bf16 v9, v29, s52, v9
  v_dot2_f32_bf16 v8, v30, s52, v8
  v_dot2_f32_bf16 v9, v31, s52, v9
  v_dot2_f32_bf16 v8, v32, s52, v8
  v_dot2_f32_bf16 v9, v33, s52, v9
  v_dot2_f32_bf16 v8, v34, s52, v8
  v_dot2_f32_bf16 v9, v35, s52, v9
  v_dot2_f32_bf16 v8, v36, s52, v8
  v_dot2_f32_bf16 v9, v37, s52, v9
  v_dot2_f32_bf16 v8, v38, s52, v8
  v_dot2_f32_bf16 v9, v39, s52, v9
  v_dot2_f32_bf16 v8, v40, s52, v8
  v_dot2_f32_bf16 v9, v41, s52, v9
  v_dot2_f32_bf16 v8, v42, s52, v8
  v_dot2_f32_bf16 v9, v43, s52, v9
  v_dot2_f32_bf16 v8, v44, s52, v8
  v_dot2_f32_bf16 v9, v45, s52, v9
  v_dot2_f32_bf16 v8, v46, s52, v8
  v_dot2_f32_bf16 v9, v47, s52, v9
  v_dot2_f32_bf16 v8, v48, s52, v8
  v_dot2_f32_bf16 v9, v49, s52, v9
  v_dot2_f32_bf16 v8, v50, s52, v8
  v_dot2_f32_bf16 v9, v51, s52, v9
  v_dot2_f32_bf16 v8, v52, s52, v8
  v_dot2_f32_bf16 v9, v53, s52, v9
  v_dot2_f32_bf16 v8, v54, s52, v8
  v_dot2_f32_bf16 v9, v55, s52, v9
  v_dot2_f32_bf16 v8, v56, s52, v8
  v_dot2_f32_bf16 v9, v57, s52, v9
  v_dot2_f32_bf16 v8, v58, s52, v8
  v_dot2_f32_bf16 v9, v59, s52, v9
  v_dot2_f32_bf16 v8, v60, s52, v8
  v_dot2_f32_bf16 v9, v61, s52, v9
  v_dot2_f32_bf16 v8, v62, s52, v8
  v_dot2_f32_bf16 v9, v63, s52, v9
  v_dot2_f32_bf16 v8, v64, s52, v8
  v_dot2_f32_bf16 v9, v65, s52, v9
  v_dot2_f32_bf16 v8, v66, s52, v8
  v_dot2_f32_bf16 v9, v67, s52, v9
  s_nop 2
  v_add_f32 v8, v8, v9
  v_mov_b32 v9, v8
  s_nop 1
  v_permlane16_swap_b32 v8, v9
  v_add_f32 v8, v8, v9
  v_mov_b32 v9, v8
  s_nop 1
  v_permlane32_swap_b32 v8, v9
  v_add_f32 v8, v8, v9
  v_mul_f32 v8, 0x3b124925, v8
  v_lshlrev_b32 v10, 16, v12
  v_and_b32 v11, 0xffff0000, v12
  v_pk_add_f32 v[10:11], v[10:11], v[8:9] op_sel_hi:[1,0] neg_lo:[0,1] neg_hi:[0,1]
  v_cvt_pk_bf16_f32 v10, v10, v11
  v_accvgpr_write_b32 a8, v10
  v_lshlrev_b32 v6, 16, v13
  v_and_b32 v7, 0xffff0000, v13
  v_pk_add_f32 v[6:7], v[6:7], v[8:9] op_sel_hi:[1,0] neg_lo:[0,1] neg_hi:[0,1]
  v_cvt_pk_bf16_f32 v6, v6, v7
  v_accvgpr_write_b32 a9, v6
  v_lshlrev_b32 v10, 16, v14
  v_and_b32 v11, 0xffff0000, v14
  v_pk_add_f32 v[10:11], v[10:11], v[8:9] op_sel_hi:[1,0] neg_lo:[0,1] neg_hi:[0,1]
  v_cvt_pk_bf16_f32 v10, v10, v11
  v_accvgpr_write_b32 a10, v10
  v_lshlrev_b32 v6, 16, v15
  v_and_b32 v7, 0xffff0000, v15
  v_pk_add_f32 v[6:7], v[6:7], v[8:9] op_sel_hi:[1,0] neg_lo:[0,1] neg_hi:[0,1]
  v_cvt_pk_bf16_f32 v6, v6, v7
  v_accvgpr_write_b32 a11, v6
  v_lshlrev_b32 v10, 16, v16
  v_and_b32 v11, 0xffff0000, v16
  v_pk_add_f32 v[10:11], v[10:11], v[8:9] op_sel_hi:[1,0] neg_lo:[0,1] neg_hi:[0,1]
  v_cvt_pk_bf16_f32 v10, v10, v11
  v_accvgpr_write_b32 a24, v10
  v_lshlrev_b32 v6, 16, v17
  v_and_b32 v7, 0xffff0000, v17
  v_pk_add_f32 v[6:7], v[6:7], v[8:9] op_sel_hi:[1,0] neg_lo:[0,1] neg_hi:[0,1]
  v_cvt_pk_bf16_f32 v6, v6, v7
  v_accvgpr_write_b32 a25, v6
  v_lshlrev_b32 v10, 16, v18
  v_and_b32 v11, 0xffff0000, v18
  v_pk_add_f32 v[10:11], v[10:11], v[8:9] op_sel_hi:[1,0] neg_lo:[0,1] neg_hi:[0,1]
  v_cvt_pk_bf16_f32 v10, v10, v11
  v_accvgpr_write_b32 a26, v10
  v_lshlrev_b32 v6, 16, v19
  v_and_b32 v7, 0xffff0000, v19
  v_pk_add_f32 v[6:7], v[6:7], v[8:9] op_sel_hi:[1,0] neg_lo:[0,1] neg_hi:[0,1]
  v_cvt_pk_bf16_f32 v6, v6, v7
  v_accvgpr_write_b32 a27, v6
  v_lshlrev_b32 v10, 16, v20
  v_and_b32 v11, 0xffff0000, v20
  v_pk_add_f32 v[10:11], v[10:11], v[8:9] op_sel_hi:[1,0] neg_lo:[0,1] neg_hi:[0,1]
  v_cvt_pk_bf16_f32 v10, v10, v11
  v_accvgpr_write_b32 a40, v10
  v_lshlrev_b32 v6, 16, v21
  v_and_b32 v7, 0xffff0000, v21
  v_pk_add_f32 v[6:7], v[6:7], v[8:9] op_sel_hi:[1,0] neg_lo:[0,1] neg_hi:[0,1]
  v_cvt_pk_bf16_f32 v6, v6, v7
  v_accvgpr_write_b32 a41, v6
  v_lshlrev_b32 v10, 16, v22
  v_and_b32 v11, 0xffff0000, v22
  v_pk_add_f32 v[10:11], v[10:11], v[8:9] op_sel_hi:[1,0] neg_lo:[0,1] neg_hi:[0,1]
  v_cvt_pk_bf16_f32 v10, v10, v11
  v_accvgpr_write_b32 a42, v10
  v_lshlrev_b32 v6, 16, v23
  v_and_b32 v7, 0xffff0000, v23
  v_pk_add_f32 v[6:7], v[6:7], v[8:9] op_sel_hi:[1,0] neg_lo:[0,1] neg_hi:[0,1]
  v_cvt_pk_bf16_f32 v6, v6, v7
  v_accvgpr_write_b32 a43, v6
  v_lshlrev_b32 v10, 16, v24
  v_and_b32 v11, 0xffff0000, v24
  v_pk_add_f32 v[10:11], v[10:11], v[8:9] op_sel_hi:[1,0] neg_lo:[0,1] neg_hi:[0,1]
  v_cvt_pk_bf16_f32 v10, v10, v11
  v_accvgpr_write_b32 a56, v10
  v_lshlrev_b32 v6, 16, v25
  v_and_b32 v7, 0xffff0000, v25
  v_pk_add_f32 v[6:7], v[6:7], v[8:9] op_sel_hi:[1,0] neg_lo:[0,1] neg_hi:[0,1]
  v_cvt_pk_bf16_f32 v6, v6, v7
  v_accvgpr_write_b32 a57, v6
  v_lshlrev_b32 v10, 16, v26
  v_and_b32 v11, 0xffff0000, v26
  v_pk_add_f32 v[10:11], v[10:11], v[8:9] op_sel_hi:[1,0] neg_lo:[0,1] neg_hi:[0,1]
  v_cvt_pk_bf16_f32 v10, v10, v11
  v_accvgpr_write_b32 a58, v10
  v_lshlrev_b32 v6, 16, v27
  v_and_b32 v7, 0xffff0000, v27
  v_pk_add_f32 v[6:7], v[6:7], v[8:9] op_sel_hi:[1,0] neg_lo:[0,1] neg_hi:[0,1]
  v_cvt_pk_bf16_f32 v6, v6, v7
  v_accvgpr_write_b32 a59, v6
  v_lshlrev_b32 v10, 16, v28
  v_and_b32 v11, 0xffff0000, v28
  v_pk_add_f32 v[10:11], v[10:11], v[8:9] op_sel_hi:[1,0] neg_lo:[0,1] neg_hi:[0,1]
  v_cvt_pk_bf16_f32 v10, v10, v11
  v_accvgpr_write_b32 a72, v10
  v_lshlrev_b32 v6, 16, v29
  v_and_b32 v7, 0xffff0000, v29
  v_pk_add_f32 v[6:7], v[6:7], v[8:9] op_sel_hi:[1,0] neg_lo:[0,1] neg_hi:[0,1]
  v_cvt_pk_bf16_f32 v6, v6, v7
  v_accvgpr_write_b32 a73, v6
  v_lshlrev_b32 v10, 16, v30
  v_and_b32 v11, 0xffff0000, v30
  v_pk_add_f32 v[10:11], v[10:11], v[8:9] op_sel_hi:[1,0] neg_lo:[0,1] neg_hi:[0,1]
  v_cvt_pk_bf16_f32 v10, v10, v11
  v_accvgpr_write_b32 a74, v10
  v_lshlrev_b32 v6, 16, v31
  v_and_b32 v7, 0xffff0000, v31
  v_pk_add_f32 v[6:7], v[6:7], v[8:9] op_sel_hi:[1,0] neg_lo:[0,1] neg_hi:[0,1]
  v_cvt_pk_bf16_f32 v6, v6, v7
  v_accvgpr_write_b32 a75, v6
  v_lshlrev_b32 v10, 16, v32
  v_and_b32 v11, 0xffff0000, v32
  v_pk_add_f32 v[10:11], v[10:11], v[8:9] op_sel_hi:[1,0] neg_lo:[0,1] neg_hi:[0,1]
  v_cvt_pk_bf16_f32 v10, v10, v11
  v_accvgpr_write_b32 a88, v10
  v_lshlrev_b32 v6, 16, v33
  v_and_b32 v7, 0xffff0000, v33
  v_pk_add_f32 v[6:7], v[6:7], v[8:9] op_sel_hi:[1,0] neg_lo:[0,1] neg_hi:[0,1]
  v_cvt_pk_bf16_f32 v6, v6, v7
  v_accvgpr_write_b32 a89, v6
  v_lshlrev_b32 v10, 16, v34
  v_and_b32 v11, 0xffff0000, v34
  v_pk_add_f32 v[10:11], v[10:11], v[8:9] op_sel_hi:[1,0] neg_lo:[0,1] neg_hi:[0,1]
  v_cvt_pk_bf16_f32 v10, v10, v11
  v_accvgpr_write_b32 a90, v10
  v_lshlrev_b32 v6, 16, v35
  v_and_b32 v7, 0xffff0000, v35
  v_pk_add_f32 v[6:7], v[6:7], v[8:9] op_sel_hi:[1,0] neg_lo:[0,1] neg_hi:[0,1]
  v_cvt_pk_bf16_f32 v6, v6, v7
  v_accvgpr_write_b32 a91, v6
  v_lshlrev_b32 v10, 16, v36
  v_and_b32 v11, 0xffff0000, v36
  v_pk_add_f32 v[10:11], v[10:11], v[8:9] op_sel_hi:[1,0] neg_lo:[0,1] neg_hi:[0,1]
  v_cvt_pk_bf16_f32 v10, v10, v11
  v_accvgpr_write_b32 a104, v10
  v_lshlrev_b32 v6, 16, v37
  v_and_b32 v7, 0xffff0000, v37
  v_pk_add_f32 v[6:7], v[6:7], v[8:9] op_sel_hi:[1,0] neg_lo:[0,1] neg_hi:[0,1]
  v_cvt_pk_bf16_f32 v6, v6, v7
  v_accvgpr_write_b32 a105, v6
  v_lshlrev_b32 v10, 16, v38
  v_and_b32 v11, 0xffff0000, v38
  v_pk_add_f32 v[10:11], v[10:11], v[8:9] op_sel_hi:[1,0] neg_lo:[0,1] neg_hi:[0,1]
  v_cvt_pk_bf16_f32 v10, v10, v11
  v_accvgpr_write_b32 a106, v10
  v_lshlrev_b32 v6, 16, v39
  v_and_b32 v7, 0xffff0000, v39
  v_pk_add_f32 v[6:7], v[6:7], v[8:9] op_sel_hi:[1,0] neg_lo:[0,1] neg_hi:[0,1]
  v_cvt_pk_bf16_f32 v6, v6, v7
  v_accvgpr_write_b32 a107, v6
  v_lshlrev_b32 v10, 16, v40
  v_and_b32 v11, 0xffff0000, v40
  v_pk_add_f32 v[10:11], v[10:11], v[8:9] op_sel_hi:[1,0] neg_lo:[0,1] neg_hi:[0,1]
  v_cvt_pk_bf16_f32 v10, v10, v11
  v_accvgpr_write_b32 a120, v10
  v_lshlrev_b32 v6, 16, v41
  v_and_b32 v7, 0xffff0000, v41
  v_pk_add_f32 v[6:7], v[6:7], v[8:9] op_sel_hi:[1,0] neg_lo:[0,1] neg_hi:[0,1]
  v_cvt_pk_bf16_f32 v6, v6, v7
  v_accvgpr_write_b32 a121, v6
  v_lshlrev_b32 v10, 16, v42
  v_and_b32 v11, 0xffff0000, v42
  v_pk_add_f32 v[10:11], v[10:11], v[8:9] op_sel_hi:[1,0] neg_lo:[0,1] neg_hi:[0,1]
  v_cvt_pk_bf16_f32 v10, v10, v11
  v_accvgpr_write_b32 a122, v10
  v_lshlrev_b32 v6, 16, v43
  v_and_b32 v7, 0xffff0000, v43
  v_pk_add_f32 v[6:7], v[6:7], v[8:9] op_sel_hi:[1,0] neg_lo:[0,1] neg_hi:[0,1]
  v_cvt_pk_bf16_f32 v6, v6, v7
  v_accvgpr_write_b32 a123, v6
  v_lshlrev_b32 v10, 16, v44
  v_and_b32 v11, 0xffff0000, v44
  v_pk_add_f32 v[10:11], v[10:11], v[8:9] op_sel_hi:[1,0] neg_lo:[0,1] neg_hi:[0,1]
  v_cvt_pk_bf16_f32 v10, v10, v11
  v_accvgpr_write_b32 a136, v10
  v_lshlrev_b32 v6, 16, v45
  v_and_b32 v7, 0xffff0000, v45
  v_pk_add_f32 v[6:7], v[6:7], v[8:9] op_sel_hi:[1,0] neg_lo:[0,1] neg_hi:[0,1]
  v_cvt_pk_bf16_f32 v6, v6, v7
  v_accvgpr_write_b32 a137, v6
  v_lshlrev_b32 v10, 16, v46
  v_and_b32 v11, 0xffff0000, v46
  v_pk_add_f32 v[10:11], v[10:11], v[8:9] op_sel_hi:[1,0] neg_lo:[0,1] neg_hi:[0,1]
  v_cvt_pk_bf16_f32 v10, v10, v11
  v_accvgpr_write_b32 a138, v10
  v_lshlrev_b32 v6, 16, v47
  v_and_b32 v7, 0xffff0000, v47
  v_pk_add_f32 v[6:7], v[6:7], v[8:9] op_sel_hi:[1,0] neg_lo:[0,1] neg_hi:[0,1]
  v_cvt_pk_bf16_f32 v6, v6, v7
  v_accvgpr_write_b32 a139, v6
  v_lshlrev_b32 v10, 16, v48
  v_and_b32 v11, 0xffff0000, v48
  v_pk_add_f32 v[10:11], v[10:11], v[8:9] op_sel_hi:[1,0] neg_lo:[0,1] neg_hi:[0,1]
  v_cvt_pk_bf16_f32 v10, v10, v11
  v_accvgpr_write_b32 a152, v10
  v_lshlrev_b32 v6, 16, v49
  v_and_b32 v7, 0xffff0000, v49
  v_pk_add_f32 v[6:7], v[6:7], v[8:9] op_sel_hi:[1,0] neg_lo:[0,1] neg_hi:[0,1]
  v_cvt_pk_bf16_f32 v6, v6, v7
  v_accvgpr_write_b32 a153, v6
  v_lshlrev_b32 v10, 16, v50
  v_and_b32 v11, 0xffff0000, v50
  v_pk_add_f32 v[10:11], v[10:11], v[8:9] op_sel_hi:[1,0] neg_lo:[0,1] neg_hi:[0,1]
  v_cvt_pk_bf16_f32 v10, v10, v11
  v_accvgpr_write_b32 a154, v10
  v_lshlrev_b32 v6, 16, v51
  v_and_b32 v7, 0xffff0000, v51
  v_pk_add_f32 v[6:7], v[6:7], v[8:9] op_sel_hi:[1,0] neg_lo:[0,1] neg_hi:[0,1]
  v_cvt_pk_bf16_f32 v6, v6, v7
  v_accvgpr_write_b32 a155, v6
  v_lshlrev_b32 v10, 16, v52
  v_and_b32 v11, 0xffff0000, v52
  v_pk_add_f32 v[10:11], v[10:11], v[8:9] op_sel_hi:[1,0] neg_lo:[0,1] neg_hi:[0,1]
  v_cvt_pk_bf16_f32 v10, v10, v11
  v_accvgpr_write_b32 a168, v10
  v_lshlrev_b32 v6, 16, v53
  v_and_b32 v7, 0xffff0000, v53
  v_pk_add_f32 v[6:7], v[6:7], v[8:9] op_sel_hi:[1,0] neg_lo:[0,1] neg_hi:[0,1]
  v_cvt_pk_bf16_f32 v6, v6, v7
  v_accvgpr_write_b32 a169, v6
  v_lshlrev_b32 v10, 16, v54
  v_and_b32 v11, 0xffff0000, v54
  v_pk_add_f32 v[10:11], v[10:11], v[8:9] op_sel_hi:[1,0] neg_lo:[0,1] neg_hi:[0,1]
  v_cvt_pk_bf16_f32 v10, v10, v11
  v_accvgpr_write_b32 a170, v10
  v_lshlrev_b32 v6, 16, v55
  v_and_b32 v7, 0xffff0000, v55
  v_pk_add_f32 v[6:7], v[6:7], v[8:9] op_sel_hi:[1,0] neg_lo:[0,1] neg_hi:[0,1]
  v_cvt_pk_bf16_f32 v6, v6, v7
  v_accvgpr_write_b32 a171, v6
  v_lshlrev_b32 v10, 16, v56
  v_and_b32 v11, 0xffff0000, v56
  v_pk_add_f32 v[10:11], v[10:11], v[8:9] op_sel_hi:[1,0] neg_lo:[0,1] neg_hi:[0,1]
  v_cvt_pk_bf16_f32 v10, v10, v11
  v_accvgpr_write_b32 a184, v10
  v_lshlrev_b32 v6, 16, v57
  v_and_b32 v7, 0xffff0000, v57
  v_pk_add_f32 v[6:7], v[6:7], v[8:9] op_sel_hi:[1,0] neg_lo:[0,1] neg_hi:[0,1]
  v_cvt_pk_bf16_f32 v6, v6, v7
  v_accvgpr_write_b32 a185, v6
  v_lshlrev_b32 v10, 16, v58
  v_and_b32 v11, 0xffff0000, v58
  v_pk_add_f32 v[10:11], v[10:11], v[8:9] op_sel_hi:[1,0] neg_lo:[0,1] neg_hi:[0,1]
  v_cvt_pk_bf16_f32 v10, v10, v11
  v_accvgpr_write_b32 a186, v10
  v_lshlrev_b32 v6, 16, v59
  v_and_b32 v7, 0xffff0000, v59
  v_pk_add_f32 v[6:7], v[6:7], v[8:9] op_sel_hi:[1,0] neg_lo:[0,1] neg_hi:[0,1]
  v_cvt_pk_bf16_f32 v6, v6, v7
  v_accvgpr_write_b32 a187, v6
  v_lshlrev_b32 v10, 16, v60
  v_and_b32 v11, 0xffff0000, v60
  v_pk_add_f32 v[10:11], v[10:11], v[8:9] op_sel_hi:[1,0] neg_lo:[0,1] neg_hi:[0,1]
  v_cvt_pk_bf16_f32 v10, v10, v11
  v_accvgpr_write_b32 a200, v10
  v_lshlrev_b32 v6, 16, v61
  v_and_b32 v7, 0xffff0000, v61
  v_pk_add_f32 v[6:7], v[6:7], v[8:9] op_sel_hi:[1,0] neg_lo:[0,1] neg_hi:[0,1]
  v_cvt_pk_bf16_f32 v6, v6, v7
  v_accvgpr_write_b32 a201, v6
  v_lshlrev_b32 v10, 16, v62
  v_and_b32 v11, 0xffff0000, v62
  v_pk_add_f32 v[10:11], v[10:11], v[8:9] op_sel_hi:[1,0] neg_lo:[0,1] neg_hi:[0,1]
  v_cvt_pk_bf16_f32 v10, v10, v11
  v_accvgpr_write_b32 a202, v10
  v_lshlrev_b32 v6, 16, v63
  v_and_b32 v7, 0xffff0000, v63
  v_pk_add_f32 v[6:7], v[6:7], v[8:9] op_sel_hi:[1,0] neg_lo:[0,1] neg_hi:[0,1]
  v_cvt_pk_bf16_f32 v6, v6, v7
  v_accvgpr_write_b32 a203, v6
  v_lshlrev_b32 v10, 16, v64
  v_and_b32 v11, 0xffff0000, v64
  v_pk_add_f32 v[10:11], v[10:11], v[8:9] op_sel_hi:[1,0] neg_lo:[0,1] neg_hi:[0,1]
  v_cvt_pk_bf16_f32 v10, v10, v11
  v_accvgpr_write_b32 a216, v10
  v_lshlrev_b32 v6, 16, v65
  v_and_b32 v7, 0xffff0000, v65
  v_pk_add_f32 v[6:7], v[6:7], v[8:9] op_sel_hi:[1,0] neg_lo:[0,1] neg_hi:[0,1]
  v_cvt_pk_bf16_f32 v6, v6, v7
  v_accvgpr_write_b32 a217, v6
  v_lshlrev_b32 v10, 16, v66
  v_and_b32 v11, 0xffff0000, v66
  v_pk_add_f32 v[10:11], v[10:11], v[8:9] op_sel_hi:[1,0] neg_lo:[0,1] neg_hi:[0,1]
  v_cvt_pk_bf16_f32 v10, v10, v11
  v_accvgpr_write_b32 a218, v10
  v_lshlrev_b32 v6, 16, v67
  v_and_b32 v7, 0xffff0000, v67
  v_pk_add_f32 v[6:7], v[6:7], v[8:9] op_sel_hi:[1,0] neg_lo:[0,1] neg_hi:[0,1]
  v_cvt_pk_bf16_f32 v6, v6, v7
  v_accvgpr_write_b32 a219, v6
  s_waitcnt vmcnt(55)
  v_mov_b32 v8, 0
  v_mov_b32 v9, 0
  v_dot2_f32_bf16 v8, v68, s52, v8
  v_dot2_f32_bf16 v9, v69, s52, v9
  v_dot2_f32_bf16 v8, v70, s52, v8
  v_dot2_f32_bf16 v9, v71, s52, v9
  v_dot2_f32_bf16 v8, v72, s52, v8
  v_dot2_f32_bf16 v9, v73, s52, v9
  v_dot2_f32_bf16 v8, v74, s52, v8
  v_dot2_f32_bf16 v9, v75, s52, v9
  v_dot2_f32_bf16 v8, v76, s52, v8
  v_dot2_f32_bf16 v9, v77, s52, v9
  v_dot2_f32_bf16 v8, v78, s52, v8
  v_dot2_f32_bf16 v9, v79, s52, v9
  v_dot2_f32_bf16 v8, v80, s52, v8
  v_dot2_f32_bf16 v9, v81, s52, v9
  v_dot2_f32_bf16 v8, v82, s52, v8
  v_dot2_f32_bf16 v9, v83, s52, v9
  v_dot2_f32_bf16 v8, v84, s52, v8
  v_dot2_f32_bf16 v9, v85, s52, v9
  v_dot2_f32_bf16 v8, v86, s52, v8
  v_dot2_f32_bf16 v9, v87, s52, v9
  v_dot2_f32_bf16 v8, v88, s52, v8
  v_dot2_f32_bf16 v9, v89, s52, v9
  v_dot2_f32_bf16 v8, v90, s52, v8
  v_dot2_f32_bf16 v9, v91, s52, v9
  v_dot2_f32_bf16 v8, v92, s52, v8
  v_dot2_f32_bf16 v9, v93, s52, v9
  v_dot2_f32_bf16 v8, v94, s52, v8
  v_dot2_f32_bf16 v9, v95, s52, v9
  v_dot2_f32_bf16 v8, v96, s52, v8
  v_dot2_f32_bf16 v9, v97, s52, v9
  v_dot2_f32_bf16 v8, v98, s52, v8
  v_dot2_f32_bf16 v9, v99, s52, v9
  v_dot2_f32_bf16 v8, v100, s52, v8
  v_dot2_f32_bf16 v9, v101, s52, v9
  v_dot2_f32_bf16 v8, v102, s52, v8
  v_dot2_f32_bf16 v9, v103, s52, v9
  v_dot2_f32_bf16 v8, v104, s52, v8
  v_dot2_f32_bf16 v9, v105, s52, v9
  v_dot2_f32_bf16 v8, v106, s52, v8
  v_dot2_f32_bf16 v9, v107, s52, v9
  v_dot2_f32_bf16 v8, v108, s52, v8
  v_dot2_f32_bf16 v9, v109, s52, v9
  v_dot2_f32_bf16 v8, v110, s52, v8
  v_dot2_f32_bf16 v9, v111, s52, v9
  v_dot2_f32_bf16 v8, v112, s52, v8
  v_dot2_f32_bf16 v9, v113, s52, v9
  v_dot2_f32_bf16 v8, v114, s52, v8
  v_dot2_f32_bf16 v9, v115, s52, v9
  v_dot2_f32_bf16 v8, v116, s52, v8
  v_dot2_f32_bf16 v9, v117, s52, v9
  v_dot2_f32_bf16 v8, v118, s52, v8
  v_dot2_f32_bf16 v9, v119, s52, v9
  v_dot2_f32_bf16 v8, v248, s52, v8
  v_dot2_f32_bf16 v9, v249, s52, v9
  v_dot2_f32_bf16 v8, v250, s52, v8
  v_dot2_f32_bf16 v9, v251, s52, v9
  s_nop 2
  v_add_f32 v8, v8, v9
  v_mov_b32 v9, v8
  s_nop 1
  v_permlane16_swap_b32 v8, v9
  v_add_f32 v8, v8, v9
  v_mov_b32 v9, v8
  s_nop 1
  v_permlane32_swap_b32 v8, v9
  v_add_f32 v8, v8, v9
  v_mul_f32 v8, 0x3b124925, v8
  v_lshlrev_b32 v10, 16, v68
  v_and_b32 v11, 0xffff0000, v68
  v_pk_add_f32 v[10:11], v[10:11], v[8:9] op_sel_hi:[1,0] neg_lo:[0,1] neg_hi:[0,1]
  v_cvt_pk_bf16_f32 v10, v10, v11
  v_accvgpr_write_b32 a12, v10
  v_lshlrev_b32 v6, 16, v69
  v_and_b32 v7, 0xffff0000, v69
  v_pk_add_f32 v[6:7], v[6:7], v[8:9] op_sel_hi:[1,0] neg_lo:[0,1] neg_hi:[0,1]
  v_cvt_pk_bf16_f32 v6, v6, v7
  v_accvgpr_write_b32 a13, v6
  v_lshlrev_b32 v10, 16, v70
  v_and_b32 v11, 0xffff0000, v70
  v_pk_add_f32 v[10:11], v[10:11], v[8:9] op_sel_hi:[1,0] neg_lo:[0,1] neg_hi:[0,1]
  v_cvt_pk_bf16_f32 v10, v10, v11
  v_accvgpr_write_b32 a14, v10
  v_lshlrev_b32 v6, 16, v71
  v_and_b32 v7, 0xffff0000, v71
  v_pk_add_f32 v[6:7], v[6:7], v[8:9] op_sel_hi:[1,0] neg_lo:[0,1] neg_hi:[0,1]
  v_cvt_pk_bf16_f32 v6, v6, v7
  v_accvgpr_write_b32 a15, v6
  v_lshlrev_b32 v10, 16, v72
  v_and_b32 v11, 0xffff0000, v72
  v_pk_add_f32 v[10:11], v[10:11], v[8:9] op_sel_hi:[1,0] neg_lo:[0,1] neg_hi:[0,1]
  v_cvt_pk_bf16_f32 v10, v10, v11
  v_accvgpr_write_b32 a28, v10
  v_lshlrev_b32 v6, 16, v73
  v_and_b32 v7, 0xffff0000, v73
  v_pk_add_f32 v[6:7], v[6:7], v[8:9] op_sel_hi:[1,0] neg_lo:[0,1] neg_hi:[0,1]
  v_cvt_pk_bf16_f32 v6, v6, v7
  v_accvgpr_write_b32 a29, v6
  v_lshlrev_b32 v10, 16, v74
  v_and_b32 v11, 0xffff0000, v74
  v_pk_add_f32 v[10:11], v[10:11], v[8:9] op_sel_hi:[1,0] neg_lo:[0,1] neg_hi:[0,1]
  v_cvt_pk_bf16_f32 v10, v10, v11
  v_accvgpr_write_b32 a30, v10
  v_lshlrev_b32 v6, 16, v75
  v_and_b32 v7, 0xffff0000, v75
  v_pk_add_f32 v[6:7], v[6:7], v[8:9] op_sel_hi:[1,0] neg_lo:[0,1] neg_hi:[0,1]
  v_cvt_pk_bf16_f32 v6, v6, v7
  v_accvgpr_write_b32 a31, v6
  v_lshlrev_b32 v10, 16, v76
  v_and_b32 v11, 0xffff0000, v76
  v_pk_add_f32 v[10:11], v[10:11], v[8:9] op_sel_hi:[1,0] neg_lo:[0,1] neg_hi:[0,1]
  v_cvt_pk_bf16_f32 v10, v10, v11
  v_accvgpr_write_b32 a44, v10
  v_lshlrev_b32 v6, 16, v77
  v_and_b32 v7, 0xffff0000, v77
  v_pk_add_f32 v[6:7], v[6:7], v[8:9] op_sel_hi:[1,0] neg_lo:[0,1] neg_hi:[0,1]
  v_cvt_pk_bf16_f32 v6, v6, v7
  v_accvgpr_write_b32 a45, v6
  v_lshlrev_b32 v10, 16, v78
  v_and_b32 v11, 0xffff0000, v78
  v_pk_add_f32 v[10:11], v[10:11], v[8:9] op_sel_hi:[1,0] neg_lo:[0,1] neg_hi:[0,1]
  v_cvt_pk_bf16_f32 v10, v10, v11
  v_accvgpr_write_b32 a46, v10
  v_lshlrev_b32 v6, 16, v79
  v_and_b32 v7, 0xffff0000, v79
  v_pk_add_f32 v[6:7], v[6:7], v[8:9] op_sel_hi:[1,0] neg_lo:[0,1] neg_hi:[0,1]
  v_cvt_pk_bf16_f32 v6, v6, v7
  v_accvgpr_write_b32 a47, v6
  v_lshlrev_b32 v10, 16, v80
  v_and_b32 v11, 0xffff0000, v80
  v_pk_add_f32 v[10:11], v[10:11], v[8:9] op_sel_hi:[1,0] neg_lo:[0,1] neg_hi:[0,1]
  v_cvt_pk_bf16_f32 v10, v10, v11
  v_accvgpr_write_b32 a60, v10
  v_lshlrev_b32 v6, 16, v81
  v_and_b32 v7, 0xffff0000, v81
  v_pk_add_f32 v[6:7], v[6:7], v[8:9] op_sel_hi:[1,0] neg_lo:[0,1] neg_hi:[0,1]
  v_cvt_pk_bf16_f32 v6, v6, v7
  v_accvgpr_write_b32 a61, v6
  v_lshlrev_b32 v10, 16, v82
  v_and_b32 v11, 0xffff0000, v82
  v_pk_add_f32 v[10:11], v[10:11], v[8:9] op_sel_hi:[1,0] neg_lo:[0,1] neg_hi:[0,1]
  v_cvt_pk_bf16_f32 v10, v10, v11
  v_accvgpr_write_b32 a62, v10
  v_lshlrev_b32 v6, 16, v83
  v_and_b32 v7, 0xffff0000, v83
  v_pk_add_f32 v[6:7], v[6:7], v[8:9] op_sel_hi:[1,0] neg_lo:[0,1] neg_hi:[0,1]
  v_cvt_pk_bf16_f32 v6, v6, v7
  v_accvgpr_write_b32 a63, v6
  v_lshlrev_b32 v10, 16, v84
  v_and_b32 v11, 0xffff0000, v84
  v_pk_add_f32 v[10:11], v[10:11], v[8:9] op_sel_hi:[1,0] neg_lo:[0,1] neg_hi:[0,1]
  v_cvt_pk_bf16_f32 v10, v10, v11
  v_accvgpr_write_b32 a76, v10
  v_lshlrev_b32 v6, 16, v85
  v_and_b32 v7, 0xffff0000, v85
  v_pk_add_f32 v[6:7], v[6:7], v[8:9] op_sel_hi:[1,0] neg_lo:[0,1] neg_hi:[0,1]
  v_cvt_pk_bf16_f32 v6, v6, v7
  v_accvgpr_write_b32 a77, v6
  v_lshlrev_b32 v10, 16, v86
  v_and_b32 v11, 0xffff0000, v86
  v_pk_add_f32 v[10:11], v[10:11], v[8:9] op_sel_hi:[1,0] neg_lo:[0,1] neg_hi:[0,1]
  v_cvt_pk_bf16_f32 v10, v10, v11
  v_accvgpr_write_b32 a78, v10
  v_lshlrev_b32 v6, 16, v87
  v_and_b32 v7, 0xffff0000, v87
  v_pk_add_f32 v[6:7], v[6:7], v[8:9] op_sel_hi:[1,0] neg_lo:[0,1] neg_hi:[0,1]
  v_cvt_pk_bf16_f32 v6, v6, v7
  v_accvgpr_write_b32 a79, v6
  v_lshlrev_b32 v10, 16, v88
  v_and_b32 v11, 0xffff0000, v88
  v_pk_add_f32 v[10:11], v[10:11], v[8:9] op_sel_hi:[1,0] neg_lo:[0,1] neg_hi:[0,1]
  v_cvt_pk_bf16_f32 v10, v10, v11
  v_accvgpr_write_b32 a92, v10
  v_lshlrev_b32 v6, 16, v89
  v_and_b32 v7, 0xffff0000, v89
  v_pk_add_f32 v[6:7], v[6:7], v[8:9] op_sel_hi:[1,0] neg_lo:[0,1] neg_hi:[0,1]
  v_cvt_pk_bf16_f32 v6, v6, v7
  v_accvgpr_write_b32 a93, v6
  v_lshlrev_b32 v10, 16, v90
  v_and_b32 v11, 0xffff0000, v90
  v_pk_add_f32 v[10:11], v[10:11], v[8:9] op_sel_hi:[1,0] neg_lo:[0,1] neg_hi:[0,1]
  v_cvt_pk_bf16_f32 v10, v10, v11
  v_accvgpr_write_b32 a94, v10
  v_lshlrev_b32 v6, 16, v91
  v_and_b32 v7, 0xffff0000, v91
  v_pk_add_f32 v[6:7], v[6:7], v[8:9] op_sel_hi:[1,0] neg_lo:[0,1] neg_hi:[0,1]
  v_cvt_pk_bf16_f32 v6, v6, v7
  v_accvgpr_write_b32 a95, v6
  v_lshlrev_b32 v10, 16, v92
  v_and_b32 v11, 0xffff0000, v92
  v_pk_add_f32 v[10:11], v[10:11], v[8:9] op_sel_hi:[1,0] neg_lo:[0,1] neg_hi:[0,1]
  v_cvt_pk_bf16_f32 v10, v10, v11
  v_accvgpr_write_b32 a108, v10
  v_lshlrev_b32 v6, 16, v93
  v_and_b32 v7, 0xffff0000, v93
  v_pk_add_f32 v[6:7], v[6:7], v[8:9] op_sel_hi:[1,0] neg_lo:[0,1] neg_hi:[0,1]
  v_cvt_pk_bf16_f32 v6, v6, v7
  v_accvgpr_write_b32 a109, v6
  v_lshlrev_b32 v10, 16, v94
  v_and_b32 v11, 0xffff0000, v94
  v_pk_add_f32 v[10:11], v[10:11], v[8:9] op_sel_hi:[1,0] neg_lo:[0,1] neg_hi:[0,1]
  v_cvt_pk_bf16_f32 v10, v10, v11
  v_accvgpr_write_b32 a110, v10
  v_lshlrev_b32 v6, 16, v95
  v_and_b32 v7, 0xffff0000, v95
  v_pk_add_f32 v[6:7], v[6:7], v[8:9] op_sel_hi:[1,0] neg_lo:[0,1] neg_hi:[0,1]
  v_cvt_pk_bf16_f32 v6, v6, v7
  v_accvgpr_write_b32 a111, v6
  v_lshlrev_b32 v10, 16, v96
  v_and_b32 v11, 0xffff0000, v96
  v_pk_add_f32 v[10:11], v[10:11], v[8:9] op_sel_hi:[1,0] neg_lo:[0,1] neg_hi:[0,1]
  v_cvt_pk_bf16_f32 v10, v10, v11
  v_accvgpr_write_b32 a124, v10
  v_lshlrev_b32 v6, 16, v97
  v_and_b32 v7, 0xffff0000, v97
  v_pk_add_f32 v[6:7], v[6:7], v[8:9] op_sel_hi:[1,0] neg_lo:[0,1] neg_hi:[0,1]
  v_cvt_pk_bf16_f32 v6, v6, v7
  v_accvgpr_write_b32 a125, v6
  v_lshlrev_b32 v10, 16, v98
  v_and_b32 v11, 0xffff0000, v98
  v_pk_add_f32 v[10:11], v[10:11], v[8:9] op_sel_hi:[1,0] neg_lo:[0,1] neg_hi:[0,1]
  v_cvt_pk_bf16_f32 v10, v10, v11
  v_accvgpr_write_b32 a126, v10
  v_lshlrev_b32 v6, 16, v99
  v_and_b32 v7, 0xffff0000, v99
  v_pk_add_f32 v[6:7], v[6:7], v[8:9] op_sel_hi:[1,0] neg_lo:[0,1] neg_hi:[0,1]
  v_cvt_pk_bf16_f32 v6, v6, v7
  v_accvgpr_write_b32 a127, v6
  v_lshlrev_b32 v10, 16, v100
  v_and_b32 v11, 0xffff0000, v100
  v_pk_add_f32 v[10:11], v[10:11], v[8:9] op_sel_hi:[1,0] neg_lo:[0,1] neg_hi:[0,1]
  v_cvt_pk_bf16_f32 v10, v10, v11
  v_accvgpr_write_b32 a140, v10
  v_lshlrev_b32 v6, 16, v101
  v_and_b32 v7, 0xffff0000, v101
  v_pk_add_f32 v[6:7], v[6:7], v[8:9] op_sel_hi:[1,0] neg_lo:[0,1] neg_hi:[0,1]
  v_cvt_pk_bf16_f32 v6, v6, v7
  v_accvgpr_write_b32 a141, v6
  v_lshlrev_b32 v10, 16, v102
  v_and_b32 v11, 0xffff0000, v102
  v_pk_add_f32 v[10:11], v[10:11], v[8:9] op_sel_hi:[1,0] neg_lo:[0,1] neg_hi:[0,1]
  v_cvt_pk_bf16_f32 v10, v10, v11
  v_accvgpr_write_b32 a142, v10
  v_lshlrev_b32 v6, 16, v103
  v_and_b32 v7, 0xffff0000, v103
  v_pk_add_f32 v[6:7], v[6:7], v[8:9] op_sel_hi:[1,0] neg_lo:[0,1] neg_hi:[0,1]
  v_cvt_pk_bf16_f32 v6, v6, v7
  v_accvgpr_write_b32 a143, v6
  v_lshlrev_b32 v10, 16, v104
  v_and_b32 v11, 0xffff0000, v104
  v_pk_add_f32 v[10:11], v[10:11], v[8:9] op_sel_hi:[1,0] neg_lo:[0,1] neg_hi:[0,1]
  v_cvt_pk_bf16_f32 v10, v10, v11
  v_accvgpr_write_b32 a156, v10
  v_lshlrev_b32 v6, 16, v105
  v_and_b32 v7, 0xffff0000, v105
  v_pk_add_f32 v[6:7], v[6:7], v[8:9] op_sel_hi:[1,0] neg_lo:[0,1] neg_hi:[0,1]
  v_cvt_pk_bf16_f32 v6, v6, v7
  v_accvgpr_write_b32 a157, v6
  v_lshlrev_b32 v10, 16, v106
  v_and_b32 v11, 0xffff0000, v106
  v_pk_add_f32 v[10:11], v[10:11], v[8:9] op_sel_hi:[1,0] neg_lo:[0,1] neg_hi:[0,1]
  v_cvt_pk_bf16_f32 v10, v10, v11
  v_accvgpr_write_b32 a158, v10
  v_lshlrev_b32 v6, 16, v107
  v_and_b32 v7, 0xffff0000, v107
  v_pk_add_f32 v[6:7], v[6:7], v[8:9] op_sel_hi:[1,0] neg_lo:[0,1] neg_hi:[0,1]
  v_cvt_pk_bf16_f32 v6, v6, v7
  v_accvgpr_write_b32 a159, v6
  v_lshlrev_b32 v10, 16, v108
  v_and_b32 v11, 0xffff0000, v108
  v_pk_add_f32 v[10:11], v[10:11], v[8:9] op_sel_hi:[1,0] neg_lo:[0,1] neg_hi:[0,1]
  v_cvt_pk_bf16_f32 v10, v10, v11
  v_accvgpr_write_b32 a172, v10
  v_lshlrev_b32 v6, 16, v109
  v_and_b32 v7, 0xffff0000, v109
  v_pk_add_f32 v[6:7], v[6:7], v[8:9] op_sel_hi:[1,0] neg_lo:[0,1] neg_hi:[0,1]
  v_cvt_pk_bf16_f32 v6, v6, v7
  v_accvgpr_write_b32 a173, v6
  v_lshlrev_b32 v10, 16, v110
  v_and_b32 v11, 0xffff0000, v110
  v_pk_add_f32 v[10:11], v[10:11], v[8:9] op_sel_hi:[1,0] neg_lo:[0,1] neg_hi:[0,1]
  v_cvt_pk_bf16_f32 v10, v10, v11
  v_accvgpr_write_b32 a174, v10
  v_lshlrev_b32 v6, 16, v111
  v_and_b32 v7, 0xffff0000, v111
  v_pk_add_f32 v[6:7], v[6:7], v[8:9] op_sel_hi:[1,0] neg_lo:[0,1] neg_hi:[0,1]
  v_cvt_pk_bf16_f32 v6, v6, v7
  v_accvgpr_write_b32 a175, v6
  v_lshlrev_b32 v10, 16, v112
  v_and_b32 v11, 0xffff0000, v112
  v_pk_add_f32 v[10:11], v[10:11], v[8:9] op_sel_hi:[1,0] neg_lo:[0,1] neg_hi:[0,1]
  v_cvt_pk_bf16_f32 v10, v10, v11
  v_accvgpr_write_b32 a188, v10
  v_lshlrev_b32 v6, 16, v113
  v_and_b32 v7, 0xffff0000, v113
  v_pk_add_f32 v[6:7], v[6:7], v[8:9] op_sel_hi:[1,0] neg_lo:[0,1] neg_hi:[0,1]
  v_cvt_pk_bf16_f32 v6, v6, v7
  v_accvgpr_write_b32 a189, v6
  v_lshlrev_b32 v10, 16, v114
  v_and_b32 v11, 0xffff0000, v114
  v_pk_add_f32 v[10:11], v[10:11], v[8:9] op_sel_hi:[1,0] neg_lo:[0,1] neg_hi:[0,1]
  v_cvt_pk_bf16_f32 v10, v10, v11
  v_accvgpr_write_b32 a190, v10
  v_lshlrev_b32 v6, 16, v115
  v_and_b32 v7, 0xffff0000, v115
  v_pk_add_f32 v[6:7], v[6:7], v[8:9] op_sel_hi:[1,0] neg_lo:[0,1] neg_hi:[0,1]
  v_cvt_pk_bf16_f32 v6, v6, v7
  v_accvgpr_write_b32 a191, v6
  v_lshlrev_b32 v10, 16, v116
  v_and_b32 v11, 0xffff0000, v116
  v_pk_add_f32 v[10:11], v[10:11], v[8:9] op_sel_hi:[1,0] neg_lo:[0,1] neg_hi:[0,1]
  v_cvt_pk_bf16_f32 v10, v10, v11
  v_accvgpr_write_b32 a204, v10
  v_lshlrev_b32 v6, 16, v117
  v_and_b32 v7, 0xffff0000, v117
  v_pk_add_f32 v[6:7], v[6:7], v[8:9] op_sel_hi:[1,0] neg_lo:[0,1] neg_hi:[0,1]
  v_cvt_pk_bf16_f32 v6, v6, v7
  v_accvgpr_write_b32 a205, v6
  v_lshlrev_b32 v10, 16, v118
  v_and_b32 v11, 0xffff0000, v118
  v_pk_add_f32 v[10:11], v[10:11], v[8:9] op_sel_hi:[1,0] neg_lo:[0,1] neg_hi:[0,1]
  v_cvt_pk_bf16_f32 v10, v10, v11
  v_accvgpr_write_b32 a206, v10
  v_lshlrev_b32 v6, 16, v119
  v_and_b32 v7, 0xffff0000, v119
  v_pk_add_f32 v[6:7], v[6:7], v[8:9] op_sel_hi:[1,0] neg_lo:[0,1] neg_hi:[0,1]
  v_cvt_pk_bf16_f32 v6, v6, v7
  v_accvgpr_write_b32 a207, v6
  v_lshlrev_b32 v10, 16, v248
  v_and_b32 v11, 0xffff0000, v248
  v_pk_add_f32 v[10:11], v[10:11], v[8:9] op_sel_hi:[1,0] neg_lo:[0,1] neg_hi:[0,1]
  v_cvt_pk_bf16_f32 v10, v10, v11
  v_accvgpr_write_b32 a220, v10
  v_lshlrev_b32 v6, 16, v249
  v_and_b32 v7, 0xffff0000, v249
  v_pk_add_f32 v[6:7], v[6:7], v[8:9] op_sel_hi:[1,0] neg_lo:[0,1] neg_hi:[0,1]
  v_cvt_pk_bf16_f32 v6, v6, v7
  v_accvgpr_write_b32 a221, v6
  v_lshlrev_b32 v10, 16, v250
  v_and_b32 v11, 0xffff0000, v250
  v_pk_add_f32 v[10:11], v[10:11], v[8:9] op_sel_hi:[1,0] neg_lo:[0,1] neg_hi:[0,1]
  v_cvt_pk_bf16_f32 v10, v10, v11
  v_accvgpr_write_b32 a222, v10
  v_lshlrev_b32 v6, 16, v251
  v_and_b32 v7, 0xffff0000, v251
  v_pk_add_f32 v[6:7], v[6:7], v[8:9] op_sel_hi:[1,0] neg_lo:[0,1] neg_hi:[0,1]
  v_cvt_pk_bf16_f32 v6, v6, v7
  v_accvgpr_write_b32 a223, v6
  s_add_u32 s22, s20, 98304
  buffer_load_dwordx4 v[248:251], v2, s[12:15], s22 offen
  s_waitcnt vmcnt(0)
  s_cmp_lg_u32 s3, 0
  s_cbranch_scc1 FF_TA_B
  v_lshrrev_b32 v16, 1, v1
  v_lshlrev_b32 v16, 7, v16
  v_and_b32 v17, 1, v1
  v_lshl_add_u32 v16, v17, 4, v16
  s_mov_b32 s58, 17895424
  s_mov_b32 s59, 0
FF_TA_L:
  buffer_load_dwordx4 v[12:15], v16, s[12:15], s58 offen sc1
  s_add_u32 s59, s59, 1
  s_cmp_gt_u32 s59, 131072
  s_mov_b32 s99, 18
  s_cbranch_scc1 FAIL
  s_waitcnt vmcnt(0)
  v_xor_b32 v12, s90, v12
  v_xor_b32 v13, s90, v13
  v_xor_b32 v14, s90, v14
  v_xor_b32 v15, s90, v15
  v_or3_b32 v12, v12, v13, v14
  v_or_b32 v12, v12, v15
  v_cmp_ne_u32 vcc, 0, v12
  s_cbranch_vccz FF_TA_B
  s_sleep 4
  s_branch FF_TA_L
FF_TA_B:
  s_barrier
  s_branch FF_W
FF_NOW:
  s_cmp_lg_u32 s3, 0
  s_cbranch_scc1 FR_TA_B
  v_lshrrev_b32 v16, 1, v1
  v_lshlrev_b32 v16, 7, v16
  v_and_b32 v17, 1, v1
  v_lshl_add_u32 v16, v17, 4, v16
  s_mov_b32 s58, 17895424
  s_mov_b32 s59, 0
FR_TA_L:
  buffer_load_dwordx4 v[12:15], v16, s[12:15], s58 offen sc1
  s_add_u32 s59, s59, 1
  s_cmp_gt_u32 s59, 131072
  s_mov_b32 s99, 18
  s_cbranch_scc1 FAIL
  s_waitcnt vmcnt(0)
  v_xor_b32 v12, s90, v12
  v_xor_b32 v13, s90, v13
  v_xor_b32 v14, s90, v14
  v_xor_b32 v15, s90, v15
  v_or3_b32 v12, v12, v13, v14
  v_or_b32 v12, v12, v15
  v_cmp_ne_u32 vcc, 0, v12
  s_cbranch_vccz FR_TA_B
  s_sleep 4
  s_branch FR_TA_L
FR_TA_B:
  s_barrier
  s_waitcnt vmcnt(0)
FF_W:
  s_and_b32 s36, s3, 1
  s_mul_i32 s36, s36, 14336
  s_lshr_b32 s37, s3, 1
  s_mul_i32 s37, s37, 7168
  s_add_u32 s36, s36, s37
  v_add_u32 v3, s36, v2
  s_lshl_b32 s37, s3, 11
  s_add_u32 s37, s37, 86016
  v_add_u32 v6, s37, v2
  v_add_u32 v7, 86016, v2
  s_lshl_b32 s38, s16, 6
  s_add_u32 s38, s38, s18
  s_mul_i32 s21, s38, 28672
  s_add_u32 s21, s21, s36
  s_add_u32 s21, s21, 80297984
  s_mul_i32 s37, s16, 3
  s_add_u32 s37, s37, s18
  s_mul_i32 s26, s37, 200704
  s_add_u32 s26, s26, 91473920
  s_mul_i32 s37, s17, 28672
  s_add_u32 s25, s26, s37
  s_mul_i32 s48, s3, 7
  s_add_u32 s48, s48, 1
  s_lshr_b32 s48, s48, 1
  s_lshl_b32 s48, s48, 10
  s_lshr_b32 s49, s3, 1
  s_mul_i32 s49, s49, 7
  s_add_u32 s49, s49, 3
  s_lshl_b32 s49, s49, 10
  s_and_b32 s37, s3, 1
  s_lshl_b32 s37, s37, 3
  s_add_u32 s49, s49, s37
  v_lshrrev_b32 v4, 2, v1
  v_cmp_gt_u32 vcc, 14, v4
  v_min_u32 v4, 13, v4
  s_nop 0
  v_cndmask_b32 v11, 0, 1.0, vcc
  s_mov_b64 s[50:51], vcc
  s_mul_i32 s37, s3, 14
  v_add_u32 v4, s37, v4
  v_and_b32 v56, 3, v1
  v_lshlrev_b32 v8, 8, v4
  v_lshl_add_u32 v8, v56, 4, v8
  v_lshrrev_b32 v57, 2, v4
  v_lshlrev_b32 v0, 6, v57
  v_and_b32 v57, 3, v4
  v_lshl_add_u32 v0, v57, 3, v0
  v_mul_u32_u24 v56, 896, v56
  v_add_u32 v0, v0, v56
  s_lshr_b32 s37, s17, 2
  s_mul_i32 s37, s37, 14336
  s_and_b32 s39, s17, 3
  s_lshl_b32 s39, s39, 6
  s_add_u32 s37, s37, s39
  v_add_u32 v8, s37, v8
  s_mul_i32 s37, s17, 3584
  v_add_u32 v0, s37, v0
  s_mul_i32 s27, s18, 28672
  s_mov_b32 s23, s18
  s_mov_b32 s41, 0
  s_mov_b32 s52, 0x3f803f80
  s_mov_b32 s61, 0x3f80
  s_mov_b32 s62, 0x3f800000
  s_waitcnt vmcnt(0)
  s_mov_b32 s53, 0x3b124925
  s_cmp_eq_u32 s17, 7
  s_cbranch_scc1 FR
  s_mul_i32 s43, s16, 3
  s_add_u32 s43, s43, s18
  s_lshl_b32 s43, s43, 7
  s_add_u32 s43, s43, 91472896
  s_mov_b32 s63, -2
  v_mov_b32 v63, -1
  v_lshlrev_b32 v12, 3, v2
  s_mul_i32 s37, s3, 7168
  s_add_u32 s37, s37, s25
  v_min_u32 v12, 7040, v12
  buffer_load_dword v13, v12, s[12:15], s37 offen sc1
  s_add_u32 s37, s37, 1204224
  buffer_load_dword v13, v12, s[12:15], s37 offen sc1
  s_add_u32 s37, s37, 1204224
  buffer_load_dword v13, v12, s[12:15], s37 offen sc1
  s_add_u32 s37, s37, 1204224
  s_add_u32 s22, s21, 4096
  buffer_load_dwordx4 v[92:95], v2, s[12:15], s21 offen offset:0 sc1
  buffer_load_dwordx4 v[96:99], v2, s[12:15], s21 offen offset:1024 sc1
  buffer_load_dwordx4 v[100:103], v2, s[12:15], s21 offen offset:2048 sc1
  buffer_load_dwordx4 v[104:107], v2, s[12:15], s21 offen offset:3072 sc1
  buffer_load_dwordx4 v[108:111], v2, s[12:15], s22 offen offset:0 sc1
  buffer_load_dwordx4 v[112:115], v2, s[12:15], s22 offen offset:1024 sc1
  buffer_load_dwordx4 v[116:119], v2, s[12:15], s22 offen offset:2048 sc1
  s_waitcnt vmcnt(0)
FF_TASK:
  s_waitcnt vmcnt(2)
  v_cmp_gt_i32 vcc, s63, v63
  s_cbranch_vccnz FF_ACK
FF_ACKED:
  s_mov_b32 s24, 0
  s_waitcnt vmcnt(2)
  v_max3_u32 v4, v92, v93, v94
  v_max3_u32 v4, v4, v95, v96
  v_max3_u32 v4, v4, v97, v98
  v_max3_u32 v4, v4, v99, v100
  v_max3_u32 v4, v4, v101, v102
  v_max3_u32 v4, v4, v103, v104
  v_max3_u32 v4, v4, v105, v106
  v_max3_u32 v4, v4, v107, v108
  v_max3_u32 v4, v4, v109, v110
  v_max3_u32 v4, v4, v111, v112
  v_max3_u32 v4, v4, v113, v114
  v_max3_u32 v4, v4, v115, v116
  v_max3_u32 v4, v4, v117, v118
  v_max_u32 v4, v4, v119
  v_cmp_eq_u32 vcc, -1, v4
  s_cbranch_vccz FF_X_OK
FF_X_L:
  buffer_load_dwordx4 v[92:95], v2, s[12:15], s21 offen offset:0 sc1
  buffer_load_dwordx4 v[96:99], v2, s[12:15], s21 offen offset:1024 sc1
  buffer_load_dwordx4 v[100:103], v2, s[12:15], s21 offen offset:2048 sc1
  buffer_load_dwordx4 v[104:107], v2, s[12:15], s21 offen offset:3072 sc1
  buffer_load_dwordx4 v[108:111], v2, s[12:15], s22 offen offset:0 sc1
  buffer_load_dwordx4 v[112:115], v2, s[12:15], s22 offen offset:1024 sc1
  buffer_load_dwordx4 v[116:119], v2, s[12:15], s22 offen offset:2048 sc1
  s_add_u32 s24, s24, 1
  s_cmp_gt_u32 s24, 131072
  s_mov_b32 s99, 14
  s_cbranch_scc1 FAIL
  s_waitcnt vmcnt(0)
  v_max3_u32 v4, v92, v93, v94
  v_max3_u32 v4, v4, v95, v96
  v_max3_u32 v4, v4, v97, v98
  v_max3_u32 v4, v4, v99, v100
  v_max3_u32 v4, v4, v101, v102
  v_max3_u32 v4, v4, v103, v104
  v_max3_u32 v4, v4, v105, v106
  v_max3_u32 v4, v4, v107, v108
  v_max3_u32 v4, v4, v109, v110
  v_max3_u32 v4, v4, v111, v112
  v_max3_u32 v4, v4, v113, v114
  v_max3_u32 v4, v4, v115, v116
  v_max3_u32 v4, v4, v117, v118
  v_max_u32 v4, v4, v119
  v_cmp_eq_u32 vcc, -1, v4
  s_cbranch_vccz FF_X_OK
  s_sleep 1
  s_branch FF_X_L
FF_X_OK:
  s_mov_b32 s38, s24
  v_mov_b32 v56, 0
  v_mov_b32 v57, 0
  v_mov_b32 v58, 0
  v_mov_b32 v59, 0
  ds_write_b128 v3, v[92:95] offset:0
  v_dot2_f32_bf16 v56, v92, s52, v56
  v_dot2_f32_bf16 v57, v92, v92, v57
  v_dot2_f32_bf16 v58, v93, s52, v58
  v_dot2_f32_bf16 v59, v93, v93, v59
  v_dot2_f32_bf16 v56, v94, s52, v56
  v_dot2_f32_bf16 v57, v94, v94, v57
  v_dot2_f32_bf16 v58, v95, s52, v58
  v_dot2_f32_bf16 v59, v95, v95, v59
  ds_write_b128 v3, v[96:99] offset:1024
  v_dot2_f32_bf16 v56, v96, s52, v56
  v_dot2_f32_bf16 v57, v96, v96, v57
  v_dot2_f32_bf16 v58, v97, s52, v58
  v_dot2_f32_bf16 v59, v97, v97, v59
  v_dot2_f32_bf16 v56, v98, s52, v56
  v_dot2_f32_bf16 v57, v98, v98, v57
  v_dot2_f32_bf16 v58, v99, s52, v58
  v_dot2_f32_bf16 v59, v99, v99, v59
  ds_write_b128 v3, v[100:103] offset:2048
  v_dot2_f32_bf16 v56, v100, s52, v56
  v_dot2_f32_bf16 v57, v100, v100, v57
  v_dot2_f32_bf16 v58, v101, s52, v58
  v_dot2_f32_bf16 v59, v101, v101, v59
  v_dot2_f32_bf16 v56, v102, s52, v56
  v_dot2_f32_bf16 v57, v102, v102, v57
  v_dot2_f32_bf16 v58, v103, s52, v58
  v_dot2_f32_bf16 v59, v103, v103, v59
  ds_write_b128 v3, v[104:107] offset:3072
  v_dot2_f32_bf16 v56, v104, s52, v56
  v_dot2_f32_bf16 v57, v104, v104, v57
  v_dot2_f32_bf16 v58, v105, s52, v58
  v_dot2_f32_bf16 v59, v105, v105, v59
  v_dot2_f32_bf16 v56, v106, s52, v56
  v_dot2_f32_bf16 v57, v106, v106, v57
  v_dot2_f32_bf16 v58, v107, s52, v58
  v_dot2_f32_bf16 v59, v107, v107, v59
  ds_write_b128 v3, v[108:111] offset:4096
  v_dot2_f32_bf16 v56, v108, s52, v56
  v_dot2_f32_bf16 v57, v108, v108, v57
  v_dot2_f32_bf16 v58, v109, s52, v58
  v_dot2_f32_bf16 v59, v109, v109, v59
  v_dot2_f32_bf16 v56, v110, s52, v56
  v_dot2_f32_bf16 v57, v110, v110, v57
  v_dot2_f32_bf16 v58, v111, s52, v58
  v_dot2_f32_bf16 v59, v111, v111, v59
  ds_write_b128 v3, v[112:115] offset:5120
  v_dot2_f32_bf16 v56, v112, s52, v56
  v_dot2_f32_bf16 v57, v112, v112, v57
  v_dot2_f32_bf16 v58, v113, s52, v58
  v_dot2_f32_bf16 v59, v113, v113, v59
  v_dot2_f32_bf16 v56, v114, s52, v56
  v_dot2_f32_bf16 v57, v114, v114, v57
  v_dot2_f32_bf16 v58, v115, s52, v58
  v_dot2_f32_bf16 v59, v115, v115, v59
  ds_write_b128 v3, v[116:119] offset:6144
  v_dot2_f32_bf16 v56, v116, s52, v56
  v_dot2_f32_bf16 v57, v116, v116, v57
  v_dot2_f32_bf16 v58, v117, s52, v58
  v_dot2_f32_bf16 v59, v117, v117, v59
  v_dot2_f32_bf16 v56, v118, s52, v56
  v_dot2_f32_bf16 v57, v118, v118, v57
  v_dot2_f32_bf16 v58, v119, s52, v58
  v_dot2_f32_bf16 v59, v119, v119, v59
  v_and_b32 v4, 15, v1
  v_lshlrev_b32 v4, 3, v4
  s_lshl_b32 s37, s3, 7
  s_add_u32 s37, s37, 102400
  v_add_u32 v60, s37, v4
  v_add_f32 v56, v56, v58
  v_add_f32 v57, v57, v59
  v_mov_b32 v58, v56
  v_mov_b32 v59, v57
  s_nop 0
  v_permlane16_swap_b32 v56, v58
  v_permlane16_swap_b32 v57, v59
  v_add_f32 v56, v56, v58
  v_add_f32 v57, v57, v59
  v_mov_b32 v58, v56
  v_mov_b32 v59, v57
  s_nop 0
  v_permlane32_swap_b32 v56, v58
  v_permlane32_swap_b32 v57, v59
  v_add_f32 v56, v56, v58
  v_add_f32 v57, v57, v59
  ds_write_b64 v60, v[56:57]
  v_add_u32 v4, 102400, v4
  s_waitcnt lgkmcnt(0)
  s_barrier
  s_cmp_eq_u32 s41, 2
  s_mov_b32 s56, 1204224
  s_cselect_b32 s56, 0xffdb4000, s56
  s_add_u32 s57, s25, s56
  s_mul_i32 s37, s3, 7168
  s_add_u32 s57, s57, s37
  s_add_u32 s58, s57, 4096
  s_add_u32 s59, s27, 78635008
  s_add_u32 s60, s27, 84140032
  s_lshl_b32 s37, s16, 6
  s_add_u32 s37, s37, s23
  s_cmp_lt_u32 s37, 58
  s_cselect_b32 s59, s59, 2147418112
  s_cselect_b32 s60, s60, 2147418112
  ds_read2_b64 v[28:31], v4 offset0:0 offset1:32
  ds_read2_b64 v[32:35], v4 offset0:16 offset1:48
  ds_read_b128 v[12:15], v2 offset:0
  ds_read_b128 v[16:19], v2 offset:14336
  ds_read_b128 v[20:23], v2 offset:1024
  ds_read_b128 v[24:27], v2 offset:15360
  v_mov_b32 v36, -1
  v_mov_b32 v37, -1
  v_mov_b32 v38, -1
  v_mov_b32 v39, -1
  buffer_store_dwordx4 v[36:39], v2, s[12:15], s57 offen offset:0
  buffer_store_dwordx4 v[36:39], v2, s[12:15], s57 offen offset:1024
  s_waitcnt lgkmcnt(5)
  v_pk_add_f32 v[28:29], v[28:29], v[30:31]
  s_waitcnt lgkmcnt(3)
  v_mfma_f32_16x16x32_bf16 v[64:67], a[0:3], v[12:15], 0
  v_mul_f32 v28, 0x3b124925, v28
  v_mul_f32 v28, v28, v28
  v_mfma_f32_16x16x32_bf16 v[72:75], a[4:7], v[12:15], 0
  ds_read_b128 v[12:15], v2 offset:2048
  v_fma_f32 v28, v29, s53, -v28
  s_waitcnt lgkmcnt(2)
  v_mfma_f32_16x16x32_bf16 v[68:71], a[0:3], v[16:19], 0
  v_max_f32 v28, 0, v28
  v_add_f32 v28, 0x3727c5ac, v28
  v_mfma_f32_16x16x32_bf16 v[76:79], a[4:7], v[16:19], 0
  ds_read_b128 v[16:19], v2 offset:16384
  buffer_store_dwordx4 v[36:39], v2, s[12:15], s57 offen offset:2048
  v_mfma_f32_16x16x32_bf16 v[64:67], a[16:19], v[20:23], v[64:67]
  v_rsq_f32 v9, v28
  v_mfma_f32_16x16x32_bf16 v[72:75], a[20:23], v[20:23], v[72:75]
  ds_read_b128 v[20:23], v2 offset:3072
  v_pk_add_f32 v[32:33], v[32:33], v[34:35]
  s_waitcnt lgkmcnt(3)
  v_mfma_f32_16x16x32_bf16 v[68:71], a[16:19], v[24:27], v[68:71]
  v_mul_f32 v58, v28, v9
  v_mul_f32 v32, 0x3b124925, v32
  v_mfma_f32_16x16x32_bf16 v[76:79], a[20:23], v[24:27], v[76:79]
  ds_read_b128 v[24:27], v2 offset:17408
  buffer_store_dwordx4 v[36:39], v2, s[12:15], s57 offen offset:3072
  s_waitcnt lgkmcnt(3)
  v_mfma_f32_16x16x32_bf16 v[64:67], a[32:35], v[12:15], v[64:67]
  v_mul_f32 v9, 0xbfb8aa3b, v9
  v_mul_f32 v32, v32, v32
  v_mfma_f32_16x16x32_bf16 v[72:75], a[36:39], v[12:15], v[72:75]
  ds_read_b128 v[12:15], v2 offset:4096
  v_fma_f32 v32, v33, s53, -v32
  s_waitcnt lgkmcnt(3)
  v_mfma_f32_16x16x32_bf16 v[68:71], a[32:35], v[16:19], v[68:71]
  v_max_f32 v32, 0, v32
  v_add_f32 v32, 0x3727c5ac, v32
  v_mfma_f32_16x16x32_bf16 v[76:79], a[36:39], v[16:19], v[76:79]
  ds_read_b128 v[16:19], v2 offset:18432
  buffer_store_dwordx4 v[36:39], v2, s[12:15], s58 offen offset:0
  s_waitcnt lgkmcnt(3)
  v_mfma_f32_16x16x32_bf16 v[64:67], a[48:51], v[20:23], v[64:67]
  v_rsq_f32 v10, v32
  v_mfma_f32_16x16x32_bf16 v[72:75], a[52:55], v[20:23], v[72:75]
  ds_read_b128 v[20:23], v2 offset:5120
  v_mul_f32 v59, v32, v10
  s_waitcnt lgkmcnt(3)
  v_mfma_f32_16x16x32_bf16 v[68:71], a[48:51], v[24:27], v[68:71]
  v_mul_f32 v10, 0xbfb8aa3b, v10
  v_mfma_f32_16x16x32_bf16 v[76:79], a[52:55], v[24:27], v[76:79]
  ds_read_b128 v[24:27], v2 offset:19456
  buffer_store_dwordx4 v[36:39], v2, s[12:15], s58 offen offset:1024
  s_waitcnt lgkmcnt(3)
  v_mfma_f32_16x16x32_bf16 v[64:67], a[64:67], v[12:15], v[64:67]
  v_mfma_f32_16x16x32_bf16 v[72:75], a[68:71], v[12:15], v[72:75]
  ds_read_b128 v[12:15], v2 offset:6144
  s_waitcnt lgkmcnt(3)
  v_mfma_f32_16x16x32_bf16 v[68:71], a[64:67], v[16:19], v[68:71]
  v_mfma_f32_16x16x32_bf16 v[76:79], a[68:71], v[16:19], v[76:79]
  ds_read_b128 v[16:19], v2 offset:20480
  buffer_store_dwordx4 v[36:39], v2, s[12:15], s58 offen offset:2048
  s_waitcnt lgkmcnt(3)
  v_mfma_f32_16x16x32_bf16 v[64:67], a[80:83], v[20:23], v[64:67]
  v_mfma_f32_16x16x32_bf16 v[72:75], a[84:87], v[20:23], v[72:75]
  ds_read_b128 v[20:23], v2 offset:7168
  s_waitcnt lgkmcnt(3)
  v_mfma_f32_16x16x32_bf16 v[68:71], a[80:83], v[24:27], v[68:71]
  v_mfma_f32_16x16x32_bf16 v[76:79], a[84:87], v[24:27], v[76:79]
  ds_read_b128 v[24:27], v2 offset:21504
  buffer_store_dwordx4 v[36:39], v8, s[12:15], s59 offen sc1
  s_waitcnt lgkmcnt(3)
  v_mfma_f32_16x16x32_bf16 v[64:67], a[96:99], v[12:15], v[64:67]
  v_mfma_f32_16x16x32_bf16 v[72:75], a[100:103], v[12:15], v[72:75]
  ds_read_b128 v[12:15], v2 offset:8192
  s_waitcnt lgkmcnt(3)
  v_mfma_f32_16x16x32_bf16 v[68:71], a[96:99], v[16:19], v[68:71]
  v_mfma_f32_16x16x32_bf16 v[76:79], a[100:103], v[16:19], v[76:79]
  ds_read_b128 v[16:19], v2 offset:22528
  buffer_store_dwordx4 v[36:39], v8, s[12:15], s60 offen sc1
  s_waitcnt lgkmcnt(3)
  v_mfma_f32_16x16x32_bf16 v[64:67], a[112:115], v[20:23], v[64:67]
  v_mfma_f32_16x16x32_bf16 v[72:75], a[116:119], v[20:23], v[72:75]
  ds_read_b128 v[20:23], v2 offset:9216
  s_waitcnt lgkmcnt(3)
  v_mfma_f32_16x16x32_bf16 v[68:71], a[112:115], v[24:27], v[68:71]
  v_mfma_f32_16x16x32_bf16 v[76:79], a[116:119], v[24:27], v[76:79]
  ds_read_b128 v[24:27], v2 offset:23552
  s_waitcnt lgkmcnt(3)
  v_mfma_f32_16x16x32_bf16 v[64:67], a[128:131], v[12:15], v[64:67]
  v_mfma_f32_16x16x32_bf16 v[72:75], a[132:135], v[12:15], v[72:75]
  ds_read_b128 v[12:15], v2 offset:10240
  s_waitcnt lgkmcnt(3)
  v_mfma_f32_16x16x32_bf16 v[68:71], a[128:131], v[16:19], v[68:71]
  v_mfma_f32_16x16x32_bf16 v[76:79], a[132:135], v[16:19], v[76:79]
  ds_read_b128 v[16:19], v2 offset:24576
  s_waitcnt lgkmcnt(3)
  v_mfma_f32_16x16x32_bf16 v[64:67], a[144:147], v[20:23], v[64:67]
  v_mfma_f32_16x16x32_bf16 v[72:75], a[148:151], v[20:23], v[72:75]
  ds_read_b128 v[20:23], v2 offset:11264
  s_waitcnt lgkmcnt(3)
  v_mfma_f32_16x16x32_bf16 v[68:71], a[144:147], v[24:27], v[68:71]
  v_mfma_f32_16x16x32_bf16 v[76:79], a[148:151], v[24:27], v[76:79]
  ds_read_b128 v[24:27], v2 offset:25600
  s_waitcnt lgkmcnt(3)
  v_mfma_f32_16x16x32_bf16 v[64:67], a[160:163], v[12:15], v[64:67]
  v_mfma_f32_16x16x32_bf16 v[72:75], a[164:167], v[12:15], v[72:75]
  ds_read_b128 v[12:15], v2 offset:12288
  s_waitcnt lgkmcnt(3)
  v_mfma_f32_16x16x32_bf16 v[68:71], a[160:163], v[16:19], v[68:71]
  v_mfma_f32_16x16x32_bf16 v[76:79], a[164:167], v[16:19], v[76:79]
  ds_read_b128 v[16:19], v2 offset:26624
  s_waitcnt lgkmcnt(3)
  v_mfma_f32_16x16x32_bf16 v[64:67], a[176:179], v[20:23], v[64:67]
  v_mfma_f32_16x16x32_bf16 v[72:75], a[180:183], v[20:23], v[72:75]
  ds_read_b128 v[20:23], v2 offset:13312
  s_waitcnt lgkmcnt(3)
  v_mfma_f32_16x16x32_bf16 v[68:71], a[176:179], v[24:27], v[68:71]
  v_mfma_f32_16x16x32_bf16 v[76:79], a[180:183], v[24:27], v[76:79]
  ds_read_b128 v[24:27], v2 offset:27648
  s_waitcnt lgkmcnt(3)
  v_mfma_f32_16x16x32_bf16 v[64:67], a[192:195], v[12:15], v[64:67]
  v_mfma_f32_16x16x32_bf16 v[72:75], a[196:199], v[12:15], v[72:75]
  ds_read_b128 v[12:15], v2 offset:0
  s_waitcnt lgkmcnt(3)
  v_mfma_f32_16x16x32_bf16 v[68:71], a[192:195], v[16:19], v[68:71]
  v_mfma_f32_16x16x32_bf16 v[76:79], a[196:199], v[16:19], v[76:79]
  ds_read_b128 v[16:19], v2 offset:14336
  s_waitcnt lgkmcnt(3)
  v_mfma_f32_16x16x32_bf16 v[64:67], a[208:211], v[20:23], v[64:67]
  v_mfma_f32_16x16x32_bf16 v[72:75], a[212:215], v[20:23], v[72:75]
  ds_read_b128 v[20:23], v2 offset:1024
  s_waitcnt lgkmcnt(3)
  v_mfma_f32_16x16x32_bf16 v[68:71], a[208:211], v[24:27], v[68:71]
  v_mul_f32 v56, v64, v9
  v_mul_f32 v57, v65, v9
  v_mfma_f32_16x16x32_bf16 v[76:79], a[212:215], v[24:27], v[76:79]
  ds_read_b128 v[24:27], v2 offset:15360
  v_mul_f32 v36, v66, v9
  s_waitcnt lgkmcnt(3)
  v_mfma_f32_16x16x32_bf16 v[40:43], a[8:11], v[12:15], 0
  v_mul_f32 v37, v67, v9
  v_mul_f32 v38, v72, v9
  v_mfma_f32_16x16x32_bf16 v[48:51], a[12:15], v[12:15], 0
  ds_read_b128 v[12:15], v2 offset:2048
  v_mul_f32 v39, v73, v9
  s_waitcnt lgkmcnt(3)
  v_mfma_f32_16x16x32_bf16 v[44:47], a[8:11], v[16:19], 0
  v_exp_f32 v56, v56
  v_mfma_f32_16x16x32_bf16 v[52:55], a[12:15], v[16:19], 0
  ds_read_b128 v[16:19], v2 offset:16384
  v_fma_f32 v56, v56, v58, v58
  s_waitcnt lgkmcnt(3)
  v_mfma_f32_16x16x32_bf16 v[40:43], a[24:27], v[20:23], v[40:43]
  v_exp_f32 v57, v57
  v_mfma_f32_16x16x32_bf16 v[48:51], a[28:31], v[20:23], v[48:51]
  ds_read_b128 v[20:23], v2 offset:3072
  v_fma_f32 v57, v57, v58, v58
  s_waitcnt lgkmcnt(3)
  v_mfma_f32_16x16x32_bf16 v[44:47], a[24:27], v[24:27], v[44:47]
  v_exp_f32 v36, v36
  v_mfma_f32_16x16x32_bf16 v[52:55], a[28:31], v[24:27], v[52:55]
  ds_read_b128 v[24:27], v2 offset:17408
  v_fma_f32 v36, v36, v58, v58
  s_waitcnt lgkmcnt(3)
  v_mfma_f32_16x16x32_bf16 v[40:43], a[40:43], v[12:15], v[40:43]
  v_exp_f32 v37, v37
  v_mfma_f32_16x16x32_bf16 v[48:51], a[44:47], v[12:15], v[48:51]
  ds_read_b128 v[12:15], v2 offset:4096
  v_fma_f32 v37, v37, v58, v58
  s_waitcnt lgkmcnt(3)
  v_mfma_f32_16x16x32_bf16 v[44:47], a[40:43], v[16:19], v[44:47]
  v_rcp_f32 v56, v56
  v_mfma_f32_16x16x32_bf16 v[52:55], a[44:47], v[16:19], v[52:55]
  ds_read_b128 v[16:19], v2 offset:18432
  v_mul_f32 v64, v64, v56
  s_waitcnt lgkmcnt(3)
  v_mfma_f32_16x16x32_bf16 v[40:43], a[56:59], v[20:23], v[40:43]
  v_rcp_f32 v57, v57
  v_mfma_f32_16x16x32_bf16 v[48:51], a[60:63], v[20:23], v[48:51]
  ds_read_b128 v[20:23], v2 offset:5120
  v_mul_f32 v65, v65, v57
  s_waitcnt lgkmcnt(3)
  v_mfma_f32_16x16x32_bf16 v[44:47], a[56:59], v[24:27], v[44:47]
  v_rcp_f32 v36, v36
  v_mfma_f32_16x16x32_bf16 v[52:55], a[60:63], v[24:27], v[52:55]
  ds_read_b128 v[24:27], v2 offset:19456
  v_mul_f32 v66, v66, v36
  s_waitcnt lgkmcnt(3)
  v_mfma_f32_16x16x32_bf16 v[40:43], a[72:75], v[12:15], v[40:43]
  v_rcp_f32 v37, v37
  v_mfma_f32_16x16x32_bf16 v[48:51], a[76:79], v[12:15], v[48:51]
  ds_read_b128 v[12:15], v2 offset:6144
  v_mul_f32 v67, v67, v37
  s_waitcnt lgkmcnt(3)
  v_mfma_f32_16x16x32_bf16 v[44:47], a[72:75], v[16:19], v[44:47]
  v_mul_f32 v56, v74, v9
  v_mul_f32 v57, v75, v9
  v_mfma_f32_16x16x32_bf16 v[52:55], a[76:79], v[16:19], v[52:55]
  ds_read_b128 v[16:19], v2 offset:20480
  v_mul_f32 v36, v68, v10
  s_waitcnt lgkmcnt(3)
  v_mfma_f32_16x16x32_bf16 v[40:43], a[88:91], v[20:23], v[40:43]
  v_mul_f32 v37, v69, v10
  v_cvt_pk_bf16_f32 v60, v64, v65
  v_mfma_f32_16x16x32_bf16 v[48:51], a[92:95], v[20:23], v[48:51]
  ds_read_b128 v[20:23], v2 offset:7168
  v_cvt_pk_bf16_f32 v61, v66, v67
  s_waitcnt lgkmcnt(3)
  v_mfma_f32_16x16x32_bf16 v[44:47], a[88:91], v[24:27], v[44:47]
  v_exp_f32 v38, v38
  v_mfma_f32_16x16x32_bf16 v[52:55], a[92:95], v[24:27], v[52:55]
  ds_read_b128 v[24:27], v2 offset:21504
  v_fma_f32 v38, v38, v58, v58
  s_waitcnt lgkmcnt(3)
  v_mfma_f32_16x16x32_bf16 v[40:43], a[104:107], v[12:15], v[40:43]
  v_exp_f32 v39, v39
  v_mfma_f32_16x16x32_bf16 v[48:51], a[108:111], v[12:15], v[48:51]
  ds_read_b128 v[12:15], v2 offset:8192
  v_fma_f32 v39, v39, v58, v58
  s_waitcnt lgkmcnt(3)
  v_mfma_f32_16x16x32_bf16 v[44:47], a[104:107], v[16:19], v[44:47]
  v_exp_f32 v56, v56
  v_mfma_f32_16x16x32_bf16 v[52:55], a[108:111], v[16:19], v[52:55]
  ds_read_b128 v[16:19], v2 offset:22528
  v_fma_f32 v56, v56, v58, v58
  s_waitcnt lgkmcnt(3)
  v_mfma_f32_16x16x32_bf16 v[40:43], a[120:123], v[20:23], v[40:43]
  v_exp_f32 v57, v57
  v_mfma_f32_16x16x32_bf16 v[48:51], a[124:127], v[20:23], v[48:51]
  ds_read_b128 v[20:23], v2 offset:9216
  v_fma_f32 v57, v57, v58, v58
  s_waitcnt lgkmcnt(3)
  v_mfma_f32_16x16x32_bf16 v[44:47], a[120:123], v[24:27], v[44:47]
  v_exp_f32 v36, v36
  v_mfma_f32_16x16x32_bf16 v[52:55], a[124:127], v[24:27], v[52:55]
  ds_read_b128 v[24:27], v2 offset:23552
  v_fma_f32 v36, v36, v59, v59
  s_waitcnt lgkmcnt(3)
  v_mfma_f32_16x16x32_bf16 v[40:43], a[136:139], v[12:15], v[40:43]
  v_exp_f32 v37, v37
  v_mfma_f32_16x16x32_bf16 v[48:51], a[140:143], v[12:15], v[48:51]
  ds_read_b128 v[12:15], v2 offset:10240
  v_fma_f32 v37, v37, v59, v59
  s_waitcnt lgkmcnt(3)
  v_mfma_f32_16x16x32_bf16 v[44:47], a[136:139], v[16:19], v[44:47]
  v_rcp_f32 v38, v38
  v_mfma_f32_16x16x32_bf16 v[52:55], a[140:143], v[16:19], v[52:55]
  ds_read_b128 v[16:19], v2 offset:24576
  v_mul_f32 v72, v72, v38
  s_waitcnt lgkmcnt(3)
  v_mfma_f32_16x16x32_bf16 v[40:43], a[152:155], v[20:23], v[40:43]
  v_rcp_f32 v39, v39
  v_mfma_f32_16x16x32_bf16 v[48:51], a[156:159], v[20:23], v[48:51]
  ds_read_b128 v[20:23], v2 offset:11264
  v_mul_f32 v73, v73, v39
  s_waitcnt lgkmcnt(3)
  v_mfma_f32_16x16x32_bf16 v[44:47], a[152:155], v[24:27], v[44:47]
  v_rcp_f32 v56, v56
  v_mfma_f32_16x16x32_bf16 v[52:55], a[156:159], v[24:27], v[52:55]
  ds_read_b128 v[24:27], v2 offset:25600
  v_mul_f32 v74, v74, v56
  s_waitcnt lgkmcnt(3)
  v_mfma_f32_16x16x32_bf16 v[40:43], a[168:171], v[12:15], v[40:43]
  v_rcp_f32 v57, v57
  v_mfma_f32_16x16x32_bf16 v[48:51], a[172:175], v[12:15], v[48:51]
  ds_read_b128 v[12:15], v2 offset:12288
  v_mul_f32 v75, v75, v57
  s_waitcnt lgkmcnt(3)
  v_mfma_f32_16x16x32_bf16 v[44:47], a[168:171], v[16:19], v[44:47]
  v_rcp_f32 v36, v36
  v_mfma_f32_16x16x32_bf16 v[52:55], a[172:175], v[16:19], v[52:55]
  ds_read_b128 v[16:19], v2 offset:26624
  v_mul_f32 v68, v68, v36
  s_waitcnt lgkmcnt(3)
  v_mfma_f32_16x16x32_bf16 v[40:43], a[184:187], v[20:23], v[40:43]
  v_rcp_f32 v37, v37
  v_mfma_f32_16x16x32_bf16 v[48:51], a[188:191], v[20:23], v[48:51]
  ds_read_b128 v[20:23], v2 offset:13312
  v_mul_f32 v69, v69, v37
  s_waitcnt lgkmcnt(3)
  v_mfma_f32_16x16x32_bf16 v[44:47], a[184:187], v[24:27], v[44:47]
  v_mul_f32 v38, v70, v10
  v_mul_f32 v39, v71, v10
  v_mfma_f32_16x16x32_bf16 v[52:55], a[188:191], v[24:27], v[52:55]
  ds_read_b128 v[24:27], v2 offset:27648
  v_mul_f32 v56, v76, v10
  s_waitcnt lgkmcnt(3)
  v_mfma_f32_16x16x32_bf16 v[40:43], a[200:203], v[12:15], v[40:43]
  v_mul_f32 v57, v77, v10
  v_mul_f32 v36, v78, v10
  v_mfma_f32_16x16x32_bf16 v[48:51], a[204:207], v[12:15], v[48:51]
  v_mul_f32 v37, v79, v10
  v_cvt_pk_bf16_f32 v62, v72, v73
  s_waitcnt lgkmcnt(2)
  v_mfma_f32_16x16x32_bf16 v[44:47], a[200:203], v[16:19], v[44:47]
  v_exp_f32 v38, v38
  v_mfma_f32_16x16x32_bf16 v[52:55], a[204:207], v[16:19], v[52:55]
  v_exp_f32 v39, v39
  s_waitcnt lgkmcnt(1)
  v_mfma_f32_16x16x32_bf16 v[40:43], a[216:219], v[20:23], v[40:43]
  v_exp_f32 v56, v56
  v_mfma_f32_16x16x32_bf16 v[48:51], a[220:223], v[20:23], v[48:51]
  v_exp_f32 v57, v57
  s_waitcnt lgkmcnt(0)
  v_mfma_f32_16x16x32_bf16 v[44:47], a[216:219], v[24:27], v[44:47]
  v_exp_f32 v36, v36
  v_mfma_f32_16x16x32_bf16 v[52:55], a[220:223], v[24:27], v[52:55]
  v_exp_f32 v37, v37
  v_fma_f32 v38, v38, v59, v59
  v_fma_f32 v39, v39, v59, v59
  v_fma_f32 v56, v56, v59, v59
  v_fma_f32 v57, v57, v59, v59
  v_fma_f32 v36, v36, v59, v59
  v_fma_f32 v37, v37, v59, v59
  v_rcp_f32 v38, v38
  v_rcp_f32 v39, v39
  v_rcp_f32 v56, v56
  v_rcp_f32 v57, v57
  v_rcp_f32 v36, v36
  v_rcp_f32 v37, v37
  v_cvt_pk_bf16_f32 v63, v74, v75
  ds_write_b128 v6, v[60:63] offset:0
  v_mul_f32 v70, v70, v38
  v_mul_f32 v71, v71, v39
  v_mul_f32 v76, v76, v56
  v_mul_f32 v77, v77, v57
  v_mul_f32 v78, v78, v36
  v_mul_f32 v79, v79, v37
  v_cvt_pk_bf16_f32 v60, v68, v69
  v_cvt_pk_bf16_f32 v61, v70, v71
  v_cvt_pk_bf16_f32 v62, v76, v77
  v_cvt_pk_bf16_f32 v63, v78, v79
  ds_write_b128 v6, v[60:63] offset:1024
  s_waitcnt lgkmcnt(0)
  s_barrier
  ds_read_b128 v[12:15], v7 offset:0
  ds_read_b128 v[16:19], v7 offset:1024
  ds_read_b128 v[20:23], v7 offset:2048
  ds_read_b128 v[24:27], v7 offset:3072
  v_mul_f32 v56, v40, v9
  v_mul_f32 v57, v41, v9
  v_mul_f32 v36, v42, v9
  v_mul_f32 v37, v43, v9
  v_exp_f32 v56, v56
  v_exp_f32 v57, v57
  v_exp_f32 v36, v36
  v_exp_f32 v37, v37
  v_fma_f32 v56, v56, v58, v58
  v_fma_f32 v57, v57, v58, v58
  v_fma_f32 v36, v36, v58, v58
  v_fma_f32 v37, v37, v58, v58
  v_rcp_f32 v56, v56
  v_rcp_f32 v57, v57
  v_rcp_f32 v36, v36
  s_waitcnt lgkmcnt(3)
  v_mfma_f32_16x16x32_bf16 v[64:67], a[224:227], v[12:15], 0
  v_rcp_f32 v37, v37
  v_mfma_f32_16x16x32_bf16 v[72:75], a[228:231], v[12:15], 0
  v_mul_f32 v40, v40, v56
  v_mul_f32 v41, v41, v57
  v_mfma_f32_16x16x32_bf16 v[80:83], a[232:235], v[12:15], 0
  v_mul_f32 v42, v42, v36
  v_mul_f32 v43, v43, v37
  v_mfma_f32_16x16x32_bf16 v[88:91], a[236:239], v[12:15], 0
  v_mul_f32 v38, v48, v9
  v_mul_f32 v39, v49, v9
  v_mfma_f32_16x16x32_bf16 v[96:99], a[240:243], v[12:15], 0
  v_mul_f32 v56, v50, v9
  v_mul_f32 v57, v51, v9
  v_mfma_f32_16x16x32_bf16 v[104:107], a[244:247], v[12:15], 0
  v_mul_f32 v36, v44, v10
  v_mul_f32 v37, v45, v10
  v_mfma_f32_16x16x32_bf16 v[112:115], a[248:251], v[12:15], 0
  ds_read_b128 v[12:15], v7 offset:4096
  v_cvt_pk_bf16_f32 v60, v40, v41
  s_waitcnt lgkmcnt(1)
  v_mfma_f32_16x16x32_bf16 v[68:71], a[224:227], v[16:19], 0
  v_exp_f32 v38, v38
  v_mfma_f32_16x16x32_bf16 v[76:79], a[228:231], v[16:19], 0
  v_exp_f32 v39, v39
  v_mfma_f32_16x16x32_bf16 v[84:87], a[232:235], v[16:19], 0
  v_exp_f32 v56, v56
  v_mfma_f32_16x16x32_bf16 v[92:95], a[236:239], v[16:19], 0
  v_exp_f32 v57, v57
  v_mfma_f32_16x16x32_bf16 v[100:103], a[240:243], v[16:19], 0
  v_exp_f32 v36, v36
  v_mfma_f32_16x16x32_bf16 v[108:111], a[244:247], v[16:19], 0
  v_exp_f32 v37, v37
  v_mfma_f32_16x16x32_bf16 v[116:119], a[248:251], v[16:19], 0
  ds_read_b128 v[16:19], v7 offset:5120
  v_fma_f32 v38, v38, v58, v58
  v_mfma_f32_16x16x32_bf16 v[64:67], a[252:255], v[20:23], v[64:67]
  v_fma_f32 v39, v39, v58, v58
  v_fma_f32 v56, v56, v58, v58
  v_mfma_f32_16x16x32_bf16 v[72:75], v[120:123], v[20:23], v[72:75]
  v_fma_f32 v57, v57, v58, v58
  v_fma_f32 v36, v36, v59, v59
  v_mfma_f32_16x16x32_bf16 v[80:83], v[124:127], v[20:23], v[80:83]
  v_fma_f32 v37, v37, v59, v59
  v_cvt_pk_bf16_f32 v61, v42, v43
  v_mfma_f32_16x16x32_bf16 v[88:91], v[128:131], v[20:23], v[88:91]
  v_rcp_f32 v38, v38
  v_mfma_f32_16x16x32_bf16 v[96:99], v[132:135], v[20:23], v[96:99]
  v_rcp_f32 v39, v39
  v_mfma_f32_16x16x32_bf16 v[104:107], v[136:139], v[20:23], v[104:107]
  v_rcp_f32 v56, v56
  v_mfma_f32_16x16x32_bf16 v[112:115], v[140:143], v[20:23], v[112:115]
  ds_read_b128 v[20:23], v7 offset:6144
  v_mul_f32 v48, v48, v38
  v_mfma_f32_16x16x32_bf16 v[68:71], a[252:255], v[24:27], v[68:71]
  v_rcp_f32 v57, v57
  v_mfma_f32_16x16x32_bf16 v[76:79], v[120:123], v[24:27], v[76:79]
  v_rcp_f32 v36, v36
  v_mfma_f32_16x16x32_bf16 v[84:87], v[124:127], v[24:27], v[84:87]
  v_rcp_f32 v37, v37
  v_mfma_f32_16x16x32_bf16 v[92:95], v[128:131], v[24:27], v[92:95]
  v_mul_f32 v49, v49, v39
  v_mul_f32 v50, v50, v56
  v_mfma_f32_16x16x32_bf16 v[100:103], v[132:135], v[24:27], v[100:103]
  v_mul_f32 v51, v51, v57
  v_mul_f32 v44, v44, v36
  v_mfma_f32_16x16x32_bf16 v[108:111], v[136:139], v[24:27], v[108:111]
  v_mul_f32 v45, v45, v37
  v_mul_f32 v38, v46, v10
  v_mfma_f32_16x16x32_bf16 v[116:119], v[140:143], v[24:27], v[116:119]
  ds_read_b128 v[24:27], v7 offset:7168
  v_mul_f32 v39, v47, v10
  s_waitcnt lgkmcnt(2)
  v_mfma_f32_16x16x32_bf16 v[64:67], v[144:147], v[12:15], v[64:67]
  v_mul_f32 v56, v52, v10
  v_mul_f32 v57, v53, v10
  v_mfma_f32_16x16x32_bf16 v[68:71], v[144:147], v[16:19], v[68:71]
  v_mul_f32 v36, v54, v10
  v_mul_f32 v37, v55, v10
  v_mfma_f32_16x16x32_bf16 v[72:75], v[148:151], v[12:15], v[72:75]
  v_exp_f32 v38, v38
  v_mfma_f32_16x16x32_bf16 v[76:79], v[148:151], v[16:19], v[76:79]
  v_exp_f32 v39, v39
  v_mfma_f32_16x16x32_bf16 v[80:83], v[152:155], v[12:15], v[80:83]
  v_exp_f32 v56, v56
  v_mfma_f32_16x16x32_bf16 v[84:87], v[152:155], v[16:19], v[84:87]
  v_exp_f32 v57, v57
  v_mfma_f32_16x16x32_bf16 v[88:91], v[156:159], v[12:15], v[88:91]
  v_exp_f32 v36, v36
  v_mfma_f32_16x16x32_bf16 v[92:95], v[156:159], v[16:19], v[92:95]
  v_exp_f32 v37, v37
  v_mfma_f32_16x16x32_bf16 v[96:99], v[160:163], v[12:15], v[96:99]
  v_fma_f32 v38, v38, v59, v59
  v_fma_f32 v39, v39, v59, v59
  v_mfma_f32_16x16x32_bf16 v[100:103], v[160:163], v[16:19], v[100:103]
  v_fma_f32 v56, v56, v59, v59
  v_fma_f32 v57, v57, v59, v59
  v_mfma_f32_16x16x32_bf16 v[104:107], v[164:167], v[12:15], v[104:107]
  v_fma_f32 v36, v36, v59, v59
  v_fma_f32 v37, v37, v59, v59
  v_mfma_f32_16x16x32_bf16 v[108:111], v[164:167], v[16:19], v[108:111]
  v_rcp_f32 v38, v38
  v_mfma_f32_16x16x32_bf16 v[112:115], v[168:171], v[12:15], v[112:115]
  v_rcp_f32 v39, v39
  v_mfma_f32_16x16x32_bf16 v[116:119], v[168:171], v[16:19], v[116:119]
  v_rcp_f32 v56, v56
  s_waitcnt lgkmcnt(0)
  v_mfma_f32_16x16x32_bf16 v[64:67], v[172:175], v[20:23], v[64:67]
  v_rcp_f32 v57, v57
  v_mfma_f32_16x16x32_bf16 v[68:71], v[172:175], v[24:27], v[68:71]
  v_rcp_f32 v36, v36
  v_mfma_f32_16x16x32_bf16 v[72:75], v[176:179], v[20:23], v[72:75]
  v_rcp_f32 v37, v37
  v_mfma_f32_16x16x32_bf16 v[76:79], v[176:179], v[24:27], v[76:79]
  v_cvt_pk_bf16_f32 v62, v48, v49
  v_cvt_pk_bf16_f32 v63, v50, v51
  v_mfma_f32_16x16x32_bf16 v[80:83], v[180:183], v[20:23], v[80:83]
  ds_write_b128 v6, v[60:63] offset:8192
  v_mul_f32 v46, v46, v38
  v_mfma_f32_16x16x32_bf16 v[84:87], v[180:183], v[24:27], v[84:87]
  v_mul_f32 v47, v47, v39
  v_mul_f32 v52, v52, v56
  v_mfma_f32_16x16x32_bf16 v[88:91], v[184:187], v[20:23], v[88:91]
  v_mul_f32 v53, v53, v57
  v_mul_f32 v54, v54, v36
  v_mfma_f32_16x16x32_bf16 v[92:95], v[184:187], v[24:27], v[92:95]
  v_mul_f32 v55, v55, v37
  v_cvt_pk_bf16_f32 v60, v44, v45
  v_mfma_f32_16x16x32_bf16 v[96:99], v[188:191], v[20:23], v[96:99]
  v_cvt_pk_bf16_f32 v61, v46, v47
  v_cvt_pk_bf16_f32 v62, v52, v53
  v_mfma_f32_16x16x32_bf16 v[100:103], v[188:191], v[24:27], v[100:103]
  v_cvt_pk_bf16_f32 v63, v54, v55
  ds_write_b128 v6, v[60:63] offset:9216
  v_mfma_f32_16x16x32_bf16 v[104:107], v[192:195], v[20:23], v[104:107]
  v_mfma_f32_16x16x32_bf16 v[108:111], v[192:195], v[24:27], v[108:111]
  v_mfma_f32_16x16x32_bf16 v[112:115], v[196:199], v[20:23], v[112:115]
  v_mfma_f32_16x16x32_bf16 v[116:119], v[196:199], v[24:27], v[116:119]
  s_waitcnt lgkmcnt(0)
  s_barrier
  s_waitcnt vmcnt(0)
  s_add_u32 s28, s25, s48
  s_add_u32 s54, s28, 14336
  s_add_u32 s29, s25, s49
  s_add_u32 s55, s29, 14336
  ds_read_b128 v[12:15], v7 offset:8192
  ds_read_b128 v[16:19], v7 offset:9216
  ds_read_b128 v[20:23], v7 offset:10240
  ds_read_b128 v[24:27], v7 offset:11264
  s_waitcnt lgkmcnt(3)
  v_mfma_f32_16x16x32_bf16 v[64:67], v[200:203], v[12:15], v[64:67]
  v_mfma_f32_16x16x32_bf16 v[72:75], v[204:207], v[12:15], v[72:75]
  v_mfma_f32_16x16x32_bf16 v[80:83], v[208:211], v[12:15], v[80:83]
  v_mfma_f32_16x16x32_bf16 v[88:91], v[212:215], v[12:15], v[88:91]
  v_mfma_f32_16x16x32_bf16 v[96:99], v[216:219], v[12:15], v[96:99]
  v_mfma_f32_16x16x32_bf16 v[104:107], v[220:223], v[12:15], v[104:107]
  v_mfma_f32_16x16x32_bf16 v[112:115], v[224:227], v[12:15], v[112:115]
  ds_read_b128 v[12:15], v7 offset:12288
  s_waitcnt lgkmcnt(1)
  v_mfma_f32_16x16x32_bf16 v[68:71], v[200:203], v[16:19], v[68:71]
  v_mfma_f32_16x16x32_bf16 v[76:79], v[204:207], v[16:19], v[76:79]
  v_mfma_f32_16x16x32_bf16 v[84:87], v[208:211], v[16:19], v[84:87]
  v_mfma_f32_16x16x32_bf16 v[92:95], v[212:215], v[16:19], v[92:95]
  v_mfma_f32_16x16x32_bf16 v[100:103], v[216:219], v[16:19], v[100:103]
  v_mfma_f32_16x16x32_bf16 v[108:111], v[220:223], v[16:19], v[108:111]
  v_mfma_f32_16x16x32_bf16 v[116:119], v[224:227], v[16:19], v[116:119]
  ds_read_b128 v[16:19], v7 offset:13312
  v_mfma_f32_16x16x32_bf16 v[64:67], v[228:231], v[20:23], v[64:67]
  v_mfma_f32_16x16x32_bf16 v[72:75], v[232:235], v[20:23], v[72:75]
  v_mfma_f32_16x16x32_bf16 v[80:83], v[236:239], v[20:23], v[80:83]
  v_mfma_f32_16x16x32_bf16 v[88:91], v[240:243], v[20:23], v[88:91]
  v_mfma_f32_16x16x32_bf16 v[96:99], v[244:247], v[20:23], v[96:99]
  v_mfma_f32_16x16x32_bf16 v[104:107], v[248:251], v[20:23], v[104:107]
  v_mfma_f32_16x16x32_bf16 v[112:115], v[252:255], v[20:23], v[112:115]
  ds_read_b128 v[20:23], v7 offset:14336
  v_mfma_f32_16x16x32_bf16 v[68:71], v[228:231], v[24:27], v[68:71]
  v_mfma_f32_16x16x32_bf16 v[76:79], v[232:235], v[24:27], v[76:79]
  v_mfma_f32_16x16x32_bf16 v[84:87], v[236:239], v[24:27], v[84:87]
  v_mfma_f32_16x16x32_bf16 v[92:95], v[240:243], v[24:27], v[92:95]
  v_mfma_f32_16x16x32_bf16 v[100:103], v[244:247], v[24:27], v[100:103]
  v_mfma_f32_16x16x32_bf16 v[108:111], v[248:251], v[24:27], v[108:111]
  v_mfma_f32_16x16x32_bf16 v[116:119], v[252:255], v[24:27], v[116:119]
  ds_read_b128 v[24:27], v7 offset:15360
  ds_read_b128 v[28:31], v5 offset:0
  ds_read_b128 v[32:35], v5 offset:7168
  ds_read_b128 v[36:39], v5 offset:1024
  ds_read_b128 v[56:59], v5 offset:8192
  ds_read_b128 v[60:63], v5 offset:2048
  s_waitcnt lgkmcnt(4)
  v_mfma_f32_16x16x32_bf16 v[64:67], v[28:31], v[12:15], v[64:67]
  v_mfma_f32_16x16x32_bf16 v[68:71], v[28:31], v[16:19], v[68:71]
  ds_read_b128 v[28:31], v5 offset:9216
  s_waitcnt lgkmcnt(3)
  v_mfma_f32_16x16x32_bf16 v[64:67], v[32:35], v[20:23], v[64:67]
  v_mfma_f32_16x16x32_bf16 v[68:71], v[32:35], v[24:27], v[68:71]
  ds_read_b128 v[32:35], v5 offset:3072
  v_mfma_f32_16x16x32_bf16 v[72:75], v[36:39], v[12:15], v[72:75]
  v_cvt_pk_bf16_f32 v40, v64, v65
  v_cvt_pk_bf16_f32 v41, v66, v67
  v_mfma_f32_16x16x32_bf16 v[76:79], v[36:39], v[16:19], v[76:79]
  ds_read_b128 v[36:39], v5 offset:10240
  v_cvt_pk_bf16_f32 v44, v68, v69
  s_waitcnt lgkmcnt(3)
  v_mfma_f32_16x16x32_bf16 v[72:75], v[56:59], v[20:23], v[72:75]
  v_cvt_pk_bf16_f32 v45, v70, v71
  v_mfma_f32_16x16x32_bf16 v[76:79], v[56:59], v[24:27], v[76:79]
  ds_read_b128 v[56:59], v5 offset:4096
  v_mfma_f32_16x16x32_bf16 v[80:83], v[60:63], v[12:15], v[80:83]
  v_cvt_pk_bf16_f32 v42, v72, v73
  v_cvt_pk_bf16_f32 v43, v74, v75
  v_mfma_f32_16x16x32_bf16 v[84:87], v[60:63], v[16:19], v[84:87]
  ds_read_b128 v[60:63], v5 offset:11264
  buffer_store_dwordx4 v[40:43], v2, s[12:15], s28 offen offset:0
  s_waitcnt lgkmcnt(3)
  v_mfma_f32_16x16x32_bf16 v[88:91], v[32:35], v[12:15], v[88:91]
  v_cvt_pk_bf16_f32 v46, v76, v77
  v_cvt_pk_bf16_f32 v47, v78, v79
  v_mfma_f32_16x16x32_bf16 v[92:95], v[32:35], v[16:19], v[92:95]
  buffer_store_dwordx4 v[44:47], v2, s[12:15], s54 offen offset:0
  v_mfma_f32_16x16x32_bf16 v[80:83], v[28:31], v[20:23], v[80:83]
  v_mfma_f32_16x16x32_bf16 v[84:87], v[28:31], v[24:27], v[84:87]
  ds_read_b128 v[28:31], v5 offset:5120
  ds_read_b128 v[32:35], v5 offset:12288
  s_waitcnt lgkmcnt(4)
  v_mfma_f32_16x16x32_bf16 v[88:91], v[36:39], v[20:23], v[88:91]
  v_cvt_pk_bf16_f32 v48, v80, v81
  v_cvt_pk_bf16_f32 v49, v82, v83
  v_mfma_f32_16x16x32_bf16 v[92:95], v[36:39], v[24:27], v[92:95]
  ds_read_b128 v[36:39], v5 offset:6144
  v_cvt_pk_bf16_f32 v52, v84, v85
  s_waitcnt lgkmcnt(4)
  v_mfma_f32_16x16x32_bf16 v[96:99], v[56:59], v[12:15], v[96:99]
  v_cvt_pk_bf16_f32 v50, v88, v89
  v_cvt_pk_bf16_f32 v51, v90, v91
  v_mfma_f32_16x16x32_bf16 v[100:103], v[56:59], v[16:19], v[100:103]
  ds_read_b128 v[56:59], v5 offset:13312
  buffer_store_dwordx4 v[48:51], v2, s[12:15], s28 offen offset:1024
  s_waitcnt lgkmcnt(4)
  v_mfma_f32_16x16x32_bf16 v[96:99], v[60:63], v[20:23], v[96:99]
  v_cvt_pk_bf16_f32 v53, v86, v87
  v_cvt_pk_bf16_f32 v54, v92, v93
  v_mfma_f32_16x16x32_bf16 v[100:103], v[60:63], v[24:27], v[100:103]
  v_cvt_pk_bf16_f32 v55, v94, v95
  buffer_store_dwordx4 v[52:55], v2, s[12:15], s54 offen offset:1024
  s_waitcnt lgkmcnt(3)
  v_mfma_f32_16x16x32_bf16 v[104:107], v[28:31], v[12:15], v[104:107]
  v_cvt_pk_bf16_f32 v40, v96, v97
  v_cvt_pk_bf16_f32 v41, v98, v99
  v_mfma_f32_16x16x32_bf16 v[108:111], v[28:31], v[16:19], v[108:111]
  v_cvt_pk_bf16_f32 v44, v100, v101
  v_cvt_pk_bf16_f32 v45, v102, v103
  s_waitcnt lgkmcnt(1)
  v_mfma_f32_16x16x32_bf16 v[112:115], v[36:39], v[12:15], v[112:115]
  v_mfma_f32_16x16x32_bf16 v[104:107], v[32:35], v[20:23], v[104:107]
  v_mfma_f32_16x16x32_bf16 v[116:119], v[36:39], v[16:19], v[116:119]
  v_mfma_f32_16x16x32_bf16 v[108:111], v[32:35], v[24:27], v[108:111]
  v_cvt_pk_bf16_f32 v42, v104, v105
  v_cvt_pk_bf16_f32 v43, v106, v107
  s_waitcnt lgkmcnt(0)
  v_mfma_f32_16x16x32_bf16 v[112:115], v[56:59], v[20:23], v[112:115]
  buffer_store_dwordx4 v[40:43], v2, s[12:15], s28 offen offset:2048
  v_mfma_f32_16x16x32_bf16 v[116:119], v[56:59], v[24:27], v[116:119]
  v_cvt_pk_bf16_f32 v46, v108, v109
  v_cvt_pk_bf16_f32 v47, v110, v111
  buffer_store_dwordx4 v[44:47], v2, s[12:15], s54 offen offset:2048
  s_nop 0
  v_cvt_pk_bf16_f32 v48, v112, v113
  v_cvt_pk_bf16_f32 v49, v114, v115
  buffer_store_dwordx2 v[48:49], v2, s[12:15], s29 offen
  s_nop 0
  v_cvt_pk_bf16_f32 v52, v116, v117
  v_cvt_pk_bf16_f32 v53, v118, v119
  buffer_store_dwordx2 v[52:53], v2, s[12:15], s55 offen
  ds_read_b128 v[40:43], v8 offset:0
  s_mov_b32 s24, 0
FF_R_L:
  s_add_u32 s42, s26, 0
  buffer_load_dwordx4 v[64:67], v8, s[12:15], s42 offen sc1
  s_add_u32 s42, s26, 28672
  buffer_load_dwordx4 v[68:71], v8, s[12:15], s42 offen sc1
  s_add_u32 s42, s26, 57344
  buffer_load_dwordx4 v[72:75], v8, s[12:15], s42 offen sc1
  s_add_u32 s42, s26, 86016
  buffer_load_dwordx4 v[76:79], v8, s[12:15], s42 offen sc1
  s_add_u32 s42, s26, 114688
  buffer_load_dwordx4 v[80:83], v8, s[12:15], s42 offen sc1
  s_add_u32 s42, s26, 143360
  buffer_load_dwordx4 v[84:87], v8, s[12:15], s42 offen sc1
  s_add_u32 s42, s26, 172032
  buffer_load_dwordx4 v[88:91], v8, s[12:15], s42 offen sc1
  s_add_u32 s24, s24, 1
  s_cmp_gt_u32 s24, 131072
  s_mov_b32 s99, 15
  s_cbranch_scc1 FAIL
  s_waitcnt vmcnt(0)
  v_max3_u32 v4, v64, v65, v66
  v_max3_u32 v4, v4, v67, v68
  v_max3_u32 v4, v4, v69, v70
  v_max3_u32 v4, v4, v71, v72
  v_max3_u32 v4, v4, v73, v74
  v_max3_u32 v4, v4, v75, v76
  v_max3_u32 v4, v4, v77, v78
  v_max3_u32 v4, v4, v79, v80
  v_max3_u32 v4, v4, v81, v82
  v_max3_u32 v4, v4, v83, v84
  v_max3_u32 v4, v4, v85, v86
  v_max3_u32 v4, v4, v87, v88
  v_max3_u32 v4, v4, v89, v90
  v_max_u32 v4, v4, v91
  v_cmp_eq_u32 vcc, -1, v4
  s_cbranch_vccz FF_R_OK
  s_sleep 1
  s_branch FF_R_L
FF_R_OK:
  s_add_u32 s23, s23, 3
  s_cmp_lt_u32 s23, 64
  s_cselect_b32 s37, 86016, 0
  s_add_u32 s21, s21, s37
  s_add_u32 s22, s21, 4096
  buffer_load_dword v63, off, s[12:15], s43 sc1
  s_cmp_gt_u32 s38, 1
  s_cbranch_scc1 FF_NOE
  buffer_load_dwordx4 v[92:95], v2, s[12:15], s21 offen offset:0 sc1
  buffer_load_dwordx4 v[96:99], v2, s[12:15], s21 offen offset:1024 sc1
  buffer_load_dwordx4 v[100:103], v2, s[12:15], s21 offen offset:2048 sc1
  buffer_load_dwordx4 v[104:107], v2, s[12:15], s21 offen offset:3072 sc1
  buffer_load_dwordx4 v[108:111], v2, s[12:15], s22 offen offset:0 sc1
  buffer_load_dwordx4 v[112:115], v2, s[12:15], s22 offen offset:1024 sc1
  buffer_load_dwordx4 v[116:119], v2, s[12:15], s22 offen offset:2048 sc1
FF_NOE:
  s_waitcnt lgkmcnt(0)
  v_lshlrev_b32 v48, 16, v40
  v_and_b32 v49, 0xffff0000, v40
  v_lshlrev_b32 v50, 16, v41
  v_and_b32 v51, 0xffff0000, v41
  v_lshlrev_b32 v52, 16, v42
  v_and_b32 v53, 0xffff0000, v42
  v_lshlrev_b32 v54, 16, v43
  v_and_b32 v55, 0xffff0000, v43
  v_dot2_f32_bf16 v48, v64, s61, v48
  v_dot2_f32_bf16 v49, v64, s62, v49
  v_dot2_f32_bf16 v50, v65, s61, v50
  v_dot2_f32_bf16 v51, v65, s62, v51
  v_dot2_f32_bf16 v52, v66, s61, v52
  v_dot2_f32_bf16 v53, v66, s62, v53
  v_dot2_f32_bf16 v54, v67, s61, v54
  v_dot2_f32_bf16 v55, v67, s62, v55
  v_dot2_f32_bf16 v48, v68, s61, v48
  v_dot2_f32_bf16 v49, v68, s62, v49
  v_dot2_f32_bf16 v50, v69, s61, v50
  v_dot2_f32_bf16 v51, v69, s62, v51
  v_dot2_f32_bf16 v52, v70, s61, v52
  v_dot2_f32_bf16 v53, v70, s62, v53
  v_dot2_f32_bf16 v54, v71, s61, v54
  v_dot2_f32_bf16 v55, v71, s62, v55
  v_dot2_f32_bf16 v48, v72, s61, v48
  v_dot2_f32_bf16 v49, v72, s62, v49
  v_dot2_f32_bf16 v50, v73, s61, v50
  v_dot2_f32_bf16 v51, v73, s62, v51
  v_dot2_f32_bf16 v52, v74, s61, v52
  v_dot2_f32_bf16 v53, v74, s62, v53
  v_dot2_f32_bf16 v54, v75, s61, v54
  v_dot2_f32_bf16 v55, v75, s62, v55
  v_dot2_f32_bf16 v48, v76, s61, v48
  v_dot2_f32_bf16 v49, v76, s62, v49
  v_dot2_f32_bf16 v50, v77, s61, v50
  v_dot2_f32_bf16 v51, v77, s62, v51
  v_dot2_f32_bf16 v52, v78, s61, v52
  v_dot2_f32_bf16 v53, v78, s62, v53
  v_dot2_f32_bf16 v54, v79, s61, v54
  v_dot2_f32_bf16 v55, v79, s62, v55
  v_dot2_f32_bf16 v48, v80, s61, v48
  v_dot2_f32_bf16 v49, v80, s62, v49
  v_dot2_f32_bf16 v50, v81, s61, v50
  v_dot2_f32_bf16 v51, v81, s62, v51
  v_dot2_f32_bf16 v52, v82, s61, v52
  v_dot2_f32_bf16 v53, v82, s62, v53
  v_dot2_f32_bf16 v54, v83, s61, v54
  v_dot2_f32_bf16 v55, v83, s62, v55
  v_dot2_f32_bf16 v48, v84, s61, v48
  v_dot2_f32_bf16 v49, v84, s62, v49
  v_dot2_f32_bf16 v50, v85, s61, v50
  v_dot2_f32_bf16 v51, v85, s62, v51
  v_dot2_f32_bf16 v52, v86, s61, v52
  v_dot2_f32_bf16 v53, v86, s62, v53
  v_dot2_f32_bf16 v54, v87, s61, v54
  v_dot2_f32_bf16 v55, v87, s62, v55
  v_dot2_f32_bf16 v48, v88, s61, v48
  v_dot2_f32_bf16 v49, v88, s62, v49
  v_dot2_f32_bf16 v50, v89, s61, v50
  v_dot2_f32_bf16 v51, v89, s62, v51
  v_dot2_f32_bf16 v52, v90, s61, v52
  v_dot2_f32_bf16 v53, v90, s62, v53
  v_dot2_f32_bf16 v54, v91, s61, v54
  v_dot2_f32_bf16 v55, v91, s62, v55
  v_cvt_pk_bf16_f32 v40, v48, v49
  v_cvt_pk_bf16_f32 v41, v50, v51
  v_cvt_pk_bf16_f32 v42, v52, v53
  v_cvt_pk_bf16_f32 v43, v54, v55
  s_cmp_eq_u32 s16, 0
  s_cbranch_scc1 FF_R_LN
  s_mov_b64 exec, s[50:51]
  buffer_store_dwordx2 v[40:41], v0, s[44:47], s27 offen nt
  buffer_store_dwordx2 v[42:43], v0, s[44:47], s27 offen offset:32 nt
  s_mov_b64 exec, -1
  s_barrier
  s_branch FF_R_E
FF_R_LN:
  v_mov_b32 v64, 0
  v_mov_b32 v65, 0
  v_dot2_f32_bf16 v64, v40, s52, v64
  v_dot2_f32_bf16 v65, v40, v40, v65
  v_dot2_f32_bf16 v64, v41, s52, v64
  v_dot2_f32_bf16 v65, v41, v41, v65
  v_dot2_f32_bf16 v64, v42, s52, v64
  v_dot2_f32_bf16 v65, v42, v42, v65
  v_dot2_f32_bf16 v64, v43, s52, v64
  v_dot2_f32_bf16 v65, v43, v43, v65
  v_and_b32 v4, 3, v1
  v_lshlrev_b32 v4, 3, v4
  v_add_u32 v4, 102912, v4
  s_lshl_b32 s37, s3, 5
  v_add_u32 v68, s37, v4
  v_mul_f32 v64, v64, v11
  v_mul_f32 v65, v65, v11
  s_add_u32 s42, s27, 83968000
  v_add_f32_dpp v64, v64, v64 row_ror:4 row_mask:0xf bank_mask:0xf
  v_add_f32_dpp v65, v65, v65 row_ror:4 row_mask:0xf bank_mask:0xf
  s_nop 0
  v_add_f32_dpp v64, v64, v64 row_ror:8 row_mask:0xf bank_mask:0xf
  v_add_f32_dpp v65, v65, v65 row_ror:8 row_mask:0xf bank_mask:0xf
  v_mov_b32 v66, v64
  v_mov_b32 v67, v65
  s_nop 0
  v_permlane16_swap_b32 v64, v66
  v_permlane16_swap_b32 v65, v67
  v_add_f32 v64, v64, v66
  v_add_f32 v65, v65, v67
  v_mov_b32 v66, v64
  v_mov_b32 v67, v65
  s_nop 0
  v_permlane32_swap_b32 v64, v66
  v_permlane32_swap_b32 v65, v67
  v_add_f32 v64, v64, v66
  v_add_f32 v65, v65, v67
  ds_write_b64 v68, v[64:65]
  buffer_store_dwordx4 v[40:43], v8, s[12:15], s42 offen sc1
  v_lshlrev_b32 v48, 16, v40
  v_and_b32 v49, 0xffff0000, v40
  v_lshlrev_b32 v50, 16, v41
  v_and_b32 v51, 0xffff0000, v41
  v_lshlrev_b32 v52, 16, v42
  v_and_b32 v53, 0xffff0000, v42
  v_lshlrev_b32 v54, 16, v43
  v_and_b32 v55, 0xffff0000, v43
  s_waitcnt lgkmcnt(0)
  s_barrier
  ds_read2_b64 v[64:67], v4 offset0:0 offset1:4
  ds_read2_b64 v[68:71], v4 offset0:8 offset1:12
  s_add_u32 s42, s27, 78462976
  s_waitcnt lgkmcnt(0)
  v_pk_add_f32 v[64:65], v[64:65], v[66:67]
  v_pk_add_f32 v[68:69], v[68:69], v[70:71]
  v_pk_add_f32 v[64:65], v[64:65], v[68:69]
  v_mul_f32 v64, s53, v64
  v_mul_f32 v66, v64, v64
  v_fma_f32 v66, v65, s53, -v66
  v_max_f32 v66, 0, v66
  v_add_f32 v66, 0x3727c5ac, v66
  v_rsq_f32 v66, v66
  v_pk_add_f32 v[48:49], v[48:49], v[64:65] op_sel_hi:[1,0] neg_lo:[0,1] neg_hi:[0,1]
  v_pk_add_f32 v[50:51], v[50:51], v[64:65] op_sel_hi:[1,0] neg_lo:[0,1] neg_hi:[0,1]
  v_pk_add_f32 v[52:53], v[52:53], v[64:65] op_sel_hi:[1,0] neg_lo:[0,1] neg_hi:[0,1]
  v_pk_add_f32 v[54:55], v[54:55], v[64:65] op_sel_hi:[1,0] neg_lo:[0,1] neg_hi:[0,1]
  v_pk_mul_f32 v[48:49], v[48:49], v[66:67] op_sel_hi:[1,0]
  v_pk_mul_f32 v[50:51], v[50:51], v[66:67] op_sel_hi:[1,0]
  v_pk_mul_f32 v[52:53], v[52:53], v[66:67] op_sel_hi:[1,0]
  v_pk_mul_f32 v[54:55], v[54:55], v[66:67] op_sel_hi:[1,0]
  v_cvt_pk_bf16_f32 v68, v48, v49
  v_cvt_pk_bf16_f32 v69, v50, v51
  v_cvt_pk_bf16_f32 v70, v52, v53
  v_cvt_pk_bf16_f32 v71, v54, v55
  buffer_store_dwordx4 v[68:71], v8, s[12:15], s42 offen sc1
FF_R_E:
  s_cmp_gt_u32 s38, 1
  s_cbranch_scc0 FF_NOL
  buffer_load_dwordx4 v[92:95], v2, s[12:15], s21 offen offset:0 sc1
  buffer_load_dwordx4 v[96:99], v2, s[12:15], s21 offen offset:1024 sc1
  buffer_load_dwordx4 v[100:103], v2, s[12:15], s21 offen offset:2048 sc1
  buffer_load_dwordx4 v[104:107], v2, s[12:15], s21 offen offset:3072 sc1
  buffer_load_dwordx4 v[108:111], v2, s[12:15], s22 offen offset:0 sc1
  buffer_load_dwordx4 v[112:115], v2, s[12:15], s22 offen offset:1024 sc1
  buffer_load_dwordx4 v[116:119], v2, s[12:15], s22 offen offset:2048 sc1
  s_waitcnt vmcnt(0)
FF_NOL:
  s_add_u32 s25, s25, s56
  s_add_u32 s26, s26, s56
  s_add_u32 s41, s41, 1
  s_cmp_eq_u32 s41, 3
  s_cselect_b32 s41, 0, s41
  s_add_u32 s27, s27, 86016
  s_add_u32 s63, s63, 1
  s_cmp_lt_u32 s23, 64
  s_cbranch_scc1 FF_TASK
  s_endpgm
FF_ACK:
  s_mov_b32 s24, 0
FF_ACK_L:
  buffer_load_dword v63, off, s[12:15], s43 sc1
  s_add_u32 s24, s24, 1
  s_cmp_gt_u32 s24, 131072
  s_mov_b32 s99, 16
  s_cbranch_scc1 FAIL
  s_waitcnt vmcnt(0)
  v_cmp_gt_i32 vcc, s63, v63
  s_cbranch_vccnz FF_ACK_L
  s_branch FF_ACKED
FR:
  s_mul_i32 s21, s16, 1835008
  s_add_u32 s21, s21, 80297984
  s_mov_b32 s27, 0
  s_mov_b32 s23, 0
  s_mov_b32 s63, 0
  s_mov_b32 s54, 0
  v_mov_b32 v36, -1
  v_mov_b32 v37, -1
  v_mov_b32 v38, -1
  v_mov_b32 v39, -1
  s_add_u32 s59, s27, 78635008
  s_add_u32 s60, s27, 84140032
  s_lshl_b32 s37, s16, 6
  s_add_u32 s37, s37, s23
  s_cmp_lt_u32 s37, 58
  s_cselect_b32 s59, s59, 2147418112
  s_cselect_b32 s60, s60, 2147418112
  buffer_store_dwordx4 v[36:39], v8, s[12:15], s59 offen sc1
  buffer_store_dwordx4 v[36:39], v8, s[12:15], s60 offen sc1
FR_L:
  s_mul_i32 s37, s16, 3
  s_add_u32 s37, s37, s54
  s_mul_i32 s26, s37, 200704
  s_mul_i32 s39, s41, 1204224
  s_add_u32 s26, s26, s39
  s_add_u32 s26, s26, 91473920
  s_lshl_b32 s55, s37, 7
  s_add_u32 s55, s55, 91472896
  s_mov_b32 s24, 0
FR_R_L:
  s_add_u32 s42, s26, 0
  buffer_load_dwordx4 v[64:67], v8, s[12:15], s42 offen sc1
  s_add_u32 s42, s26, 28672
  buffer_load_dwordx4 v[68:71], v8, s[12:15], s42 offen sc1
  s_add_u32 s42, s26, 57344
  buffer_load_dwordx4 v[72:75], v8, s[12:15], s42 offen sc1
  s_add_u32 s42, s26, 86016
  buffer_load_dwordx4 v[76:79], v8, s[12:15], s42 offen sc1
  s_add_u32 s42, s26, 114688
  buffer_load_dwordx4 v[80:83], v8, s[12:15], s42 offen sc1
  s_add_u32 s42, s26, 143360
  buffer_load_dwordx4 v[84:87], v8, s[12:15], s42 offen sc1
  s_add_u32 s42, s26, 172032
  buffer_load_dwordx4 v[88:91], v8, s[12:15], s42 offen sc1
  buffer_load_dwordx4 v[40:43], v8, s[12:15], s21 offen sc1
  s_add_u32 s24, s24, 1
  s_cmp_gt_u32 s24, 131072
  s_mov_b32 s99, 15
  s_cbranch_scc1 FAIL
  s_waitcnt vmcnt(0)
  v_max3_u32 v4, v64, v65, v66
  v_max3_u32 v4, v4, v67, v68
  v_max3_u32 v4, v4, v69, v70
  v_max3_u32 v4, v4, v71, v72
  v_max3_u32 v4, v4, v73, v74
  v_max3_u32 v4, v4, v75, v76
  v_max3_u32 v4, v4, v77, v78
  v_max3_u32 v4, v4, v79, v80
  v_max3_u32 v4, v4, v81, v82
  v_max3_u32 v4, v4, v83, v84
  v_max3_u32 v4, v4, v85, v86
  v_max3_u32 v4, v4, v87, v88
  v_max3_u32 v4, v4, v89, v90
  v_max3_u32 v4, v4, v91, v40
  v_max3_u32 v4, v4, v41, v42
  v_max_u32 v4, v4, v43
  v_cmp_eq_u32 vcc, -1, v4
  s_cbranch_vccz FR_R_OK
  s_sleep 1
  s_branch FR_R_L
FR_R_OK:
  v_lshlrev_b32 v48, 16, v40
  v_and_b32 v49, 0xffff0000, v40
  v_lshlrev_b32 v50, 16, v41
  v_and_b32 v51, 0xffff0000, v41
  v_lshlrev_b32 v52, 16, v42
  v_and_b32 v53, 0xffff0000, v42
  v_lshlrev_b32 v54, 16, v43
  v_and_b32 v55, 0xffff0000, v43
  v_dot2_f32_bf16 v48, v64, s61, v48
  v_dot2_f32_bf16 v49, v64, s62, v49
  v_dot2_f32_bf16 v50, v65, s61, v50
  v_dot2_f32_bf16 v51, v65, s62, v51
  v_dot2_f32_bf16 v52, v66, s61, v52
  v_dot2_f32_bf16 v53, v66, s62, v53
  v_dot2_f32_bf16 v54, v67, s61, v54
  v_dot2_f32_bf16 v55, v67, s62, v55
  v_dot2_f32_bf16 v48, v68, s61, v48
  v_dot2_f32_bf16 v49, v68, s62, v49
  v_dot2_f32_bf16 v50, v69, s61, v50
  v_dot2_f32_bf16 v51, v69, s62, v51
  v_dot2_f32_bf16 v52, v70, s61, v52
  v_dot2_f32_bf16 v53, v70, s62, v53
  v_dot2_f32_bf16 v54, v71, s61, v54
  v_dot2_f32_bf16 v55, v71, s62, v55
  v_dot2_f32_bf16 v48, v72, s61, v48
  v_dot2_f32_bf16 v49, v72, s62, v49
  v_dot2_f32_bf16 v50, v73, s61, v50
  v_dot2_f32_bf16 v51, v73, s62, v51
  v_dot2_f32_bf16 v52, v74, s61, v52
  v_dot2_f32_bf16 v53, v74, s62, v53
  v_dot2_f32_bf16 v54, v75, s61, v54
  v_dot2_f32_bf16 v55, v75, s62, v55
  v_dot2_f32_bf16 v48, v76, s61, v48
  v_dot2_f32_bf16 v49, v76, s62, v49
  v_dot2_f32_bf16 v50, v77, s61, v50
  v_dot2_f32_bf16 v51, v77, s62, v51
  v_dot2_f32_bf16 v52, v78, s61, v52
  v_dot2_f32_bf16 v53, v78, s62, v53
  v_dot2_f32_bf16 v54, v79, s61, v54
  v_dot2_f32_bf16 v55, v79, s62, v55
  v_dot2_f32_bf16 v48, v80, s61, v48
  v_dot2_f32_bf16 v49, v80, s62, v49
  v_dot2_f32_bf16 v50, v81, s61, v50
  v_dot2_f32_bf16 v51, v81, s62, v51
  v_dot2_f32_bf16 v52, v82, s61, v52
  v_dot2_f32_bf16 v53, v82, s62, v53
  v_dot2_f32_bf16 v54, v83, s61, v54
  v_dot2_f32_bf16 v55, v83, s62, v55
  v_dot2_f32_bf16 v48, v84, s61, v48
  v_dot2_f32_bf16 v49, v84, s62, v49
  v_dot2_f32_bf16 v50, v85, s61, v50
  v_dot2_f32_bf16 v51, v85, s62, v51
  v_dot2_f32_bf16 v52, v86, s61, v52
  v_dot2_f32_bf16 v53, v86, s62, v53
  v_dot2_f32_bf16 v54, v87, s61, v54
  v_dot2_f32_bf16 v55, v87, s62, v55
  v_dot2_f32_bf16 v48, v88, s61, v48
  v_dot2_f32_bf16 v49, v88, s62, v49
  v_dot2_f32_bf16 v50, v89, s61, v50
  v_dot2_f32_bf16 v51, v89, s62, v51
  v_dot2_f32_bf16 v52, v90, s61, v52
  v_dot2_f32_bf16 v53, v90, s62, v53
  v_dot2_f32_bf16 v54, v91, s61, v54
  v_dot2_f32_bf16 v55, v91, s62, v55
  v_cvt_pk_bf16_f32 v40, v48, v49
  v_cvt_pk_bf16_f32 v41, v50, v51
  v_cvt_pk_bf16_f32 v42, v52, v53
  v_cvt_pk_bf16_f32 v43, v54, v55
  s_cmp_eq_u32 s16, 0
  s_cbranch_scc1 FR_R_LN
  s_mov_b64 exec, s[50:51]
  buffer_store_dwordx2 v[40:41], v0, s[44:47], s27 offen nt
  buffer_store_dwordx2 v[42:43], v0, s[44:47], s27 offen offset:32 nt
  s_mov_b64 exec, -1
  s_barrier
  s_branch FR_R_E
FR_R_LN:
  v_mov_b32 v64, 0
  v_mov_b32 v65, 0
  v_dot2_f32_bf16 v64, v40, s52, v64
  v_dot2_f32_bf16 v65, v40, v40, v65
  v_dot2_f32_bf16 v64, v41, s52, v64
  v_dot2_f32_bf16 v65, v41, v41, v65
  v_dot2_f32_bf16 v64, v42, s52, v64
  v_dot2_f32_bf16 v65, v42, v42, v65
  v_dot2_f32_bf16 v64, v43, s52, v64
  v_dot2_f32_bf16 v65, v43, v43, v65
  v_and_b32 v4, 3, v1
  v_lshlrev_b32 v4, 3, v4
  v_add_u32 v4, 102912, v4
  s_lshl_b32 s37, s3, 5
  v_add_u32 v68, s37, v4
  v_mul_f32 v64, v64, v11
  v_mul_f32 v65, v65, v11
  s_add_u32 s42, s27, 83968000
  v_add_f32_dpp v64, v64, v64 row_ror:4 row_mask:0xf bank_mask:0xf
  v_add_f32_dpp v65, v65, v65 row_ror:4 row_mask:0xf bank_mask:0xf
  s_nop 0
  v_add_f32_dpp v64, v64, v64 row_ror:8 row_mask:0xf bank_mask:0xf
  v_add_f32_dpp v65, v65, v65 row_ror:8 row_mask:0xf bank_mask:0xf
  v_mov_b32 v66, v64
  v_mov_b32 v67, v65
  s_nop 0
  v_permlane16_swap_b32 v64, v66
  v_permlane16_swap_b32 v65, v67
  v_add_f32 v64, v64, v66
  v_add_f32 v65, v65, v67
  v_mov_b32 v66, v64
  v_mov_b32 v67, v65
  s_nop 0
  v_permlane32_swap_b32 v64, v66
  v_permlane32_swap_b32 v65, v67
  v_add_f32 v64, v64, v66
  v_add_f32 v65, v65, v67
  ds_write_b64 v68, v[64:65]
  buffer_store_dwordx4 v[40:43], v8, s[12:15], s42 offen sc1
  v_lshlrev_b32 v48, 16, v40
  v_and_b32 v49, 0xffff0000, v40
  v_lshlrev_b32 v50, 16, v41
  v_and_b32 v51, 0xffff0000, v41
  v_lshlrev_b32 v52, 16, v42
  v_and_b32 v53, 0xffff0000, v42
  v_lshlrev_b32 v54, 16, v43
  v_and_b32 v55, 0xffff0000, v43
  s_waitcnt lgkmcnt(0)
  s_barrier
  ds_read2_b64 v[64:67], v4 offset0:0 offset1:4
  ds_read2_b64 v[68:71], v4 offset0:8 offset1:12
  s_add_u32 s42, s27, 78462976
  s_waitcnt lgkmcnt(0)
  v_pk_add_f32 v[64:65], v[64:65], v[66:67]
  v_pk_add_f32 v[68:69], v[68:69], v[70:71]
  v_pk_add_f32 v[64:65], v[64:65], v[68:69]
  v_mul_f32 v64, s53, v64
  v_mul_f32 v66, v64, v64
  v_fma_f32 v66, v65, s53, -v66
  v_max_f32 v66, 0, v66
  v_add_f32 v66, 0x3727c5ac, v66
  v_rsq_f32 v66, v66
  v_pk_add_f32 v[48:49], v[48:49], v[64:65] op_sel_hi:[1,0] neg_lo:[0,1] neg_hi:[0,1]
  v_pk_add_f32 v[50:51], v[50:51], v[64:65] op_sel_hi:[1,0] neg_lo:[0,1] neg_hi:[0,1]
  v_pk_add_f32 v[52:53], v[52:53], v[64:65] op_sel_hi:[1,0] neg_lo:[0,1] neg_hi:[0,1]
  v_pk_add_f32 v[54:55], v[54:55], v[64:65] op_sel_hi:[1,0] neg_lo:[0,1] neg_hi:[0,1]
  v_pk_mul_f32 v[48:49], v[48:49], v[66:67] op_sel_hi:[1,0]
  v_pk_mul_f32 v[50:51], v[50:51], v[66:67] op_sel_hi:[1,0]
  v_pk_mul_f32 v[52:53], v[52:53], v[66:67] op_sel_hi:[1,0]
  v_pk_mul_f32 v[54:55], v[54:55], v[66:67] op_sel_hi:[1,0]
  v_cvt_pk_bf16_f32 v68, v48, v49
  v_cvt_pk_bf16_f32 v69, v50, v51
  v_cvt_pk_bf16_f32 v70, v52, v53
  v_cvt_pk_bf16_f32 v71, v54, v55
  buffer_store_dwordx4 v[68:71], v8, s[12:15], s42 offen sc1
FR_R_E:
  v_mov_b32 v63, s63
  buffer_store_dword v63, off, s[12:15], s55
  s_add_u32 s21, s21, 28672
  s_add_u32 s27, s27, 28672
  s_add_u32 s23, s23, 1
  s_add_u32 s54, s54, 1
  s_cmp_lt_u32 s54, 3
  s_cbranch_scc1 FR_N
  s_mov_b32 s54, 0
  s_add_u32 s63, s63, 1
  s_add_u32 s41, s41, 1
  s_cmp_eq_u32 s41, 3
  s_cselect_b32 s41, 0, s41
FR_N:
  s_add_u32 s59, s27, 78635008
  s_add_u32 s60, s27, 84140032
  s_lshl_b32 s37, s16, 6
  s_add_u32 s37, s37, s23
  s_cmp_lt_u32 s37, 58
  s_cselect_b32 s59, s59, 2147418112
  s_cselect_b32 s60, s60, 2147418112
  buffer_store_dwordx4 v[36:39], v8, s[12:15], s59 offen sc1
  buffer_store_dwordx4 v[36:39], v8, s[12:15], s60 offen sc1
  s_barrier
  s_cmp_lt_u32 s23, 64
  s_cbranch_scc1 FR_L
  s_endpgm
CODE_END:
.section .rodata,"a"
.p2align 6
.amdhsa_kernel interleave_layers__memory_aug_recurrent_mem_tr__dense_activation_silu__prompt_kernel
  .amdhsa_next_free_vgpr 512
  .amdhsa_next_free_sgpr 102
  .amdhsa_accum_offset 256
  .amdhsa_group_segment_fixed_size 0
  .amdhsa_kernarg_size 104
  .amdhsa_user_sgpr_count 2
  .amdhsa_user_sgpr_kernarg_segment_ptr 1
  .amdhsa_system_sgpr_workgroup_id_x 1
  .amdhsa_float_denorm_mode_32 3
.end_amdhsa_kernel
```
